```python
import torch

def _softmax(x, axis=-1):
    return torch.softmax(x, dim=axis)
def _gelu(x):
    return torch.nn.functional.gelu(x, approximate="tanh")
def _silu(x):
    return torch.nn.functional.silu(x)
def _sigmoid(x):
    return torch.sigmoid(x)
def _layernorm(x, axis=-1, eps=1e-5):
    m = x.mean(dim=axis, keepdim=True)
    v = x.var(dim=axis, keepdim=True, unbiased=False)
    return (x - m) / torch.sqrt(v + eps)
def _scatter_add(tgt, idx, src, axis=0):
    return tgt.clone().index_add_(axis, idx, src)
def _segment_sum(src, seg, n):
    out = torch.zeros((n,) + src.shape[1:], dtype=src.dtype)
    return out.index_add_(0, seg, src)
def _pad(x, pw):
    flat = tuple(v for pair in reversed(pw) for v in pair)
    return torch.nn.functional.pad(x, flat)

kernel_name = 'sequential_preLN__spectral_fnet__glu_gated_glu__prompt'

def setup_inputs():

    _w = (lambda a: (lambda t: t.to(torch.bfloat16) if t.is_floating_point() else t)(torch.as_tensor(a)))
    def _A_setup():
        B, S, D = 1, 2048, 576
        ns = torch.arange(S)[:, None] * torch.arange(S)[None, :]
        nd = torch.arange(D)[:, None] * torch.arange(D)[None, :]
        Ws_re = torch.cos(-2.0 * torch.pi * ns / S).to(float)
        Ws_im = torch.sin(-2.0 * torch.pi * ns / S).to(float)
        Wd_re = torch.cos(-2.0 * torch.pi * nd / D).to(float)
        Wd_im = torch.sin(-2.0 * torch.pi * nd / D).to(float)
        return {
            "x": _w((lambda *s: torch.randn(*s, dtype=torch.bfloat16) * 0.05)(B, S, D)),
            "dft_seq_re": _w(Ws_re),
            "dft_seq_im": _w(Ws_im),
            "dft_hid_re": _w(Wd_re),
            "dft_hid_im": _w(Wd_im),
        }
    _A_in = _A_setup()

    def _B_setup():
        B, S, D, F = 1, 2048, 576, 4608
        return {
            "x": _w((lambda *s: torch.randn(*s, dtype=torch.bfloat16) * 0.05)(B, S, D)),
            "w_gate": _w((lambda *s: torch.randn(*s, dtype=torch.bfloat16) * 1.6)(D, F)),
            "w_up": _w((lambda *s: torch.randn(*s, dtype=torch.bfloat16) * 0.4)(D, F)),
            "w_down": _w((lambda *s: torch.randn(*s, dtype=torch.bfloat16) * 0.4)(F, D)),
        }
    _B_in = _B_setup()

    return {
        "A_x": _A_in["x"],
        "A_dft_seq_re": _A_in["dft_seq_re"],
        "A_dft_seq_im": _A_in["dft_seq_im"],
        "A_dft_hid_re": _A_in["dft_hid_re"],
        "A_dft_hid_im": _A_in["dft_hid_im"],
        "B_x": _B_in["x"],
        "B_w_gate": _B_in["w_gate"],
        "B_w_up": _B_in["w_up"],
        "B_w_down": _B_in["w_down"],
    }

def reference(A_x, A_dft_seq_re, A_dft_seq_im, A_dft_hid_re, A_dft_hid_im, B_x, B_w_gate, B_w_up, B_w_down):
    def _A_ref(x, dft_seq_re, dft_seq_im, dft_hid_re, dft_hid_im):
        a = torch.einsum("bsd,ed->bse", x, dft_hid_re)
        b = torch.einsum("bsd,ed->bse", x, dft_hid_im)
        y = torch.einsum("ts,bse->bte", dft_seq_re, a) - torch.einsum("ts,bse->bte", dft_seq_im, b)
        return y

    def _B_ref(x, w_gate, w_up, w_down):
        g = torch.einsum("bsd,df->bsf", x, w_gate)
        u = torch.einsum("bsd,df->bsf", x, w_up)
        h = _sigmoid(g) * u
        return torch.einsum("bsf,fd->bsd", h, w_down)

    x = A_x
    h = x + _A_ref(_layernorm(x, axis=-1), A_dft_seq_re, A_dft_seq_im, A_dft_hid_re, A_dft_hid_im)
    h2 = h + _B_ref(_layernorm(h, axis=-1), B_w_gate, B_w_up, B_w_down)
    return h2
```

```asm
; @launch grid=(256,1,1) block=(256,1,1) lds=163840
.amdgcn_target "amdgcn-amd-amdhsa--gfx950"
.text
.globl sequential_preLN__spectral_fnet__glu_gated_glu__prompt_kernel
.p2align 8
.type sequential_preLN__spectral_fnet__glu_gated_glu__prompt_kernel,@function
sequential_preLN__spectral_fnet__glu_gated_glu__prompt_kernel:
Lfnet_glu_kernel_beg:
    s_cmp_ge_u32 s2, 256
    s_cbranch_scc1 fnet_glu_kernel_end
    s_load_dwordx2 s[4:5], s[0:1], 0
    s_load_dwordx4 s[44:47], s[0:1], 8
    s_load_dwordx4 s[20:23], s[0:1], 24
    s_load_dwordx4 s[56:59], s[0:1], 80
    s_load_dwordx4 s[84:87], s[0:1], 48
    v_lshrrev_b32 v1, 6, v0
    s_nop 0
    v_readfirstlane_b32 s3, v1
    s_nop 3
    s_getpc_b64 s[48:49]
fnet_glu_kernel_pc_1:
    s_sub_u32 s48, s48, fnet_glu_kernel_pc_1-Lfnet_glu_kernel_beg
    s_subb_u32 s49, s49, 0
    v_mov_b32 v15, s49
    v_mov_b32 v14, s2
    v_bfe_u32 v14, v14, 3, 3
    v_lshl_add_u32 v14, v14, 2, s3
    v_and_b32 v16, 15, v0
    v_lshl_add_u32 v14, v14, 4, v16
    v_lshlrev_b32 v14, 7, v14
    v_min_u32 v14, fnet_glu_kernel_end-Lfnet_glu_kernel_beg, v14
    v_add_co_u32 v14, vcc, s48, v14
    v_addc_co_u32 v15, vcc, 0, v15, vcc
    global_load_dword v222, v[14:15], off
    s_and_b32 s24, s2, 7
    s_lshr_b32 s25, s2, 3
    s_lshr_b32 s26, s24, 1
    s_lshl_b32 s26, s26, 3
    s_and_b32 s34, s25, 7
    s_add_u32 s26, s26, s34
    s_and_b32 s28, s24, 1
    s_lshr_b32 s27, s25, 3
    s_lshl_b32 s36, s27, 1
    s_add_u32 s34, s34, s36
    s_sub_u32 s36, s34, 9
    s_cmp_ge_u32 s34, 9
    s_cselect_b32 s34, s36, s34
    s_lshl_b32 s34, s34, 7
    s_mov_b32 s37, s34
    v_and_b32 v1, 63, v0
    v_lshrrev_b32 v2, 3, v1
    v_and_b32 v3, 7, v1
    v_lshrrev_b32 v5, 1, v2
    v_xor_b32 v5, v5, v3
    v_xor_b32 v3, 4, v5
    s_lshr_b32 s29, s3, 1
    s_lshl_b32 s29, s29, 5
    s_and_b32 s31, s3, 1
    s_lshl_b32 s31, s31, 2
    s_add_u32 s29, s29, s31
    s_lshl_b32 s30, s26, 6
    s_add_u32 s29, s29, s30
    v_and_b32 v4, 4, v2
    v_add_u32 v4, v4, v2
    v_add_u32 v4, s29, v4
    v_mul_u32_u24 v6, 1152, v4
    v_lshl_add_u32 v4, v5, 4, v6
    v_lshl_add_u32 v7, v3, 4, v6
    v_add_u32 v7, 17408, v7
    s_lshl_b32 s38, s3, 11
    s_mul_i32 s32, s27, 9
    s_lshl_b32 s29, s3, 1
    s_add_u32 s33, s32, s29
    s_mul_i32 s29, s33, 18432
    s_lshl_b32 s35, s3, 12
    s_add_u32 s35, s35, 98304
    v_mul_u32_u24 v13, 1152, v2
    v_add_u32 v6, s29, v13
    v_lshl_add_u32 v8, v5, 4, v6
    v_lshl_add_u32 v9, v3, 4, v6
    v_add_u32 v9, 8192, v9
    v_add_u32 v10, 16384, v8
    v_add_u32 v11, 16384, v9
    s_add_u32 s32, s32, 8
    s_mul_i32 s29, s32, 18432
    s_mul_i32 s30, s3, 9216
    s_add_u32 s29, s29, s30
    s_lshl_b32 s39, s3, 10
    s_add_u32 s39, s39, 8192
    s_cmp_lt_u32 s3, 2
    s_cselect_b32 s29, s29, 0x40000000
    s_cselect_b32 s39, s39, 0x29000
    v_xor_b32 v12, s31, v5
    v_lshl_add_u32 v12, v12, 4, v13
    v_add_u32 v12, s29, v12
    s_waitcnt lgkmcnt(0)
    s_mov_b32 s8, s4
    s_and_b32 s9, s5, 0xffff
    s_mov_b32 s10, 0x240000
    s_mov_b32 s11, 0x00020000
    s_cmp_eq_u32 s28, 0
    s_cselect_b32 s12, s20, s22
    s_cselect_b32 s13, s21, s23
    s_and_b32 s13, s13, 0xffff
    s_mov_b32 s14, 663552
    s_mov_b32 s15, 0x00020000
    s_mov_b32 s6, s58
    s_mov_b32 s7, s59
    s_add_u32 m0, s38, 0
    s_nop 0
    buffer_load_dwordx4 v4, s[8:11], s37 offen lds
    buffer_load_dwordx4 v7, s[8:11], s37 offen offset:1024 lds
    s_add_u32 m0, s39, 0
    s_nop 0
    buffer_load_dwordx4 v12, s[12:15], s37 offen lds
    s_add_u32 s37, s37, 128
    s_cmp_eq_u32 s37, 1152
    s_cselect_b32 s37, 0, s37
    s_add_u32 m0, s35, 0
    s_nop 0
    buffer_load_dwordx4 v8, s[12:15], s34 offen offset:0 lds
    buffer_load_dwordx4 v9, s[12:15], s34 offen offset:1024 lds
    buffer_load_dwordx4 v10, s[12:15], s34 offen offset:2048 lds
    buffer_load_dwordx4 v11, s[12:15], s34 offen offset:3072 lds
    s_add_u32 s34, s34, 128
    s_cmp_eq_u32 s34, 1152
    s_cselect_b32 s34, 0, s34
    s_add_u32 m0, s38, 10240
    s_nop 0
    buffer_load_dwordx4 v4, s[8:11], s37 offen lds
    buffer_load_dwordx4 v7, s[8:11], s37 offen offset:1024 lds
    s_add_u32 m0, s39, 10240
    s_nop 0
    buffer_load_dwordx4 v12, s[12:15], s37 offen lds
    s_add_u32 s37, s37, 128
    s_cmp_eq_u32 s37, 1152
    s_cselect_b32 s37, 0, s37
    s_add_u32 s52, s6, 0x3600000
    s_addc_u32 s53, s7, 0
    s_and_b32 s53, s53, 0xffff
    s_mov_b32 s54, 0x28080
    s_mov_b32 s55, 0x00020000
    s_mov_b32 s48, s56
    s_and_b32 s49, s57, 0xffff
    s_mov_b32 s50, 0x100
    s_mov_b32 s51, 0x00020000
    v_mov_b32 v221, 0x40000000
    v_cmp_eq_u32 vcc, 0, v0
    v_mov_b32 v220, 0
    s_nop 0
    v_cndmask_b32 v223, v221, v0, vcc
    s_or_b32 s29, s2, s3
    s_cmp_lg_u32 s29, 0
    s_cbranch_scc1 fnet_glu_kernel_non_2
    s_mov_b32 s29, 163840
    buffer_load_dword v219, v220, s[52:55], s29 offen sc1
    s_waitcnt vmcnt(0)
    v_add_u32 v219, 1, v219
    v_max_u32 v219, 1, v219
    buffer_store_dword v219, v223, s[48:51], 0 offen sc1
    buffer_store_dword v219, v223, s[52:55], s29 offen sc1
fnet_glu_kernel_non_2:
    v_lshrrev_b32 v21, 4, v1
    v_and_b32 v22, 15, v1
    v_lshrrev_b32 v20, 1, v22
    v_xor_b32 v20, v20, v21
    v_lshlrev_b32 v20, 4, v20
    v_lshl_add_u32 v20, v22, 7, v20
    v_add_u32 v14, s35, v20
    v_xor_b32 v15, 64, v14
    v_mov_b32 v16, v20
    v_xor_b32 v17, 64, v16
    v_add_u32 v18, 0x8000, v16
    v_add_u32 v19, 0x8000, v17
    v_add_u32 v200, s38, v20
    v_xor_b32 v201, 64, v200
    v_add_u32 v202, 0x8000, v200
    v_add_u32 v203, 0x8000, v201
    s_add_u32 s16, s6, 0x0
    s_addc_u32 s17, s7, 0
    s_and_b32 s17, s17, 0xffff
    s_mov_b32 s18, 0x480000
    s_mov_b32 s19, 0x00020000
    s_lshl_b32 s40, s28, 6
    s_lshl_b32 s41, s26, 1
    s_add_u32 s40, s40, s41
    s_lshl_b32 s61, s40, 1
    s_add_u32 s61, s61, s27
    s_lshl_b32 s61, s61, 7
    s_add_u32 s61, s61, 131072
    s_lshr_b32 s30, s3, 1
    s_add_u32 s43, s40, s30
    s_mul_i32 s43, s43, 36
    s_add_u32 s43, s43, s32
    s_lshl_b32 s43, s43, 10
    s_lshl_b32 s30, s31, 1
    s_add_u32 s43, s43, s30
    s_mul_i32 s40, s40, 36
    s_add_u32 s40, s40, s33
    s_lshl_b32 s40, s40, 10
    s_add_u32 s42, s40, 36864
    v_lshlrev_b32 v2, 4, v1
    v_lshlrev_b32 v23, 5, v21
    v_add_u32 v23, 92160, v23
    s_cmp_eq_u32 s28, 0
    s_cselect_b32 s41, 1.0, -1.0
    s_lshl_b32 s31, s3, 7
    v_add_u32 v3, s31, v23
    s_add_u32 s31, s31, 92160
    v_lshl_add_u32 v204, v22, 3, s31
    v_lshrrev_b32 v205, 2, v22
    v_cmp_eq_u32 vcc, v205, v21
    v_mov_b32 v205, 92672
    s_nop 0
    v_cndmask_b32 v204, v205, v204, vcc
    v_and_b32 v205, 3, v22
    v_cmp_eq_u32 s[20:21], 1, v205
    v_cmp_eq_u32 s[22:23], 2, v205
    v_cmp_eq_u32 s[62:63], 3, v205
    s_lshr_b32 s74, s2, 3
    s_mul_i32 s75, s74, 43
    s_lshr_b32 s75, s75, 7
    s_mul_i32 s68, s75, 3
    s_sub_u32 s74, s74, s68
    s_mul_i32 s68, s24, 10
    s_add_u32 s75, s75, s68
    s_and_b32 s71, s75, 15
    s_lshr_b32 s75, s75, 4
    s_mul_i32 s69, s75, 13
    s_add_u32 s70, s69, 13
    s_mul_i32 s68, s74, 4
    s_add_u32 s68, s68, s69
    s_lshl_b32 s71, s71, 19
    s_lshl_b32 s72, s3, 12
    s_and_b32 s45, s45, 0xffff
    s_and_b32 s47, s47, 0xffff
    s_mov_b32 s64, s44
    s_mov_b32 s65, s45
    s_mov_b32 s66, 8388608
    s_mov_b32 s67, 0x00020000
    v_lshrrev_b32 v212, 3, v1
    s_lshl_b32 s73, s3, 5
    v_add_u32 v212, s73, v212
    v_lshlrev_b32 v212, 12, v212
    v_lshl_add_u32 v208, v5, 4, v212
    v_xor_b32 v213, 4, v5
    v_lshl_add_u32 v209, v213, 4, v212
    v_add_u32 v209, 31744, v209
    v_add_u32 v210, 63488, v208
    v_add_u32 v211, 63488, v209
    v_mov_b32 v24, 0x3f803f80
    v_mov_b32 v25, 0x3f803f80
    v_mov_b32 v26, 0x3f803f80
    v_mov_b32 v27, 0x3f803f80
    s_add_u32 m0, s38, 20480
    s_nop 0
    buffer_load_dwordx4 v4, s[8:11], s37 offen lds
    buffer_load_dwordx4 v7, s[8:11], s37 offen offset:1024 lds
    s_add_u32 m0, s39, 20480
    s_nop 0
    buffer_load_dwordx4 v12, s[12:15], s37 offen lds
    s_add_u32 s37, s37, 128
    s_cmp_eq_u32 s37, 1152
    s_cselect_b32 s37, 0, s37
    s_add_u32 m0, s35, 16384
    s_nop 0
    buffer_load_dwordx4 v8, s[12:15], s34 offen offset:0 lds
    buffer_load_dwordx4 v9, s[12:15], s34 offen offset:1024 lds
    buffer_load_dwordx4 v10, s[12:15], s34 offen offset:2048 lds
    buffer_load_dwordx4 v11, s[12:15], s34 offen offset:3072 lds
    s_add_u32 s34, s34, 128
    s_cmp_eq_u32 s34, 1152
    s_cselect_b32 s34, 0, s34
    s_waitcnt vmcnt(10)
    ds_read_b128 v[120:123], v14 offset:0
    ds_read_b128 v[124:127], v14 offset:2048
    ds_read_b128 v[128:131], v15 offset:0
    ds_read_b128 v[132:135], v15 offset:2048
    s_waitcnt vmcnt(4)
    s_barrier
    ds_read_b128 v[88:91], v16 offset:0
    ds_read_b128 v[92:95], v16 offset:2048
    ds_read_b128 v[96:99], v16 offset:4096
    ds_read_b128 v[100:103], v16 offset:6144
    ds_read_b128 v[152:155], v200 offset:0
    ds_read_b128 v[156:159], v16 offset:8192
    ds_read_b128 v[160:163], v201 offset:0
    ds_read_b128 v[164:167], v17 offset:8192
    s_add_u32 m0, s38, 30720
    s_nop 0
    buffer_load_dwordx4 v4, s[8:11], s37 offen lds
    buffer_load_dwordx4 v7, s[8:11], s37 offen offset:1024 lds
    s_add_u32 m0, s39, 30720
    s_nop 0
    buffer_load_dwordx4 v12, s[12:15], s37 offen lds
    s_add_u32 s37, s37, 128
    s_cmp_eq_u32 s37, 1152
    s_cselect_b32 s37, 0, s37
    s_add_u32 m0, s35, 32768
    s_nop 0
    buffer_load_dwordx4 v8, s[12:15], s34 offen offset:0 lds
    buffer_load_dwordx4 v9, s[12:15], s34 offen offset:1024 lds
    buffer_load_dwordx4 v10, s[12:15], s34 offen offset:2048 lds
    buffer_load_dwordx4 v11, s[12:15], s34 offen offset:3072 lds
    s_add_u32 s34, s34, 128
    s_cmp_eq_u32 s34, 1152
    s_cselect_b32 s34, 0, s34
    s_waitcnt lgkmcnt(6)
    v_mfma_f32_16x16x32_bf16 v[28:31], v[88:91], v[120:123], 0
    ds_read_b128 v[104:107], v17 offset:0
    v_mfma_f32_16x16x32_bf16 v[48:51], v[88:91], v[124:127], 0
    s_add_u32 m0, s38, 40960
    v_mfma_f32_16x16x32_bf16 v[32:35], v[92:95], v[120:123], 0
    ds_read_b128 v[108:111], v17 offset:2048
    buffer_load_dwordx4 v4, s[8:11], s37 offen lds
    v_mfma_f32_16x16x32_bf16 v[52:55], v[92:95], v[124:127], 0
    s_waitcnt lgkmcnt(6)
    buffer_load_dwordx4 v7, s[8:11], s37 offen offset:1024 lds
    s_add_u32 m0, s39, 40960
    v_mfma_f32_16x16x32_bf16 v[36:39], v[96:99], v[120:123], 0
    ds_read_b128 v[112:115], v17 offset:4096
    buffer_load_dwordx4 v12, s[12:15], s37 offen lds
    v_mfma_f32_16x16x32_bf16 v[56:59], v[96:99], v[124:127], 0
    s_add_u32 s37, s37, 128
    s_cmp_eq_u32 s37, 1152
    s_cselect_b32 s37, 0, s37
    v_mfma_f32_16x16x32_bf16 v[40:43], v[100:103], v[120:123], 0
    ds_read_b128 v[116:119], v17 offset:6144
    v_mfma_f32_16x16x32_bf16 v[60:63], v[100:103], v[124:127], 0
    s_add_u32 m0, s35, 0
    v_mfma_f32_16x16x32_bf16 v[44:47], v[24:27], v[120:123], 0
    buffer_load_dwordx4 v8, s[12:15], s34 offen offset:0 lds
    v_mfma_f32_16x16x32_bf16 v[64:67], v[24:27], v[124:127], 0
    s_waitcnt lgkmcnt(6)
    buffer_load_dwordx4 v9, s[12:15], s34 offen offset:1024 lds
    v_mfma_f32_16x16x32_bf16 v[184:187], v[152:155], v[24:27], 0
    buffer_load_dwordx4 v10, s[12:15], s34 offen offset:2048 lds
    v_mfma_f32_16x16x32_bf16 v[188:191], v[152:155], v[152:155], 0
    buffer_load_dwordx4 v11, s[12:15], s34 offen offset:3072 lds
    v_mfma_f32_16x16x32_bf16 v[68:71], v[152:155], v[156:159], 0
    s_add_u32 s34, s34, 128
    s_cmp_eq_u32 s34, 1152
    s_cselect_b32 s34, 0, s34
    v_mfma_f32_16x16x32_bf16 v[72:75], v[24:27], v[156:159], 0
    s_waitcnt lgkmcnt(2)
    s_add_u32 m0, s38, 51200
    v_mfma_f32_16x16x32_bf16 v[28:31], v[104:107], v[128:131], v[28:31]
    ds_read_b128 v[88:91], v16 offset:10240
    buffer_load_dwordx4 v4, s[8:11], s37 offen lds
    v_mfma_f32_16x16x32_bf16 v[48:51], v[104:107], v[132:135], v[48:51]
    buffer_load_dwordx4 v7, s[8:11], s37 offen offset:1024 lds
    v_mfma_f32_16x16x32_bf16 v[32:35], v[108:111], v[128:131], v[32:35]
    ds_read_b128 v[92:95], v16 offset:12288
    s_add_u32 m0, s39, 51200
    v_mfma_f32_16x16x32_bf16 v[52:55], v[108:111], v[132:135], v[52:55]
    s_waitcnt lgkmcnt(2)
    buffer_load_dwordx4 v12, s[12:15], s37 offen lds
    v_mfma_f32_16x16x32_bf16 v[36:39], v[112:115], v[128:131], v[36:39]
    ds_read_b128 v[96:99], v16 offset:14336
    s_add_u32 s37, s37, 128
    s_cmp_eq_u32 s37, 1152
    s_cselect_b32 s37, 0, s37
    v_mfma_f32_16x16x32_bf16 v[56:59], v[112:115], v[132:135], v[56:59]
    s_waitcnt vmcnt(17)
    ds_read_b128 v[136:139], v14 offset:16384
    v_mfma_f32_16x16x32_bf16 v[40:43], v[116:119], v[128:131], v[40:43]
    ds_read_b128 v[100:103], v16 offset:16384
    ds_read_b128 v[140:143], v14 offset:18432
    v_mfma_f32_16x16x32_bf16 v[60:63], v[116:119], v[132:135], v[60:63]
    v_mfma_f32_16x16x32_bf16 v[44:47], v[24:27], v[128:131], v[44:47]
    ds_read_b128 v[144:147], v15 offset:16384
    v_mfma_f32_16x16x32_bf16 v[64:67], v[24:27], v[132:135], v[64:67]
    ds_read_b128 v[148:151], v15 offset:18432
    v_mfma_f32_16x16x32_bf16 v[184:187], v[160:163], v[24:27], v[184:187]
    v_mfma_f32_16x16x32_bf16 v[188:191], v[160:163], v[160:163], v[188:191]
    v_mfma_f32_16x16x32_bf16 v[68:71], v[160:163], v[164:167], v[68:71]
    ds_read_b128 v[168:171], v200 offset:10240
    v_mfma_f32_16x16x32_bf16 v[72:75], v[24:27], v[164:167], v[72:75]
    s_waitcnt lgkmcnt(3)
    v_mfma_f32_16x16x32_bf16 v[28:31], v[88:91], v[136:139], v[28:31]
    ds_read_b128 v[104:107], v17 offset:10240
    v_mfma_f32_16x16x32_bf16 v[48:51], v[88:91], v[140:143], v[48:51]
    ds_read_b128 v[172:175], v16 offset:18432
    s_add_u32 m0, s38, 61440
    v_mfma_f32_16x16x32_bf16 v[32:35], v[92:95], v[136:139], v[32:35]
    ds_read_b128 v[108:111], v17 offset:12288
    buffer_load_dwordx4 v4, s[8:11], s37 offen lds
    v_mfma_f32_16x16x32_bf16 v[52:55], v[92:95], v[140:143], v[52:55]
    buffer_load_dwordx4 v7, s[8:11], s37 offen offset:1024 lds
    v_mfma_f32_16x16x32_bf16 v[36:39], v[96:99], v[136:139], v[36:39]
    ds_read_b128 v[112:115], v17 offset:14336
    s_add_u32 m0, s39, 61440
    v_mfma_f32_16x16x32_bf16 v[56:59], v[96:99], v[140:143], v[56:59]
    buffer_load_dwordx4 v12, s[12:15], s37 offen lds
    v_mfma_f32_16x16x32_bf16 v[40:43], v[100:103], v[136:139], v[40:43]
    ds_read_b128 v[116:119], v17 offset:16384
    v_mfma_f32_16x16x32_bf16 v[60:63], v[100:103], v[140:143], v[60:63]
    s_add_u32 s37, s37, 128
    s_cmp_eq_u32 s37, 1152
    s_cselect_b32 s37, 0, s37
    s_waitcnt lgkmcnt(6)
    v_mfma_f32_16x16x32_bf16 v[44:47], v[24:27], v[136:139], v[44:47]
    v_mfma_f32_16x16x32_bf16 v[64:67], v[24:27], v[140:143], v[64:67]
    s_waitcnt lgkmcnt(3)
    s_add_u32 m0, s35, 16384
    v_mfma_f32_16x16x32_bf16 v[184:187], v[168:171], v[24:27], v[184:187]
    buffer_load_dwordx4 v8, s[12:15], s34 offen offset:0 lds
    v_mfma_f32_16x16x32_bf16 v[188:191], v[168:171], v[168:171], v[188:191]
    buffer_load_dwordx4 v9, s[12:15], s34 offen offset:1024 lds
    v_mfma_f32_16x16x32_bf16 v[68:71], v[168:171], v[172:175], v[68:71]
    ds_read_b128 v[176:179], v201 offset:10240
    buffer_load_dwordx4 v10, s[12:15], s34 offen offset:2048 lds
    v_mfma_f32_16x16x32_bf16 v[72:75], v[24:27], v[172:175], v[72:75]
    s_waitcnt lgkmcnt(3)
    buffer_load_dwordx4 v11, s[12:15], s34 offen offset:3072 lds
    v_mfma_f32_16x16x32_bf16 v[28:31], v[104:107], v[144:147], v[28:31]
    ds_read_b128 v[88:91], v16 offset:20480
    v_mfma_f32_16x16x32_bf16 v[48:51], v[104:107], v[148:151], v[48:51]
    ds_read_b128 v[180:183], v17 offset:18432
    v_mfma_f32_16x16x32_bf16 v[32:35], v[108:111], v[144:147], v[32:35]
    ds_read_b128 v[92:95], v16 offset:22528
    ds_read_b128 v[152:155], v200 offset:20480
    v_mfma_f32_16x16x32_bf16 v[52:55], v[108:111], v[148:151], v[52:55]
    s_waitcnt lgkmcnt(5)
    s_add_u32 s34, s34, 128
    s_cmp_eq_u32 s34, 1152
    s_cselect_b32 s34, 0, s34
    v_mfma_f32_16x16x32_bf16 v[36:39], v[112:115], v[144:147], v[36:39]
    ds_read_b128 v[96:99], v16 offset:24576
    s_add_u32 m0, s38, 71680
    v_mfma_f32_16x16x32_bf16 v[56:59], v[112:115], v[148:151], v[56:59]
    ds_read_b128 v[156:159], v16 offset:28672
    buffer_load_dwordx4 v4, s[8:11], s37 offen lds
    v_mfma_f32_16x16x32_bf16 v[40:43], v[116:119], v[144:147], v[40:43]
    ds_read_b128 v[100:103], v16 offset:26624
    buffer_load_dwordx4 v7, s[8:11], s37 offen offset:1024 lds
    v_mfma_f32_16x16x32_bf16 v[60:63], v[116:119], v[148:151], v[60:63]
    s_add_u32 m0, s39, 71680
    v_mfma_f32_16x16x32_bf16 v[44:47], v[24:27], v[144:147], v[44:47]
    buffer_load_dwordx4 v12, s[12:15], s37 offen lds
    s_add_u32 s37, s37, 128
    s_cmp_eq_u32 s37, 1152
    s_cselect_b32 s37, 0, s37
    v_mfma_f32_16x16x32_bf16 v[64:67], v[24:27], v[148:151], v[64:67]
    s_waitcnt lgkmcnt(5)
    s_waitcnt vmcnt(20)
    ds_read_b128 v[120:123], v14 offset:32768
    v_mfma_f32_16x16x32_bf16 v[184:187], v[176:179], v[24:27], v[184:187]
    ds_read_b128 v[124:127], v14 offset:34816
    v_mfma_f32_16x16x32_bf16 v[188:191], v[176:179], v[176:179], v[188:191]
    v_mfma_f32_16x16x32_bf16 v[68:71], v[176:179], v[180:183], v[68:71]
    ds_read_b128 v[128:131], v15 offset:32768
    v_mfma_f32_16x16x32_bf16 v[72:75], v[24:27], v[180:183], v[72:75]
    s_waitcnt lgkmcnt(4)
    ds_read_b128 v[132:135], v15 offset:34816
    v_mfma_f32_16x16x32_bf16 v[184:187], v[152:155], v[24:27], v[184:187]
    v_mfma_f32_16x16x32_bf16 v[188:191], v[152:155], v[152:155], v[188:191]
    v_mfma_f32_16x16x32_bf16 v[68:71], v[152:155], v[156:159], v[68:71]
    ds_read_b128 v[160:163], v201 offset:20480
    v_mfma_f32_16x16x32_bf16 v[72:75], v[24:27], v[156:159], v[72:75]
    s_waitcnt lgkmcnt(3)
    v_mfma_f32_16x16x32_bf16 v[28:31], v[88:91], v[120:123], v[28:31]
    ds_read_b128 v[104:107], v17 offset:20480
    v_mfma_f32_16x16x32_bf16 v[48:51], v[88:91], v[124:127], v[48:51]
    ds_read_b128 v[164:167], v17 offset:28672
    s_add_u32 m0, s38, 81920
    v_mfma_f32_16x16x32_bf16 v[32:35], v[92:95], v[120:123], v[32:35]
    ds_read_b128 v[108:111], v17 offset:22528
    buffer_load_dwordx4 v4, s[8:11], s37 offen lds
    v_mfma_f32_16x16x32_bf16 v[52:55], v[92:95], v[124:127], v[52:55]
    buffer_load_dwordx4 v7, s[8:11], s37 offen offset:1024 lds
    v_mfma_f32_16x16x32_bf16 v[36:39], v[96:99], v[120:123], v[36:39]
    ds_read_b128 v[112:115], v17 offset:24576
    v_mfma_f32_16x16x32_bf16 v[56:59], v[96:99], v[124:127], v[56:59]
    s_add_u32 m0, s39, 81920
    v_mfma_f32_16x16x32_bf16 v[40:43], v[100:103], v[120:123], v[40:43]
    ds_read_b128 v[116:119], v17 offset:26624
    buffer_load_dwordx4 v12, s[12:15], s37 offen lds
    v_mfma_f32_16x16x32_bf16 v[60:63], v[100:103], v[124:127], v[60:63]
    s_add_u32 s37, s37, 128
    s_cmp_eq_u32 s37, 1152
    s_cselect_b32 s37, 0, s37
    v_mfma_f32_16x16x32_bf16 v[44:47], v[24:27], v[120:123], v[44:47]
    v_mfma_f32_16x16x32_bf16 v[64:67], v[24:27], v[124:127], v[64:67]
    s_waitcnt lgkmcnt(3)
    v_mfma_f32_16x16x32_bf16 v[184:187], v[160:163], v[24:27], v[184:187]
    s_add_u32 m0, s35, 32768
    v_mfma_f32_16x16x32_bf16 v[188:191], v[160:163], v[160:163], v[188:191]
    v_mfma_f32_16x16x32_bf16 v[68:71], v[160:163], v[164:167], v[68:71]
    s_waitcnt vmcnt(13)
    s_barrier
    buffer_load_dwordx4 v8, s[12:15], s34 offen offset:0 lds
    v_mfma_f32_16x16x32_bf16 v[72:75], v[24:27], v[164:167], v[72:75]
    s_waitcnt lgkmcnt(2)
    ds_read_b128 v[168:171], v200 offset:30720
    v_mfma_f32_16x16x32_bf16 v[28:31], v[104:107], v[128:131], v[28:31]
    ds_read_b128 v[88:91], v16 offset:30720
    buffer_load_dwordx4 v9, s[12:15], s34 offen offset:1024 lds
    v_mfma_f32_16x16x32_bf16 v[48:51], v[104:107], v[132:135], v[48:51]
    buffer_load_dwordx4 v10, s[12:15], s34 offen offset:2048 lds
    v_mfma_f32_16x16x32_bf16 v[32:35], v[108:111], v[128:131], v[32:35]
    ds_read_b128 v[92:95], v18 offset:0
    ds_read_b128 v[172:175], v18 offset:6144
    v_mfma_f32_16x16x32_bf16 v[52:55], v[108:111], v[132:135], v[52:55]
    s_waitcnt lgkmcnt(4)
    buffer_load_dwordx4 v11, s[12:15], s34 offen offset:3072 lds
    v_mfma_f32_16x16x32_bf16 v[36:39], v[112:115], v[128:131], v[36:39]
    ds_read_b128 v[96:99], v18 offset:2048
    s_add_u32 s34, s34, 128
    s_cmp_eq_u32 s34, 1152
    s_cselect_b32 s34, 0, s34
    v_mfma_f32_16x16x32_bf16 v[56:59], v[112:115], v[132:135], v[56:59]
    ds_read_b128 v[136:139], v14 offset:0
    v_mfma_f32_16x16x32_bf16 v[40:43], v[116:119], v[128:131], v[40:43]
    ds_read_b128 v[100:103], v18 offset:4096
    ds_read_b128 v[140:143], v14 offset:2048
    v_mfma_f32_16x16x32_bf16 v[60:63], v[116:119], v[132:135], v[60:63]
    v_mfma_f32_16x16x32_bf16 v[44:47], v[24:27], v[128:131], v[44:47]
    ds_read_b128 v[144:147], v15 offset:0
    v_mfma_f32_16x16x32_bf16 v[64:67], v[24:27], v[132:135], v[64:67]
    s_waitcnt lgkmcnt(5)
    ds_read_b128 v[148:151], v15 offset:2048
    v_mfma_f32_16x16x32_bf16 v[184:187], v[168:171], v[24:27], v[184:187]
    v_mfma_f32_16x16x32_bf16 v[188:191], v[168:171], v[168:171], v[188:191]
    v_mfma_f32_16x16x32_bf16 v[68:71], v[168:171], v[172:175], v[68:71]
    ds_read_b128 v[176:179], v201 offset:30720
    v_mfma_f32_16x16x32_bf16 v[72:75], v[24:27], v[172:175], v[72:75]
    s_waitcnt lgkmcnt(3)
    v_mfma_f32_16x16x32_bf16 v[28:31], v[88:91], v[136:139], v[28:31]
    ds_read_b128 v[104:107], v17 offset:30720
    v_mfma_f32_16x16x32_bf16 v[48:51], v[88:91], v[140:143], v[48:51]
    ds_read_b128 v[180:183], v19 offset:6144
    s_waitcnt lgkmcnt(3)
    v_mfma_f32_16x16x32_bf16 v[32:35], v[92:95], v[136:139], v[32:35]
    ds_read_b128 v[108:111], v19 offset:0
    ds_read_b128 v[152:155], v202 offset:8192
    v_mfma_f32_16x16x32_bf16 v[52:55], v[92:95], v[140:143], v[52:55]
    v_mfma_f32_16x16x32_bf16 v[36:39], v[96:99], v[136:139], v[36:39]
    ds_read_b128 v[112:115], v19 offset:2048
    s_add_u32 m0, s35, 0
    v_mfma_f32_16x16x32_bf16 v[56:59], v[96:99], v[140:143], v[56:59]
    ds_read_b128 v[156:159], v18 offset:16384
    v_mfma_f32_16x16x32_bf16 v[40:43], v[100:103], v[136:139], v[40:43]
    ds_read_b128 v[116:119], v19 offset:4096
    v_mfma_f32_16x16x32_bf16 v[60:63], v[100:103], v[140:143], v[60:63]
    buffer_load_dwordx4 v8, s[12:15], s34 offen offset:0 lds
    v_mfma_f32_16x16x32_bf16 v[44:47], v[24:27], v[136:139], v[44:47]
    v_mfma_f32_16x16x32_bf16 v[64:67], v[24:27], v[140:143], v[64:67]
    s_waitcnt lgkmcnt(5)
    v_mfma_f32_16x16x32_bf16 v[184:187], v[176:179], v[24:27], v[184:187]
    buffer_load_dwordx4 v9, s[12:15], s34 offen offset:1024 lds
    v_mfma_f32_16x16x32_bf16 v[188:191], v[176:179], v[176:179], v[188:191]
    v_mfma_f32_16x16x32_bf16 v[68:71], v[176:179], v[180:183], v[68:71]
    v_mfma_f32_16x16x32_bf16 v[72:75], v[24:27], v[180:183], v[72:75]
    s_waitcnt lgkmcnt(1)
    buffer_load_dwordx4 v10, s[12:15], s34 offen offset:2048 lds
    v_mfma_f32_16x16x32_bf16 v[184:187], v[152:155], v[24:27], v[184:187]
    v_mfma_f32_16x16x32_bf16 v[188:191], v[152:155], v[152:155], v[188:191]
    v_mfma_f32_16x16x32_bf16 v[68:71], v[152:155], v[156:159], v[68:71]
    ds_read_b128 v[160:163], v203 offset:8192
    buffer_load_dwordx4 v11, s[12:15], s34 offen offset:3072 lds
    v_mfma_f32_16x16x32_bf16 v[72:75], v[24:27], v[156:159], v[72:75]
    v_mfma_f32_16x16x32_bf16 v[28:31], v[104:107], v[144:147], v[28:31]
    ds_read_b128 v[88:91], v18 offset:8192
    v_mfma_f32_16x16x32_bf16 v[48:51], v[104:107], v[148:151], v[48:51]
    ds_read_b128 v[164:167], v19 offset:16384
    v_mfma_f32_16x16x32_bf16 v[32:35], v[108:111], v[144:147], v[32:35]
    ds_read_b128 v[92:95], v18 offset:10240
    v_mfma_f32_16x16x32_bf16 v[52:55], v[108:111], v[148:151], v[52:55]
    s_waitcnt lgkmcnt(4)
    s_add_u32 s34, s34, 128
    s_cmp_eq_u32 s34, 1152
    s_cselect_b32 s34, 0, s34
    v_mfma_f32_16x16x32_bf16 v[36:39], v[112:115], v[144:147], v[36:39]
    ds_read_b128 v[96:99], v18 offset:12288
    s_waitcnt vmcnt(14)
    v_mfma_f32_16x16x32_bf16 v[56:59], v[112:115], v[148:151], v[56:59]
    ds_read_b128 v[120:123], v14 offset:16384
    v_mfma_f32_16x16x32_bf16 v[40:43], v[116:119], v[144:147], v[40:43]
    ds_read_b128 v[100:103], v18 offset:14336
    ds_read_b128 v[124:127], v14 offset:18432
    v_mfma_f32_16x16x32_bf16 v[60:63], v[116:119], v[148:151], v[60:63]
    ds_read_b128 v[128:131], v15 offset:16384
    v_mfma_f32_16x16x32_bf16 v[44:47], v[24:27], v[144:147], v[44:47]
    v_mfma_f32_16x16x32_bf16 v[64:67], v[24:27], v[148:151], v[64:67]
    s_waitcnt lgkmcnt(6)
    ds_read_b128 v[132:135], v15 offset:18432
    v_mfma_f32_16x16x32_bf16 v[184:187], v[160:163], v[24:27], v[184:187]
    v_mfma_f32_16x16x32_bf16 v[188:191], v[160:163], v[160:163], v[188:191]
    v_mfma_f32_16x16x32_bf16 v[68:71], v[160:163], v[164:167], v[68:71]
    ds_read_b128 v[168:171], v202 offset:18432
    v_mfma_f32_16x16x32_bf16 v[72:75], v[24:27], v[164:167], v[72:75]
    s_waitcnt lgkmcnt(3)
    v_mfma_f32_16x16x32_bf16 v[28:31], v[88:91], v[120:123], v[28:31]
    ds_read_b128 v[104:107], v19 offset:8192
    v_mfma_f32_16x16x32_bf16 v[48:51], v[88:91], v[124:127], v[48:51]
    ds_read_b128 v[172:175], v18 offset:26624
    s_waitcnt lgkmcnt(3)
    v_mfma_f32_16x16x32_bf16 v[32:35], v[92:95], v[120:123], v[32:35]
    ds_read_b128 v[108:111], v19 offset:10240
    v_mfma_f32_16x16x32_bf16 v[52:55], v[92:95], v[124:127], v[52:55]
    v_mfma_f32_16x16x32_bf16 v[36:39], v[96:99], v[120:123], v[36:39]
    ds_read_b128 v[112:115], v19 offset:12288
    s_add_u32 m0, s35, 16384
    v_mfma_f32_16x16x32_bf16 v[56:59], v[96:99], v[124:127], v[56:59]
    v_mfma_f32_16x16x32_bf16 v[40:43], v[100:103], v[120:123], v[40:43]
    ds_read_b128 v[116:119], v19 offset:14336
    v_mfma_f32_16x16x32_bf16 v[60:63], v[100:103], v[124:127], v[60:63]
    buffer_load_dwordx4 v8, s[12:15], s34 offen offset:0 lds
    v_mfma_f32_16x16x32_bf16 v[44:47], v[24:27], v[120:123], v[44:47]
    v_mfma_f32_16x16x32_bf16 v[64:67], v[24:27], v[124:127], v[64:67]
    s_waitcnt lgkmcnt(3)
    v_mfma_f32_16x16x32_bf16 v[184:187], v[168:171], v[24:27], v[184:187]
    buffer_load_dwordx4 v9, s[12:15], s34 offen offset:1024 lds
    v_mfma_f32_16x16x32_bf16 v[188:191], v[168:171], v[168:171], v[188:191]
    v_mfma_f32_16x16x32_bf16 v[68:71], v[168:171], v[172:175], v[68:71]
    ds_read_b128 v[176:179], v203 offset:18432
    v_mfma_f32_16x16x32_bf16 v[72:75], v[24:27], v[172:175], v[72:75]
    s_waitcnt lgkmcnt(3)
    buffer_load_dwordx4 v10, s[12:15], s34 offen offset:2048 lds
    v_mfma_f32_16x16x32_bf16 v[28:31], v[104:107], v[128:131], v[28:31]
    ds_read_b128 v[88:91], v18 offset:18432
    v_mfma_f32_16x16x32_bf16 v[48:51], v[104:107], v[132:135], v[48:51]
    ds_read_b128 v[180:183], v19 offset:26624
    v_mfma_f32_16x16x32_bf16 v[32:35], v[108:111], v[128:131], v[32:35]
    s_waitcnt vmcnt(11)
    s_barrier
    buffer_load_dwordx4 v11, s[12:15], s34 offen offset:3072 lds
    v_mfma_f32_16x16x32_bf16 v[52:55], v[108:111], v[132:135], v[52:55]
    s_waitcnt lgkmcnt(3)
    ds_read_b128 v[92:95], v18 offset:20480
    v_mfma_f32_16x16x32_bf16 v[36:39], v[112:115], v[128:131], v[36:39]
    ds_read_b128 v[96:99], v18 offset:22528
    ds_read_b128 v[152:155], v202 offset:28672
    v_mfma_f32_16x16x32_bf16 v[56:59], v[112:115], v[132:135], v[56:59]
    s_add_u32 s34, s34, 128
    s_cmp_eq_u32 s34, 1152
    s_cselect_b32 s34, 0, s34
    v_mfma_f32_16x16x32_bf16 v[40:43], v[116:119], v[128:131], v[40:43]
    ds_read_b128 v[100:103], v18 offset:24576
    ds_read_b128 v[156:159], v18 offset:36864
    v_mfma_f32_16x16x32_bf16 v[60:63], v[116:119], v[132:135], v[60:63]
    s_waitcnt vmcnt(8)
    ds_read_b128 v[136:139], v14 offset:32768
    v_mfma_f32_16x16x32_bf16 v[44:47], v[24:27], v[128:131], v[44:47]
    v_mfma_f32_16x16x32_bf16 v[64:67], v[24:27], v[132:135], v[64:67]
    s_waitcnt lgkmcnt(6)
    ds_read_b128 v[140:143], v14 offset:34816
    v_mfma_f32_16x16x32_bf16 v[184:187], v[176:179], v[24:27], v[184:187]
    v_mfma_f32_16x16x32_bf16 v[188:191], v[176:179], v[176:179], v[188:191]
    ds_read_b128 v[144:147], v15 offset:32768
    v_mfma_f32_16x16x32_bf16 v[68:71], v[176:179], v[180:183], v[68:71]
    v_mfma_f32_16x16x32_bf16 v[72:75], v[24:27], v[180:183], v[72:75]
    s_waitcnt lgkmcnt(3)
    ds_read_b128 v[148:151], v15 offset:34816
    v_mfma_f32_16x16x32_bf16 v[184:187], v[152:155], v[24:27], v[184:187]
    v_mfma_f32_16x16x32_bf16 v[188:191], v[152:155], v[152:155], v[188:191]
    v_mfma_f32_16x16x32_bf16 v[68:71], v[152:155], v[156:159], v[68:71]
    ds_read_b128 v[160:163], v203 offset:28672
    v_mfma_f32_16x16x32_bf16 v[72:75], v[24:27], v[156:159], v[72:75]
    s_waitcnt lgkmcnt(3)
    v_mfma_f32_16x16x32_bf16 v[28:31], v[88:91], v[136:139], v[28:31]
    s_barrier
    ds_read_b128 v[104:107], v19 offset:18432
    v_mfma_f32_16x16x32_bf16 v[48:51], v[88:91], v[140:143], v[48:51]
    ds_read_b128 v[164:167], v19 offset:36864
    s_waitcnt lgkmcnt(3)
    v_mfma_f32_16x16x32_bf16 v[32:35], v[92:95], v[136:139], v[32:35]
    ds_read_b128 v[108:111], v19 offset:20480
    s_add_u32 m0, s35, 32768
    v_mfma_f32_16x16x32_bf16 v[52:55], v[92:95], v[140:143], v[52:55]
    buffer_load_dwordx4 v8, s[12:15], s34 offen offset:0 lds
    v_mfma_f32_16x16x32_bf16 v[36:39], v[96:99], v[136:139], v[36:39]
    ds_read_b128 v[112:115], v19 offset:22528
    buffer_load_dwordx4 v9, s[12:15], s34 offen offset:1024 lds
    v_mfma_f32_16x16x32_bf16 v[56:59], v[96:99], v[140:143], v[56:59]
    buffer_load_dwordx4 v10, s[12:15], s34 offen offset:2048 lds
    v_mfma_f32_16x16x32_bf16 v[40:43], v[100:103], v[136:139], v[40:43]
    ds_read_b128 v[116:119], v19 offset:24576
    buffer_load_dwordx4 v11, s[12:15], s34 offen offset:3072 lds
    v_mfma_f32_16x16x32_bf16 v[60:63], v[100:103], v[140:143], v[60:63]
    s_add_u32 s34, s34, 128
    s_cmp_eq_u32 s34, 1152
    s_cselect_b32 s34, 0, s34
    v_mfma_f32_16x16x32_bf16 v[44:47], v[24:27], v[136:139], v[44:47]
    s_cmp_lt_u32 s68, 32
    s_cselect_b32 s64, s44, s46
    s_cselect_b32 s65, s45, s47
    v_mfma_f32_16x16x32_bf16 v[64:67], v[24:27], v[140:143], v[64:67]
    s_waitcnt lgkmcnt(3)
    s_and_b32 s73, s68, 31
    v_mfma_f32_16x16x32_bf16 v[184:187], v[160:163], v[24:27], v[184:187]
    s_lshl_b32 s73, s73, 7
    v_mfma_f32_16x16x32_bf16 v[188:191], v[160:163], v[160:163], v[188:191]
    s_add_u32 s73, s73, s71
    v_mfma_f32_16x16x32_bf16 v[68:71], v[160:163], v[164:167], v[68:71]
    ds_read_b128 v[168:171], v202 offset:38912
    s_add_u32 m0, s72, 147456
    v_mfma_f32_16x16x32_bf16 v[72:75], v[24:27], v[164:167], v[72:75]
    s_waitcnt lgkmcnt(3)
    buffer_load_dwordx4 v208, s[64:67], s73 offen offset:0 lds
    v_mfma_f32_16x16x32_bf16 v[28:31], v[104:107], v[144:147], v[28:31]
    ds_read_b128 v[88:91], v18 offset:28672
    buffer_load_dwordx4 v209, s[64:67], s73 offen offset:1024 lds
    v_mfma_f32_16x16x32_bf16 v[48:51], v[104:107], v[148:151], v[48:51]
    ds_read_b128 v[172:175], v18 offset:47104
    buffer_load_dwordx4 v210, s[64:67], s73 offen offset:2048 lds
    v_mfma_f32_16x16x32_bf16 v[32:35], v[108:111], v[144:147], v[32:35]
    ds_read_b128 v[92:95], v18 offset:30720
    buffer_load_dwordx4 v211, s[64:67], s73 offen offset:3072 lds
    v_mfma_f32_16x16x32_bf16 v[52:55], v[108:111], v[148:151], v[52:55]
    s_waitcnt lgkmcnt(4)
    s_add_u32 s68, s68, 1
    s_cmp_eq_u32 s68, s70
    s_cselect_b32 s68, s69, s68
    v_mfma_f32_16x16x32_bf16 v[36:39], v[112:115], v[144:147], v[36:39]
    ds_read_b128 v[96:99], v18 offset:32768
    s_waitcnt vmcnt(12)
    v_mfma_f32_16x16x32_bf16 v[56:59], v[112:115], v[148:151], v[56:59]
    ds_read_b128 v[120:123], v14 offset:0
    v_mfma_f32_16x16x32_bf16 v[40:43], v[116:119], v[144:147], v[40:43]
    ds_read_b128 v[100:103], v18 offset:34816
    ds_read_b128 v[124:127], v14 offset:2048
    v_mfma_f32_16x16x32_bf16 v[60:63], v[116:119], v[148:151], v[60:63]
    ds_read_b128 v[128:131], v15 offset:0
    v_mfma_f32_16x16x32_bf16 v[44:47], v[24:27], v[144:147], v[44:47]
    v_mfma_f32_16x16x32_bf16 v[64:67], v[24:27], v[148:151], v[64:67]
    s_waitcnt lgkmcnt(6)
    ds_read_b128 v[132:135], v15 offset:2048
    v_mfma_f32_16x16x32_bf16 v[184:187], v[168:171], v[24:27], v[184:187]
    v_mfma_f32_16x16x32_bf16 v[188:191], v[168:171], v[168:171], v[188:191]
    v_mfma_f32_16x16x32_bf16 v[68:71], v[168:171], v[172:175], v[68:71]
    ds_read_b128 v[176:179], v203 offset:38912
    v_mfma_f32_16x16x32_bf16 v[72:75], v[24:27], v[172:175], v[72:75]
    s_waitcnt lgkmcnt(3)
    v_mfma_f32_16x16x32_bf16 v[28:31], v[88:91], v[120:123], v[28:31]
    ds_read_b128 v[104:107], v19 offset:28672
    v_mfma_f32_16x16x32_bf16 v[48:51], v[88:91], v[124:127], v[48:51]
    ds_read_b128 v[180:183], v19 offset:47104
    v_mfma_f32_16x16x32_bf16 v[32:35], v[92:95], v[120:123], v[32:35]
    ds_read_b128 v[108:111], v19 offset:30720
    ds_read_b128 v[152:155], v202 offset:49152
    v_mfma_f32_16x16x32_bf16 v[52:55], v[92:95], v[124:127], v[52:55]
    s_cmp_lt_u32 s68, 32
    s_cselect_b32 s64, s44, s46
    s_cselect_b32 s65, s45, s47
    v_mfma_f32_16x16x32_bf16 v[36:39], v[96:99], v[120:123], v[36:39]
    ds_read_b128 v[112:115], v19 offset:32768
    s_and_b32 s73, s68, 31
    v_mfma_f32_16x16x32_bf16 v[56:59], v[96:99], v[124:127], v[56:59]
    ds_read_b128 v[156:159], v18 offset:57344
    s_lshl_b32 s73, s73, 7
    v_mfma_f32_16x16x32_bf16 v[40:43], v[100:103], v[120:123], v[40:43]
    ds_read_b128 v[116:119], v19 offset:34816
    v_mfma_f32_16x16x32_bf16 v[60:63], v[100:103], v[124:127], v[60:63]
    s_add_u32 s73, s73, s71
    v_mfma_f32_16x16x32_bf16 v[44:47], v[24:27], v[120:123], v[44:47]
    v_mfma_f32_16x16x32_bf16 v[64:67], v[24:27], v[124:127], v[64:67]
    s_waitcnt lgkmcnt(5)
    s_add_u32 m0, s72, 0
    v_mfma_f32_16x16x32_bf16 v[184:187], v[176:179], v[24:27], v[184:187]
    v_mfma_f32_16x16x32_bf16 v[188:191], v[176:179], v[176:179], v[188:191]
    v_mfma_f32_16x16x32_bf16 v[68:71], v[176:179], v[180:183], v[68:71]
    buffer_load_dwordx4 v208, s[64:67], s73 offen offset:0 lds
    v_mfma_f32_16x16x32_bf16 v[72:75], v[24:27], v[180:183], v[72:75]
    s_waitcnt lgkmcnt(1)
    v_mfma_f32_16x16x32_bf16 v[184:187], v[152:155], v[24:27], v[184:187]
    buffer_load_dwordx4 v209, s[64:67], s73 offen offset:1024 lds
    v_mfma_f32_16x16x32_bf16 v[188:191], v[152:155], v[152:155], v[188:191]
    v_mfma_f32_16x16x32_bf16 v[68:71], v[152:155], v[156:159], v[68:71]
    ds_read_b128 v[160:163], v203 offset:49152
    buffer_load_dwordx4 v210, s[64:67], s73 offen offset:2048 lds
    v_mfma_f32_16x16x32_bf16 v[72:75], v[24:27], v[156:159], v[72:75]
    v_mfma_f32_16x16x32_bf16 v[28:31], v[104:107], v[128:131], v[28:31]
    ds_read_b128 v[88:91], v18 offset:38912
    buffer_load_dwordx4 v211, s[64:67], s73 offen offset:3072 lds
    v_mfma_f32_16x16x32_bf16 v[48:51], v[104:107], v[132:135], v[48:51]
    ds_read_b128 v[164:167], v19 offset:57344
    v_mfma_f32_16x16x32_bf16 v[32:35], v[108:111], v[128:131], v[32:35]
    ds_read_b128 v[92:95], v18 offset:40960
    v_mfma_f32_16x16x32_bf16 v[52:55], v[108:111], v[132:135], v[52:55]
    s_waitcnt lgkmcnt(4)
    s_add_u32 s68, s68, 1
    s_cmp_eq_u32 s68, s70
    s_cselect_b32 s68, s69, s68
    v_mfma_f32_16x16x32_bf16 v[36:39], v[112:115], v[128:131], v[36:39]
    ds_read_b128 v[96:99], v18 offset:43008
    s_waitcnt vmcnt(12)
    v_mfma_f32_16x16x32_bf16 v[56:59], v[112:115], v[132:135], v[56:59]
    ds_read_b128 v[136:139], v14 offset:16384
    v_mfma_f32_16x16x32_bf16 v[40:43], v[116:119], v[128:131], v[40:43]
    ds_read_b128 v[100:103], v18 offset:45056
    ds_read_b128 v[140:143], v14 offset:18432
    v_mfma_f32_16x16x32_bf16 v[60:63], v[116:119], v[132:135], v[60:63]
    ds_read_b128 v[144:147], v15 offset:16384
    v_mfma_f32_16x16x32_bf16 v[44:47], v[24:27], v[128:131], v[44:47]
    v_mfma_f32_16x16x32_bf16 v[64:67], v[24:27], v[132:135], v[64:67]
    s_waitcnt lgkmcnt(6)
    ds_read_b128 v[148:151], v15 offset:18432
    v_mfma_f32_16x16x32_bf16 v[184:187], v[160:163], v[24:27], v[184:187]
    v_mfma_f32_16x16x32_bf16 v[188:191], v[160:163], v[160:163], v[188:191]
    v_mfma_f32_16x16x32_bf16 v[68:71], v[160:163], v[164:167], v[68:71]
    v_mfma_f32_16x16x32_bf16 v[72:75], v[24:27], v[164:167], v[72:75]
    s_waitcnt lgkmcnt(2)
    v_mfma_f32_16x16x32_bf16 v[28:31], v[88:91], v[136:139], v[28:31]
    ds_read_b128 v[104:107], v19 offset:38912
    v_mfma_f32_16x16x32_bf16 v[48:51], v[88:91], v[140:143], v[48:51]
    v_mfma_f32_16x16x32_bf16 v[32:35], v[92:95], v[136:139], v[32:35]
    ds_read_b128 v[108:111], v19 offset:40960
    v_mfma_f32_16x16x32_bf16 v[52:55], v[92:95], v[140:143], v[52:55]
    v_mfma_f32_16x16x32_bf16 v[36:39], v[96:99], v[136:139], v[36:39]
    ds_read_b128 v[112:115], v19 offset:43008
    v_mfma_f32_16x16x32_bf16 v[56:59], v[96:99], v[140:143], v[56:59]
    v_mfma_f32_16x16x32_bf16 v[40:43], v[100:103], v[136:139], v[40:43]
    ds_read_b128 v[116:119], v19 offset:45056
    v_cndmask_b32 v192, v184, v185, s[20:21]
    v_mfma_f32_16x16x32_bf16 v[60:63], v[100:103], v[140:143], v[60:63]
    v_cndmask_b32 v192, v192, v186, s[22:23]
    v_mfma_f32_16x16x32_bf16 v[44:47], v[24:27], v[136:139], v[44:47]
    s_waitcnt vmcnt(8)
    v_cndmask_b32 v192, v192, v187, s[62:63]
    v_mfma_f32_16x16x32_bf16 v[64:67], v[24:27], v[140:143], v[64:67]
    s_waitcnt lgkmcnt(2)
    ds_read_b128 v[120:123], v14 offset:32768
    v_cndmask_b32 v194, v188, v189, s[20:21]
    v_mfma_f32_16x16x32_bf16 v[28:31], v[104:107], v[144:147], v[28:31]
    ds_read_b128 v[88:91], v18 offset:49152
    v_cndmask_b32 v194, v194, v190, s[22:23]
    v_mfma_f32_16x16x32_bf16 v[48:51], v[104:107], v[148:151], v[48:51]
    ds_read_b128 v[124:127], v14 offset:34816
    v_cndmask_b32 v194, v194, v191, s[62:63]
    v_mfma_f32_16x16x32_bf16 v[32:35], v[108:111], v[144:147], v[32:35]
    ds_read_b128 v[92:95], v18 offset:51200
    v_mul_f32 v192, 0x3ae38e39, v192
    v_mfma_f32_16x16x32_bf16 v[52:55], v[108:111], v[148:151], v[52:55]
    s_waitcnt lgkmcnt(4)
    ds_read_b128 v[128:131], v15 offset:32768
    v_mul_f32 v194, 0x3ae38e39, v194
    v_mfma_f32_16x16x32_bf16 v[36:39], v[112:115], v[144:147], v[36:39]
    ds_read_b128 v[96:99], v18 offset:53248
    v_fma_f32 v194, -v192, v192, v194
    v_mfma_f32_16x16x32_bf16 v[56:59], v[112:115], v[148:151], v[56:59]
    ds_read_b128 v[132:135], v15 offset:34816
    v_max_f32 v194, 0, v194
    v_mfma_f32_16x16x32_bf16 v[40:43], v[116:119], v[144:147], v[40:43]
    ds_read_b128 v[100:103], v18 offset:55296
    v_cvt_pk_bf16_f32 v192, v192, v192
    v_mfma_f32_16x16x32_bf16 v[60:63], v[116:119], v[148:151], v[60:63]
    buffer_load_dword v218, v220, s[48:51], 0 offen sc1
    v_lshlrev_b32 v192, 16, v192
    v_mfma_f32_16x16x32_bf16 v[44:47], v[24:27], v[144:147], v[44:47]
    v_cvt_pk_bf16_f32 v194, v194, v194
    v_mfma_f32_16x16x32_bf16 v[64:67], v[24:27], v[148:151], v[64:67]
    s_waitcnt lgkmcnt(4)
    v_lshlrev_b32 v194, 16, v194
    v_mfma_f32_16x16x32_bf16 v[28:31], v[88:91], v[120:123], v[28:31]
    ds_read_b128 v[104:107], v19 offset:49152
    v_add_f32 v194, 0x3727c5ac, v194
    v_mfma_f32_16x16x32_bf16 v[48:51], v[88:91], v[124:127], v[48:51]
    v_cvt_pk_bf16_f32 v194, v194, v194
    v_mfma_f32_16x16x32_bf16 v[32:35], v[92:95], v[120:123], v[32:35]
    ds_read_b128 v[108:111], v19 offset:51200
    v_lshlrev_b32 v194, 16, v194
    v_mfma_f32_16x16x32_bf16 v[52:55], v[92:95], v[124:127], v[52:55]
    s_waitcnt lgkmcnt(2)
    v_sqrt_f32 v194, v194
    v_mfma_f32_16x16x32_bf16 v[36:39], v[96:99], v[120:123], v[36:39]
    ds_read_b128 v[112:115], v19 offset:53248
    v_cvt_pk_bf16_f32 v194, v194, v194
    v_mfma_f32_16x16x32_bf16 v[56:59], v[96:99], v[124:127], v[56:59]
    v_lshlrev_b32 v194, 16, v194
    v_mfma_f32_16x16x32_bf16 v[40:43], v[100:103], v[120:123], v[40:43]
    ds_read_b128 v[116:119], v19 offset:55296
    v_rcp_f32 v194, v194
    v_mfma_f32_16x16x32_bf16 v[60:63], v[100:103], v[124:127], v[60:63]
    v_mul_f32 v193, s41, v194
    v_mfma_f32_16x16x32_bf16 v[44:47], v[24:27], v[120:123], v[44:47]
    ds_write_b64 v204, v[192:193]
    v_mfma_f32_16x16x32_bf16 v[64:67], v[24:27], v[124:127], v[64:67]
    s_waitcnt lgkmcnt(3)
    v_mfma_f32_16x16x32_bf16 v[28:31], v[104:107], v[128:131], v[28:31]
    v_mfma_f32_16x16x32_bf16 v[48:51], v[104:107], v[132:135], v[48:51]
    v_mfma_f32_16x16x32_bf16 v[32:35], v[108:111], v[128:131], v[32:35]
    s_waitcnt lgkmcnt(0)
    s_barrier
    v_mfma_f32_16x16x32_bf16 v[52:55], v[108:111], v[132:135], v[52:55]
    v_mfma_f32_16x16x32_bf16 v[36:39], v[112:115], v[128:131], v[36:39]
    v_mfma_f32_16x16x32_bf16 v[56:59], v[112:115], v[132:135], v[56:59]
    v_mfma_f32_16x16x32_bf16 v[40:43], v[116:119], v[128:131], v[40:43]
    v_mfma_f32_16x16x32_bf16 v[60:63], v[116:119], v[132:135], v[60:63]
    v_mfma_f32_16x16x32_bf16 v[44:47], v[24:27], v[128:131], v[44:47]
    v_mfma_f32_16x16x32_bf16 v[64:67], v[24:27], v[132:135], v[64:67]
    ds_read_b128 v[224:227], v23 offset:0
    ds_read_b128 v[228:231], v23 offset:16
    ds_read_b128 v[232:235], v23 offset:128
    ds_read_b128 v[236:239], v23 offset:144
    ds_read_b128 v[240:243], v23 offset:256
    ds_read_b128 v[244:247], v23 offset:272
    ds_read_b128 v[248:251], v23 offset:384
    ds_read_b128 v[252:255], v23 offset:400
    ds_read_b128 v[76:79], v3 offset:0
    ds_read_b128 v[80:83], v3 offset:16
    s_waitcnt lgkmcnt(0)
    v_fma_f32 v28, -v224, v44, v28
    v_fma_f32 v29, -v226, v44, v29
    v_fma_f32 v30, -v228, v44, v30
    v_fma_f32 v31, -v230, v44, v31
    v_mul_f32 v28, v225, v28
    v_mul_f32 v29, v227, v29
    v_mul_f32 v30, v229, v30
    v_mul_f32 v31, v231, v31
    v_cvt_pk_bf16_f32 v88, v28, v29
    v_cvt_pk_bf16_f32 v89, v30, v31
    v_fma_f32 v32, -v232, v44, v32
    v_fma_f32 v33, -v234, v44, v33
    v_fma_f32 v34, -v236, v44, v34
    v_fma_f32 v35, -v238, v44, v35
    v_mul_f32 v32, v233, v32
    v_mul_f32 v33, v235, v33
    v_mul_f32 v34, v237, v34
    v_mul_f32 v35, v239, v35
    v_cvt_pk_bf16_f32 v90, v32, v33
    v_cvt_pk_bf16_f32 v91, v34, v35
    buffer_store_dwordx4 v[88:91], v2, s[16:19], s40 offen offset:0 sc1
    v_fma_f32 v36, -v240, v44, v36
    v_fma_f32 v37, -v242, v44, v37
    v_fma_f32 v38, -v244, v44, v38
    v_fma_f32 v39, -v246, v44, v39
    v_mul_f32 v36, v241, v36
    v_mul_f32 v37, v243, v37
    v_mul_f32 v38, v245, v38
    v_mul_f32 v39, v247, v39
    v_cvt_pk_bf16_f32 v92, v36, v37
    v_cvt_pk_bf16_f32 v93, v38, v39
    v_fma_f32 v40, -v248, v44, v40
    v_fma_f32 v41, -v250, v44, v41
    v_fma_f32 v42, -v252, v44, v42
    v_fma_f32 v43, -v254, v44, v43
    v_mul_f32 v40, v249, v40
    v_mul_f32 v41, v251, v41
    v_mul_f32 v42, v253, v42
    v_mul_f32 v43, v255, v43
    v_cvt_pk_bf16_f32 v94, v40, v41
    v_cvt_pk_bf16_f32 v95, v42, v43
    buffer_store_dwordx4 v[92:95], v2, s[16:19], s42 offen offset:0 sc1
    v_fma_f32 v48, -v224, v64, v48
    v_fma_f32 v49, -v226, v64, v49
    v_fma_f32 v50, -v228, v64, v50
    v_fma_f32 v51, -v230, v64, v51
    v_mul_f32 v48, v225, v48
    v_mul_f32 v49, v227, v49
    v_mul_f32 v50, v229, v50
    v_mul_f32 v51, v231, v51
    v_cvt_pk_bf16_f32 v96, v48, v49
    v_cvt_pk_bf16_f32 v97, v50, v51
    v_fma_f32 v52, -v232, v64, v52
    v_fma_f32 v53, -v234, v64, v53
    v_fma_f32 v54, -v236, v64, v54
    v_fma_f32 v55, -v238, v64, v55
    v_mul_f32 v52, v233, v52
    v_mul_f32 v53, v235, v53
    v_mul_f32 v54, v237, v54
    v_mul_f32 v55, v239, v55
    v_cvt_pk_bf16_f32 v98, v52, v53
    v_cvt_pk_bf16_f32 v99, v54, v55
    buffer_store_dwordx4 v[96:99], v2, s[16:19], s40 offen offset:1024 sc1
    v_fma_f32 v56, -v240, v64, v56
    v_fma_f32 v57, -v242, v64, v57
    v_fma_f32 v58, -v244, v64, v58
    v_fma_f32 v59, -v246, v64, v59
    v_mul_f32 v56, v241, v56
    v_mul_f32 v57, v243, v57
    v_mul_f32 v58, v245, v58
    v_mul_f32 v59, v247, v59
    v_cvt_pk_bf16_f32 v100, v56, v57
    v_cvt_pk_bf16_f32 v101, v58, v59
    v_fma_f32 v60, -v248, v64, v60
    v_fma_f32 v61, -v250, v64, v61
    v_fma_f32 v62, -v252, v64, v62
    v_fma_f32 v63, -v254, v64, v63
    v_mul_f32 v60, v249, v60
    v_mul_f32 v61, v251, v61
    v_mul_f32 v62, v253, v62
    v_mul_f32 v63, v255, v63
    v_cvt_pk_bf16_f32 v102, v60, v61
    v_cvt_pk_bf16_f32 v103, v62, v63
    buffer_store_dwordx4 v[100:103], v2, s[16:19], s42 offen offset:1024 sc1
    v_fma_f32 v68, -v76, v72, v68
    v_fma_f32 v69, -v78, v72, v69
    v_fma_f32 v70, -v80, v72, v70
    v_fma_f32 v71, -v82, v72, v71
    v_mul_f32 v68, v77, v68
    v_mul_f32 v69, v79, v69
    v_mul_f32 v70, v81, v70
    v_mul_f32 v71, v83, v71
    v_cvt_pk_bf16_f32 v68, v68, v69
    v_cvt_pk_bf16_f32 v69, v70, v71
    buffer_store_dwordx2 v[68:69], v2, s[16:19], s43 offen sc1
    s_barrier
    s_and_b32 s27, s2, 7
    s_lshr_b32 s28, s2, 3
    s_mul_i32 s29, s28, 43
    s_lshr_b32 s29, s29, 7
    s_mul_i32 s30, s29, 3
    s_sub_u32 s26, s28, s30
    s_mul_i32 s27, s27, 10
    s_add_u32 s27, s27, s29
    s_lshr_b32 s24, s27, 4
    s_and_b32 s25, s27, 15
    s_mul_i32 s33, s24, 13
    s_add_u32 s32, s33, 13
    s_mul_i32 s60, s26, 4
    s_add_u32 s60, s60, s33
    s_mul_i32 s38, s60, 73728
    s_mul_i32 s62, s33, 73728
    s_mul_i32 s63, s32, 73728
    s_mov_b32 s39, 36864
    s_mul_i32 s31, s26, 12
    s_mul_i32 s30, s3, 3
    s_add_u32 s31, s31, s30
    s_lshl_b32 s31, s31, 10
    v_lshlrev_b32 v8, 4, v1
    v_add_u32 v8, s31, v8
    v_mov_b32 v10, v20
    v_xor_b32 v11, 64, v10
    v_add_u32 v12, 0x10000, v10
    v_add_u32 v13, 0x10000, v11
    v_add_u32 v14, 0x20000, v10
    v_add_u32 v15, 0x20000, v11
    v_and_b32 v3, 1, v1
    v_lshlrev_b32 v3, 1, v3
    s_mul_i32 s30, s26, 12
    s_mul_i32 s31, s3, 3
    s_add_u32 s30, s30, s31
    v_add_u32 v3, s30, v3
    v_mul_u32_u24 v3, 57, v3
    v_lshrrev_b32 v3, 9, v3
    v_add_u32 v3, 0x400, v3
    v_lshrrev_b32 v177, 1, v1
    v_add_u32 v2, s33, v177
    s_add_u32 s30, s33, 12
    s_min_u32 s30, s30, 63
    v_min_u32 v2, s30, v2
    v_lshl_add_u32 v9, v2, 2, v3
    v_lshlrev_b32 v9, 7, v9
    v_min_u32 v177, 2, v177
    v_add_u32 v177, s60, v177
    v_min_u32 v177, s30, v177
    v_lshl_add_u32 v176, v177, 2, v3
    v_lshlrev_b32 v176, 7, v176
    s_mov_b32 s12, s16
    s_mov_b32 s13, s17
    s_mov_b32 s14, s18
    s_mov_b32 s15, 0x00020000
    s_add_u32 s16, s6, 0x500000
    s_addc_u32 s17, s7, 0
    s_and_b32 s17, s17, 0xffff
    s_mov_b32 s18, 0xb40000
    s_mov_b32 s19, 0x00020000
    s_lshl_b32 s40, s24, 6
    s_lshl_b32 s41, s25, 2
    s_add_u32 s40, s40, s41
    s_mul_i32 s40, s40, 36864
    s_add_u32 s41, s40, 36864
    s_add_u32 s42, s40, 73728
    s_add_u32 s43, s40, 110592
    s_waitcnt vmcnt(0)
    s_mov_b32 s30, 0
fnet_glu_kernel_np_3:
    v_readfirstlane_b32 s92, v218
    s_cmp_lg_u32 s92, 0
    s_cbranch_scc1 fnet_glu_kernel_nok_4
    s_add_u32 s30, s30, 1
    s_cmp_gt_u32 s30, 0x40000
    s_cbranch_scc1 fnet_glu_kernel_nok_4
    buffer_load_dword v218, v220, s[48:51], 0 offen sc1
    s_waitcnt vmcnt(0)
    s_branch fnet_glu_kernel_np_3
fnet_glu_kernel_nok_4:
    s_barrier
    v_mov_b32 v2, s92
    buffer_store_dword v2, v223, s[52:55], s61 offen sc1
    s_mov_b32 s61, 0x40000000
    s_cmp_ge_u32 s2, 240
    s_cbranch_scc1 fnet_glu_kernel_skip2_5
    s_lshl_b32 s61, s25, 4
    s_mul_i32 s30, s24, 3
    s_add_u32 s61, s61, s30
    s_add_u32 s61, s61, s26
    s_lshl_b32 s61, s61, 7
    s_add_u32 s61, s61, 98304
    s_cmp_lt_u32 s68, 32
    s_cselect_b32 s64, s44, s46
    s_cselect_b32 s65, s45, s47
    s_and_b32 s73, s68, 31
    s_lshl_b32 s73, s73, 7
    s_add_u32 s73, s73, s71
    s_add_u32 m0, s72, 16384
    s_nop 0
    buffer_load_dwordx4 v208, s[64:67], s73 offen offset:0 lds
    buffer_load_dwordx4 v209, s[64:67], s73 offen offset:1024 lds
    buffer_load_dwordx4 v210, s[64:67], s73 offen offset:2048 lds
    buffer_load_dwordx4 v211, s[64:67], s73 offen offset:3072 lds
    s_add_u32 s68, s68, 1
    s_cmp_eq_u32 s68, s70
    s_cselect_b32 s68, s69, s68
    s_cmp_lt_u32 s68, 32
    s_cselect_b32 s64, s44, s46
    s_cselect_b32 s65, s45, s47
    s_and_b32 s73, s68, 31
    s_lshl_b32 s73, s73, 7
    s_add_u32 s73, s73, s71
    s_add_u32 m0, s72, 32768
    s_nop 0
    buffer_load_dwordx4 v208, s[64:67], s73 offen offset:0 lds
    buffer_load_dwordx4 v209, s[64:67], s73 offen offset:1024 lds
    buffer_load_dwordx4 v210, s[64:67], s73 offen offset:2048 lds
    buffer_load_dwordx4 v211, s[64:67], s73 offen offset:3072 lds
    s_add_u32 s68, s68, 1
    s_cmp_eq_u32 s68, s70
    s_cselect_b32 s68, s69, s68
    buffer_load_dword v2, v176, s[52:55], 0 offen sc1
    s_waitcnt vmcnt(0)
    s_mov_b32 s30, 0
fnet_glu_kernel_poll_6:
    v_cmp_eq_u32 vcc, s92, v2
    s_cmp_eq_u64 vcc, -1
    s_cbranch_scc1 fnet_glu_kernel_pok_7
    s_add_u32 s30, s30, 1
    s_cmp_gt_u32 s30, 0x40000
    s_cbranch_scc1 fnet_glu_kernel_pok_7
    buffer_load_dword v2, v176, s[52:55], 0 offen sc1
    s_waitcnt vmcnt(0)
    s_branch fnet_glu_kernel_poll_6
fnet_glu_kernel_pok_7:
    buffer_load_dwordx4 a[0:3], v8, s[12:15], s38 offen offset:0 sc1
    buffer_load_dwordx4 a[4:7], v8, s[12:15], s38 offen offset:1024 sc1
    buffer_load_dwordx4 a[8:11], v8, s[12:15], s38 offen offset:2048 sc1
    s_add_u32 s38, s38, s39
    buffer_load_dwordx4 a[12:15], v8, s[12:15], s38 offen offset:0 sc1
    buffer_load_dwordx4 a[16:19], v8, s[12:15], s38 offen offset:1024 sc1
    buffer_load_dwordx4 a[20:23], v8, s[12:15], s38 offen offset:2048 sc1
    s_add_u32 s38, s38, s39
    s_cmp_eq_u32 s38, s63
    s_cselect_b32 s38, s62, s38
    buffer_load_dwordx4 a[24:27], v8, s[12:15], s38 offen offset:0 sc1
    buffer_load_dwordx4 a[28:31], v8, s[12:15], s38 offen offset:1024 sc1
    buffer_load_dwordx4 a[32:35], v8, s[12:15], s38 offen offset:2048 sc1
    s_add_u32 s38, s38, s39
    buffer_load_dwordx4 a[36:39], v8, s[12:15], s38 offen offset:0 sc1
    buffer_load_dwordx4 a[40:43], v8, s[12:15], s38 offen offset:1024 sc1
    buffer_load_dwordx4 a[44:47], v8, s[12:15], s38 offen offset:2048 sc1
    s_add_u32 s38, s38, s39
    s_cmp_eq_u32 s38, s63
    s_cselect_b32 s38, s62, s38
    buffer_load_dword v2, v9, s[52:55], 0 offen sc1
    s_barrier
    ds_read_b128 v[112:115], v14 offset:16384
    ds_read_b128 v[116:119], v14 offset:18432
    ds_read_b128 v[120:123], v14 offset:20480
    ds_read_b128 v[124:127], v14 offset:22528
    ds_read_b128 v[128:131], v14 offset:24576
    ds_read_b128 v[132:135], v14 offset:26624
    ds_read_b128 v[136:139], v14 offset:28672
    ds_read_b128 v[140:143], v14 offset:30720
    s_waitcnt vmcnt(10) lgkmcnt(7)
    v_mfma_f32_16x16x32_bf16 v[16:19], a[0:3], v[112:115], 0
    ds_read_b128 v[144:147], v15 offset:16384
    v_mfma_f32_16x16x32_bf16 v[48:51], a[4:7], v[112:115], 0
    buffer_load_dwordx4 a[48:51], v8, s[12:15], s38 offen offset:0 sc1
    v_mfma_f32_16x16x32_bf16 v[80:83], a[8:11], v[112:115], 0
    s_waitcnt lgkmcnt(7)
    ds_read_b128 v[148:151], v15 offset:18432
    v_mfma_f32_16x16x32_bf16 v[20:23], a[0:3], v[116:119], 0
    v_mfma_f32_16x16x32_bf16 v[52:55], a[4:7], v[116:119], 0
    ds_read_b128 v[152:155], v15 offset:20480
    v_mfma_f32_16x16x32_bf16 v[84:87], a[8:11], v[116:119], 0
    s_waitcnt lgkmcnt(8)
    buffer_load_dwordx4 a[52:55], v8, s[12:15], s38 offen offset:1024 sc1
    v_mfma_f32_16x16x32_bf16 v[24:27], a[0:3], v[120:123], 0
    ds_read_b128 v[156:159], v15 offset:22528
    v_mfma_f32_16x16x32_bf16 v[56:59], a[4:7], v[120:123], 0
    s_cmp_lt_u32 s68, 32
    s_cselect_b32 s64, s44, s46
    s_cselect_b32 s65, s45, s47
    v_mfma_f32_16x16x32_bf16 v[88:91], a[8:11], v[120:123], 0
    s_waitcnt lgkmcnt(8)
    s_and_b32 s73, s68, 31
    s_lshl_b32 s73, s73, 7
    v_mfma_f32_16x16x32_bf16 v[28:31], a[0:3], v[124:127], 0
    ds_read_b128 v[160:163], v15 offset:24576
    v_mfma_f32_16x16x32_bf16 v[60:63], a[4:7], v[124:127], 0
    s_add_u32 s73, s73, s71
    buffer_load_dwordx4 a[56:59], v8, s[12:15], s38 offen offset:2048 sc1
    v_mfma_f32_16x16x32_bf16 v[92:95], a[8:11], v[124:127], 0
    s_waitcnt lgkmcnt(8)
    ds_read_b128 v[164:167], v15 offset:26624
    v_mfma_f32_16x16x32_bf16 v[32:35], a[0:3], v[128:131], 0
    v_mfma_f32_16x16x32_bf16 v[64:67], a[4:7], v[128:131], 0
    ds_read_b128 v[168:171], v15 offset:28672
    s_add_u32 m0, s72, 49152
    v_mfma_f32_16x16x32_bf16 v[96:99], a[8:11], v[128:131], 0
    s_waitcnt lgkmcnt(9)
    v_mfma_f32_16x16x32_bf16 v[36:39], a[0:3], v[132:135], 0
    ds_read_b128 v[172:175], v15 offset:30720
    s_add_u32 s38, s38, s39
    v_mfma_f32_16x16x32_bf16 v[68:71], a[4:7], v[132:135], 0
    buffer_load_dwordx4 v208, s[64:67], s73 offen offset:0 lds
    v_mfma_f32_16x16x32_bf16 v[100:103], a[8:11], v[132:135], 0
    s_waitcnt lgkmcnt(9)
    buffer_load_dwordx4 v209, s[64:67], s73 offen offset:1024 lds
    v_mfma_f32_16x16x32_bf16 v[40:43], a[0:3], v[136:139], 0
    v_mfma_f32_16x16x32_bf16 v[72:75], a[4:7], v[136:139], 0
    v_mfma_f32_16x16x32_bf16 v[104:107], a[8:11], v[136:139], 0
    s_waitcnt lgkmcnt(8)
    buffer_load_dwordx4 v210, s[64:67], s73 offen offset:2048 lds
    v_mfma_f32_16x16x32_bf16 v[44:47], a[0:3], v[140:143], 0
    v_mfma_f32_16x16x32_bf16 v[76:79], a[4:7], v[140:143], 0
    buffer_load_dwordx4 v211, s[64:67], s73 offen offset:3072 lds
    v_mfma_f32_16x16x32_bf16 v[108:111], a[8:11], v[140:143], 0
    s_waitcnt vmcnt(14) lgkmcnt(7)
    v_mfma_f32_16x16x32_bf16 v[16:19], a[12:15], v[144:147], v[16:19]
    ds_read_b128 v[112:115], v10 offset:0
    v_mfma_f32_16x16x32_bf16 v[48:51], a[16:19], v[144:147], v[48:51]
    s_add_u32 s68, s68, 1
    s_cmp_eq_u32 s68, s70
    s_cselect_b32 s68, s69, s68
    v_mfma_f32_16x16x32_bf16 v[80:83], a[20:23], v[144:147], v[80:83]
    s_waitcnt lgkmcnt(7)
    ds_read_b128 v[116:119], v10 offset:2048
    v_mfma_f32_16x16x32_bf16 v[20:23], a[12:15], v[148:151], v[20:23]
    buffer_load_dwordx4 a[60:63], v8, s[12:15], s38 offen offset:0 sc1
    v_mfma_f32_16x16x32_bf16 v[52:55], a[16:19], v[148:151], v[52:55]
    ds_read_b128 v[120:123], v10 offset:4096
    v_mfma_f32_16x16x32_bf16 v[84:87], a[20:23], v[148:151], v[84:87]
    s_waitcnt lgkmcnt(8)
    buffer_load_dwordx4 a[64:67], v8, s[12:15], s38 offen offset:1024 sc1
    v_mfma_f32_16x16x32_bf16 v[24:27], a[12:15], v[152:155], v[24:27]
    ds_read_b128 v[124:127], v10 offset:6144
    v_mfma_f32_16x16x32_bf16 v[56:59], a[16:19], v[152:155], v[56:59]
    v_mfma_f32_16x16x32_bf16 v[88:91], a[20:23], v[152:155], v[88:91]
    s_waitcnt lgkmcnt(8)
    v_mfma_f32_16x16x32_bf16 v[28:31], a[12:15], v[156:159], v[28:31]
    ds_read_b128 v[128:131], v10 offset:8192
    v_mfma_f32_16x16x32_bf16 v[60:63], a[16:19], v[156:159], v[60:63]
    buffer_load_dwordx4 a[68:71], v8, s[12:15], s38 offen offset:2048 sc1
    v_mfma_f32_16x16x32_bf16 v[92:95], a[20:23], v[156:159], v[92:95]
    s_waitcnt lgkmcnt(8)
    ds_read_b128 v[132:135], v10 offset:10240
    v_mfma_f32_16x16x32_bf16 v[32:35], a[12:15], v[160:163], v[32:35]
    v_mfma_f32_16x16x32_bf16 v[64:67], a[16:19], v[160:163], v[64:67]
    ds_read_b128 v[136:139], v10 offset:12288
    v_mfma_f32_16x16x32_bf16 v[96:99], a[20:23], v[160:163], v[96:99]
    s_waitcnt lgkmcnt(9)
    v_mfma_f32_16x16x32_bf16 v[36:39], a[12:15], v[164:167], v[36:39]
    ds_read_b128 v[140:143], v10 offset:14336
    v_mfma_f32_16x16x32_bf16 v[68:71], a[16:19], v[164:167], v[68:71]
    s_cmp_lt_u32 s68, 32
    s_cselect_b32 s64, s44, s46
    s_cselect_b32 s65, s45, s47
    v_mfma_f32_16x16x32_bf16 v[100:103], a[20:23], v[164:167], v[100:103]
    s_waitcnt lgkmcnt(9)
    v_mfma_f32_16x16x32_bf16 v[40:43], a[12:15], v[168:171], v[40:43]
    s_and_b32 s73, s68, 31
    v_mfma_f32_16x16x32_bf16 v[72:75], a[16:19], v[168:171], v[72:75]
    s_add_u32 s38, s38, s39
    s_cmp_eq_u32 s38, s63
    s_cselect_b32 s38, s62, s38
    v_mfma_f32_16x16x32_bf16 v[104:107], a[20:23], v[168:171], v[104:107]
    s_waitcnt lgkmcnt(8)
    s_lshl_b32 s73, s73, 7
    v_mfma_f32_16x16x32_bf16 v[44:47], a[12:15], v[172:175], v[44:47]
    v_mfma_f32_16x16x32_bf16 v[76:79], a[16:19], v[172:175], v[76:79]
    s_add_u32 s73, s73, s71
    v_mfma_f32_16x16x32_bf16 v[108:111], a[20:23], v[172:175], v[108:111]
    s_waitcnt vmcnt(14) lgkmcnt(7)
    v_mfma_f32_16x16x32_bf16 v[16:19], a[24:27], v[112:115], v[16:19]
    ds_read_b128 v[144:147], v11 offset:0
    v_mfma_f32_16x16x32_bf16 v[48:51], a[28:31], v[112:115], v[48:51]
    s_add_u32 m0, s72, 65536
    v_mfma_f32_16x16x32_bf16 v[80:83], a[32:35], v[112:115], v[80:83]
    s_waitcnt lgkmcnt(7)
    ds_read_b128 v[148:151], v11 offset:2048
    v_mfma_f32_16x16x32_bf16 v[20:23], a[24:27], v[116:119], v[20:23]
    buffer_load_dwordx4 v208, s[64:67], s73 offen offset:0 lds
    v_mfma_f32_16x16x32_bf16 v[52:55], a[28:31], v[116:119], v[52:55]
    ds_read_b128 v[152:155], v11 offset:4096
    v_mfma_f32_16x16x32_bf16 v[84:87], a[32:35], v[116:119], v[84:87]
    s_waitcnt lgkmcnt(8)
    buffer_load_dwordx4 v209, s[64:67], s73 offen offset:1024 lds
    v_mfma_f32_16x16x32_bf16 v[24:27], a[24:27], v[120:123], v[24:27]
    ds_read_b128 v[156:159], v11 offset:6144
    v_mfma_f32_16x16x32_bf16 v[56:59], a[28:31], v[120:123], v[56:59]
    s_waitcnt vmcnt(12)
    s_mov_b32 s30, 0
fnet_glu_kernel_poll_8:
    v_cmp_eq_u32 vcc, s92, v2
    s_cmp_eq_u64 vcc, -1
    s_cbranch_scc1 fnet_glu_kernel_pok_9
    s_add_u32 s30, s30, 1
    s_cmp_gt_u32 s30, 0x40000
    s_cbranch_scc1 fnet_glu_kernel_pok_9
    buffer_load_dword v2, v9, s[52:55], 0 offen sc1
    s_waitcnt vmcnt(0)
    s_branch fnet_glu_kernel_poll_8
fnet_glu_kernel_pok_9:
    v_mfma_f32_16x16x32_bf16 v[88:91], a[32:35], v[120:123], v[88:91]
    s_waitcnt lgkmcnt(8)
    buffer_load_dwordx4 v210, s[64:67], s73 offen offset:2048 lds
    v_mfma_f32_16x16x32_bf16 v[28:31], a[24:27], v[124:127], v[28:31]
    ds_read_b128 v[160:163], v11 offset:8192
    v_mfma_f32_16x16x32_bf16 v[60:63], a[28:31], v[124:127], v[60:63]
    buffer_load_dwordx4 v211, s[64:67], s73 offen offset:3072 lds
    v_mfma_f32_16x16x32_bf16 v[92:95], a[32:35], v[124:127], v[92:95]
    s_waitcnt lgkmcnt(8)
    ds_read_b128 v[164:167], v11 offset:10240
    v_mfma_f32_16x16x32_bf16 v[32:35], a[24:27], v[128:131], v[32:35]
    s_add_u32 s68, s68, 1
    s_cmp_eq_u32 s68, s70
    s_cselect_b32 s68, s69, s68
    v_mfma_f32_16x16x32_bf16 v[64:67], a[28:31], v[128:131], v[64:67]
    ds_read_b128 v[168:171], v11 offset:12288
    v_mfma_f32_16x16x32_bf16 v[96:99], a[32:35], v[128:131], v[96:99]
    s_waitcnt lgkmcnt(9)
    buffer_load_dwordx4 a[72:75], v8, s[12:15], s38 offen offset:0 sc1
    v_mfma_f32_16x16x32_bf16 v[36:39], a[24:27], v[132:135], v[36:39]
    ds_read_b128 v[172:175], v11 offset:14336
    v_mfma_f32_16x16x32_bf16 v[68:71], a[28:31], v[132:135], v[68:71]
    buffer_load_dwordx4 a[76:79], v8, s[12:15], s38 offen offset:1024 sc1
    v_mfma_f32_16x16x32_bf16 v[100:103], a[32:35], v[132:135], v[100:103]
    s_waitcnt lgkmcnt(9)
    buffer_load_dwordx4 a[80:83], v8, s[12:15], s38 offen offset:2048 sc1
    v_mfma_f32_16x16x32_bf16 v[40:43], a[24:27], v[136:139], v[40:43]
    s_add_u32 s38, s38, s39
    v_mfma_f32_16x16x32_bf16 v[72:75], a[28:31], v[136:139], v[72:75]
    v_mfma_f32_16x16x32_bf16 v[104:107], a[32:35], v[136:139], v[104:107]
    s_waitcnt lgkmcnt(8)
    v_mfma_f32_16x16x32_bf16 v[44:47], a[24:27], v[140:143], v[44:47]
    v_mfma_f32_16x16x32_bf16 v[76:79], a[28:31], v[140:143], v[76:79]
    v_mfma_f32_16x16x32_bf16 v[108:111], a[32:35], v[140:143], v[108:111]
    s_waitcnt lgkmcnt(7)
    v_mfma_f32_16x16x32_bf16 v[16:19], a[36:39], v[144:147], v[16:19]
    ds_read_b128 v[112:115], v10 offset:16384
    v_mfma_f32_16x16x32_bf16 v[48:51], a[40:43], v[144:147], v[48:51]
    buffer_load_dwordx4 a[84:87], v8, s[12:15], s38 offen offset:0 sc1
    v_mfma_f32_16x16x32_bf16 v[80:83], a[44:47], v[144:147], v[80:83]
    s_waitcnt lgkmcnt(7)
    ds_read_b128 v[116:119], v10 offset:18432
    v_mfma_f32_16x16x32_bf16 v[20:23], a[36:39], v[148:151], v[20:23]
    v_mfma_f32_16x16x32_bf16 v[52:55], a[40:43], v[148:151], v[52:55]
    ds_read_b128 v[120:123], v10 offset:20480
    v_mfma_f32_16x16x32_bf16 v[84:87], a[44:47], v[148:151], v[84:87]
    s_waitcnt lgkmcnt(8)
    buffer_load_dwordx4 a[88:91], v8, s[12:15], s38 offen offset:1024 sc1
    v_mfma_f32_16x16x32_bf16 v[24:27], a[36:39], v[152:155], v[24:27]
    ds_read_b128 v[124:127], v10 offset:22528
    v_mfma_f32_16x16x32_bf16 v[56:59], a[40:43], v[152:155], v[56:59]
    s_cmp_lt_u32 s68, 32
    s_cselect_b32 s64, s44, s46
    s_cselect_b32 s65, s45, s47
    v_mfma_f32_16x16x32_bf16 v[88:91], a[44:47], v[152:155], v[88:91]
    s_waitcnt lgkmcnt(8)
    s_and_b32 s73, s68, 31
    s_lshl_b32 s73, s73, 7
    v_mfma_f32_16x16x32_bf16 v[28:31], a[36:39], v[156:159], v[28:31]
    ds_read_b128 v[128:131], v10 offset:24576
    v_mfma_f32_16x16x32_bf16 v[60:63], a[40:43], v[156:159], v[60:63]
    s_add_u32 s73, s73, s71
    buffer_load_dwordx4 a[92:95], v8, s[12:15], s38 offen offset:2048 sc1
    v_mfma_f32_16x16x32_bf16 v[92:95], a[44:47], v[156:159], v[92:95]
    s_waitcnt lgkmcnt(8)
    ds_read_b128 v[132:135], v10 offset:26624
    v_mfma_f32_16x16x32_bf16 v[32:35], a[36:39], v[160:163], v[32:35]
    v_mfma_f32_16x16x32_bf16 v[64:67], a[40:43], v[160:163], v[64:67]
    ds_read_b128 v[136:139], v10 offset:28672
    s_add_u32 m0, s72, 81920
    v_mfma_f32_16x16x32_bf16 v[96:99], a[44:47], v[160:163], v[96:99]
    s_waitcnt lgkmcnt(9)
    v_mfma_f32_16x16x32_bf16 v[36:39], a[36:39], v[164:167], v[36:39]
    ds_read_b128 v[140:143], v10 offset:30720
    v_mfma_f32_16x16x32_bf16 v[68:71], a[40:43], v[164:167], v[68:71]
    buffer_load_dwordx4 v208, s[64:67], s73 offen offset:0 lds
    v_mfma_f32_16x16x32_bf16 v[100:103], a[44:47], v[164:167], v[100:103]
    s_waitcnt lgkmcnt(9)
    buffer_load_dwordx4 v209, s[64:67], s73 offen offset:1024 lds
    v_mfma_f32_16x16x32_bf16 v[40:43], a[36:39], v[168:171], v[40:43]
    s_add_u32 s38, s38, s39
    s_cmp_eq_u32 s38, s63
    s_cselect_b32 s38, s62, s38
    v_mfma_f32_16x16x32_bf16 v[72:75], a[40:43], v[168:171], v[72:75]
    v_mfma_f32_16x16x32_bf16 v[104:107], a[44:47], v[168:171], v[104:107]
    s_waitcnt lgkmcnt(8)
    buffer_load_dwordx4 v210, s[64:67], s73 offen offset:2048 lds
    v_mfma_f32_16x16x32_bf16 v[44:47], a[36:39], v[172:175], v[44:47]
    v_mfma_f32_16x16x32_bf16 v[76:79], a[40:43], v[172:175], v[76:79]
    buffer_load_dwordx4 v211, s[64:67], s73 offen offset:3072 lds
    v_mfma_f32_16x16x32_bf16 v[108:111], a[44:47], v[172:175], v[108:111]
    s_waitcnt vmcnt(21) lgkmcnt(7)
    v_mfma_f32_16x16x32_bf16 v[16:19], a[48:51], v[112:115], v[16:19]
    ds_read_b128 v[144:147], v11 offset:16384
    v_mfma_f32_16x16x32_bf16 v[48:51], a[52:55], v[112:115], v[48:51]
    s_add_u32 s68, s68, 1
    s_cmp_eq_u32 s68, s70
    s_cselect_b32 s68, s69, s68
    v_mfma_f32_16x16x32_bf16 v[80:83], a[56:59], v[112:115], v[80:83]
    s_waitcnt lgkmcnt(7)
    ds_read_b128 v[148:151], v11 offset:18432
    v_mfma_f32_16x16x32_bf16 v[20:23], a[48:51], v[116:119], v[20:23]
    buffer_load_dwordx4 a[0:3], v8, s[12:15], s38 offen offset:0 sc1
    v_mfma_f32_16x16x32_bf16 v[52:55], a[52:55], v[116:119], v[52:55]
    ds_read_b128 v[152:155], v11 offset:20480
    v_mfma_f32_16x16x32_bf16 v[84:87], a[56:59], v[116:119], v[84:87]
    s_waitcnt lgkmcnt(8)
    buffer_load_dwordx4 a[4:7], v8, s[12:15], s38 offen offset:1024 sc1
    v_mfma_f32_16x16x32_bf16 v[24:27], a[48:51], v[120:123], v[24:27]
    ds_read_b128 v[156:159], v11 offset:22528
    v_mfma_f32_16x16x32_bf16 v[56:59], a[52:55], v[120:123], v[56:59]
    v_mfma_f32_16x16x32_bf16 v[88:91], a[56:59], v[120:123], v[88:91]
    s_waitcnt lgkmcnt(8)
    v_mfma_f32_16x16x32_bf16 v[28:31], a[48:51], v[124:127], v[28:31]
    ds_read_b128 v[160:163], v11 offset:24576
    v_mfma_f32_16x16x32_bf16 v[60:63], a[52:55], v[124:127], v[60:63]
    buffer_load_dwordx4 a[8:11], v8, s[12:15], s38 offen offset:2048 sc1
    v_mfma_f32_16x16x32_bf16 v[92:95], a[56:59], v[124:127], v[92:95]
    s_waitcnt lgkmcnt(8)
    ds_read_b128 v[164:167], v11 offset:26624
    v_mfma_f32_16x16x32_bf16 v[32:35], a[48:51], v[128:131], v[32:35]
    v_mfma_f32_16x16x32_bf16 v[64:67], a[52:55], v[128:131], v[64:67]
    ds_read_b128 v[168:171], v11 offset:28672
    v_mfma_f32_16x16x32_bf16 v[96:99], a[56:59], v[128:131], v[96:99]
    s_waitcnt lgkmcnt(9)
    v_mfma_f32_16x16x32_bf16 v[36:39], a[48:51], v[132:135], v[36:39]
    ds_read_b128 v[172:175], v11 offset:30720
    s_add_u32 s38, s38, s39
    v_mfma_f32_16x16x32_bf16 v[68:71], a[52:55], v[132:135], v[68:71]
    s_cmp_lt_u32 s68, 32
    s_cselect_b32 s64, s44, s46
    s_cselect_b32 s65, s45, s47
    v_mfma_f32_16x16x32_bf16 v[100:103], a[56:59], v[132:135], v[100:103]
    s_waitcnt lgkmcnt(9)
    v_mfma_f32_16x16x32_bf16 v[40:43], a[48:51], v[136:139], v[40:43]
    s_and_b32 s73, s68, 31
    v_mfma_f32_16x16x32_bf16 v[72:75], a[52:55], v[136:139], v[72:75]
    v_mfma_f32_16x16x32_bf16 v[104:107], a[56:59], v[136:139], v[104:107]
    s_waitcnt lgkmcnt(8)
    s_lshl_b32 s73, s73, 7
    v_mfma_f32_16x16x32_bf16 v[44:47], a[48:51], v[140:143], v[44:47]
    v_mfma_f32_16x16x32_bf16 v[76:79], a[52:55], v[140:143], v[76:79]
    s_add_u32 s73, s73, s71
    v_mfma_f32_16x16x32_bf16 v[108:111], a[56:59], v[140:143], v[108:111]
    s_waitcnt vmcnt(17) lgkmcnt(7)
    v_mfma_f32_16x16x32_bf16 v[16:19], a[60:63], v[144:147], v[16:19]
    ds_read_b128 v[112:115], v10 offset:32768
    v_mfma_f32_16x16x32_bf16 v[48:51], a[64:67], v[144:147], v[48:51]
    s_add_u32 m0, s72, 98304
    buffer_load_dwordx4 a[12:15], v8, s[12:15], s38 offen offset:0 sc1
    v_mfma_f32_16x16x32_bf16 v[80:83], a[68:71], v[144:147], v[80:83]
    s_waitcnt lgkmcnt(7)
    ds_read_b128 v[116:119], v10 offset:34816
    v_mfma_f32_16x16x32_bf16 v[20:23], a[60:63], v[148:151], v[20:23]
    buffer_load_dwordx4 v208, s[64:67], s73 offen offset:0 lds
    v_mfma_f32_16x16x32_bf16 v[52:55], a[64:67], v[148:151], v[52:55]
    ds_read_b128 v[120:123], v10 offset:36864
    v_mfma_f32_16x16x32_bf16 v[84:87], a[68:71], v[148:151], v[84:87]
    s_waitcnt lgkmcnt(8)
    buffer_load_dwordx4 v209, s[64:67], s73 offen offset:1024 lds
    v_mfma_f32_16x16x32_bf16 v[24:27], a[60:63], v[152:155], v[24:27]
    ds_read_b128 v[124:127], v10 offset:38912
    v_mfma_f32_16x16x32_bf16 v[56:59], a[64:67], v[152:155], v[56:59]
    buffer_load_dwordx4 a[16:19], v8, s[12:15], s38 offen offset:1024 sc1
    v_mfma_f32_16x16x32_bf16 v[88:91], a[68:71], v[152:155], v[88:91]
    s_waitcnt lgkmcnt(8)
    buffer_load_dwordx4 v210, s[64:67], s73 offen offset:2048 lds
    v_mfma_f32_16x16x32_bf16 v[28:31], a[60:63], v[156:159], v[28:31]
    ds_read_b128 v[128:131], v10 offset:40960
    v_mfma_f32_16x16x32_bf16 v[60:63], a[64:67], v[156:159], v[60:63]
    buffer_load_dwordx4 v211, s[64:67], s73 offen offset:3072 lds
    v_mfma_f32_16x16x32_bf16 v[92:95], a[68:71], v[156:159], v[92:95]
    s_waitcnt lgkmcnt(8)
    ds_read_b128 v[132:135], v10 offset:43008
    v_mfma_f32_16x16x32_bf16 v[32:35], a[60:63], v[160:163], v[32:35]
    s_add_u32 s68, s68, 1
    s_cmp_eq_u32 s68, s70
    s_cselect_b32 s68, s69, s68
    v_mfma_f32_16x16x32_bf16 v[64:67], a[64:67], v[160:163], v[64:67]
    ds_read_b128 v[136:139], v10 offset:45056
    v_mfma_f32_16x16x32_bf16 v[96:99], a[68:71], v[160:163], v[96:99]
    s_waitcnt lgkmcnt(9)
    buffer_load_dwordx4 a[20:23], v8, s[12:15], s38 offen offset:2048 sc1
    v_mfma_f32_16x16x32_bf16 v[36:39], a[60:63], v[164:167], v[36:39]
    ds_read_b128 v[140:143], v10 offset:47104
    v_mfma_f32_16x16x32_bf16 v[68:71], a[64:67], v[164:167], v[68:71]
    s_add_u32 s38, s38, s39
    s_cmp_eq_u32 s38, s63
    s_cselect_b32 s38, s62, s38
    v_mfma_f32_16x16x32_bf16 v[100:103], a[68:71], v[164:167], v[100:103]
    s_waitcnt lgkmcnt(9)
    v_mfma_f32_16x16x32_bf16 v[40:43], a[60:63], v[168:171], v[40:43]
    v_mfma_f32_16x16x32_bf16 v[72:75], a[64:67], v[168:171], v[72:75]
    v_mfma_f32_16x16x32_bf16 v[104:107], a[68:71], v[168:171], v[104:107]
    s_waitcnt lgkmcnt(8)
    v_mfma_f32_16x16x32_bf16 v[44:47], a[60:63], v[172:175], v[44:47]
    v_mfma_f32_16x16x32_bf16 v[76:79], a[64:67], v[172:175], v[76:79]
    v_mfma_f32_16x16x32_bf16 v[108:111], a[68:71], v[172:175], v[108:111]
    s_waitcnt vmcnt(17) lgkmcnt(7)
    v_mfma_f32_16x16x32_bf16 v[16:19], a[72:75], v[112:115], v[16:19]
    ds_read_b128 v[144:147], v11 offset:32768
    v_mfma_f32_16x16x32_bf16 v[48:51], a[76:79], v[112:115], v[48:51]
    buffer_load_dwordx4 a[24:27], v8, s[12:15], s38 offen offset:0 sc1
    v_mfma_f32_16x16x32_bf16 v[80:83], a[80:83], v[112:115], v[80:83]
    s_waitcnt lgkmcnt(7)
    ds_read_b128 v[148:151], v11 offset:34816
    v_mfma_f32_16x16x32_bf16 v[20:23], a[72:75], v[116:119], v[20:23]
    v_mfma_f32_16x16x32_bf16 v[52:55], a[76:79], v[116:119], v[52:55]
    ds_read_b128 v[152:155], v11 offset:36864
    v_mfma_f32_16x16x32_bf16 v[84:87], a[80:83], v[116:119], v[84:87]
    s_waitcnt lgkmcnt(8)
    buffer_load_dwordx4 a[28:31], v8, s[12:15], s38 offen offset:1024 sc1
    v_mfma_f32_16x16x32_bf16 v[24:27], a[72:75], v[120:123], v[24:27]
    ds_read_b128 v[156:159], v11 offset:38912
    v_mfma_f32_16x16x32_bf16 v[56:59], a[76:79], v[120:123], v[56:59]
    s_cmp_lt_u32 s68, 32
    s_cselect_b32 s64, s44, s46
    s_cselect_b32 s65, s45, s47
    v_mfma_f32_16x16x32_bf16 v[88:91], a[80:83], v[120:123], v[88:91]
    s_waitcnt lgkmcnt(8)
    s_and_b32 s73, s68, 31
    s_lshl_b32 s73, s73, 7
    v_mfma_f32_16x16x32_bf16 v[28:31], a[72:75], v[124:127], v[28:31]
    ds_read_b128 v[160:163], v11 offset:40960
    v_mfma_f32_16x16x32_bf16 v[60:63], a[76:79], v[124:127], v[60:63]
    s_add_u32 s73, s73, s71
    buffer_load_dwordx4 a[32:35], v8, s[12:15], s38 offen offset:2048 sc1
    v_mfma_f32_16x16x32_bf16 v[92:95], a[80:83], v[124:127], v[92:95]
    s_waitcnt lgkmcnt(8)
    ds_read_b128 v[164:167], v11 offset:43008
    v_mfma_f32_16x16x32_bf16 v[32:35], a[72:75], v[128:131], v[32:35]
    v_mfma_f32_16x16x32_bf16 v[64:67], a[76:79], v[128:131], v[64:67]
    ds_read_b128 v[168:171], v11 offset:45056
    s_add_u32 m0, s72, 114688
    v_mfma_f32_16x16x32_bf16 v[96:99], a[80:83], v[128:131], v[96:99]
    s_waitcnt lgkmcnt(9)
    v_mfma_f32_16x16x32_bf16 v[36:39], a[72:75], v[132:135], v[36:39]
    ds_read_b128 v[172:175], v11 offset:47104
    s_add_u32 s38, s38, s39
    v_mfma_f32_16x16x32_bf16 v[68:71], a[76:79], v[132:135], v[68:71]
    buffer_load_dwordx4 v208, s[64:67], s73 offen offset:0 lds
    v_mfma_f32_16x16x32_bf16 v[100:103], a[80:83], v[132:135], v[100:103]
    s_waitcnt lgkmcnt(9)
    buffer_load_dwordx4 v209, s[64:67], s73 offen offset:1024 lds
    v_mfma_f32_16x16x32_bf16 v[40:43], a[72:75], v[136:139], v[40:43]
    v_mfma_f32_16x16x32_bf16 v[72:75], a[76:79], v[136:139], v[72:75]
    v_mfma_f32_16x16x32_bf16 v[104:107], a[80:83], v[136:139], v[104:107]
    s_waitcnt lgkmcnt(8)
    buffer_load_dwordx4 v210, s[64:67], s73 offen offset:2048 lds
    v_mfma_f32_16x16x32_bf16 v[44:47], a[72:75], v[140:143], v[44:47]
    v_mfma_f32_16x16x32_bf16 v[76:79], a[76:79], v[140:143], v[76:79]
    buffer_load_dwordx4 v211, s[64:67], s73 offen offset:3072 lds
    v_mfma_f32_16x16x32_bf16 v[108:111], a[80:83], v[140:143], v[108:111]
    s_waitcnt vmcnt(21) lgkmcnt(7)
    v_mfma_f32_16x16x32_bf16 v[16:19], a[84:87], v[144:147], v[16:19]
    s_barrier
    v_mfma_f32_16x16x32_bf16 v[48:51], a[88:91], v[144:147], v[48:51]
    ds_read_b128 v[112:115], v10 offset:49152
    v_mfma_f32_16x16x32_bf16 v[80:83], a[92:95], v[144:147], v[80:83]
    s_waitcnt lgkmcnt(7)
    s_add_u32 s68, s68, 1
    s_cmp_eq_u32 s68, s70
    s_cselect_b32 s68, s69, s68
    v_mfma_f32_16x16x32_bf16 v[20:23], a[84:87], v[148:151], v[20:23]
    ds_read_b128 v[116:119], v10 offset:51200
    v_mfma_f32_16x16x32_bf16 v[52:55], a[88:91], v[148:151], v[52:55]
    buffer_load_dwordx4 a[36:39], v8, s[12:15], s38 offen offset:0 sc1
    v_mfma_f32_16x16x32_bf16 v[84:87], a[92:95], v[148:151], v[84:87]
    s_waitcnt lgkmcnt(7)
    ds_read_b128 v[120:123], v10 offset:53248
    v_mfma_f32_16x16x32_bf16 v[24:27], a[84:87], v[152:155], v[24:27]
    buffer_load_dwordx4 a[40:43], v8, s[12:15], s38 offen offset:1024 sc1
    v_mfma_f32_16x16x32_bf16 v[56:59], a[88:91], v[152:155], v[56:59]
    ds_read_b128 v[124:127], v10 offset:55296
    v_mfma_f32_16x16x32_bf16 v[88:91], a[92:95], v[152:155], v[88:91]
    s_waitcnt lgkmcnt(8)
    v_mfma_f32_16x16x32_bf16 v[28:31], a[84:87], v[156:159], v[28:31]
    ds_read_b128 v[128:131], v10 offset:57344
    v_mfma_f32_16x16x32_bf16 v[60:63], a[88:91], v[156:159], v[60:63]
    buffer_load_dwordx4 a[44:47], v8, s[12:15], s38 offen offset:2048 sc1
    v_mfma_f32_16x16x32_bf16 v[92:95], a[92:95], v[156:159], v[92:95]
    s_waitcnt lgkmcnt(8)
    ds_read_b128 v[132:135], v10 offset:59392
    v_mfma_f32_16x16x32_bf16 v[32:35], a[84:87], v[160:163], v[32:35]
    v_mfma_f32_16x16x32_bf16 v[64:67], a[88:91], v[160:163], v[64:67]
    ds_read_b128 v[136:139], v10 offset:61440
    v_mfma_f32_16x16x32_bf16 v[96:99], a[92:95], v[160:163], v[96:99]
    s_waitcnt lgkmcnt(9)
    v_mfma_f32_16x16x32_bf16 v[36:39], a[84:87], v[164:167], v[36:39]
    ds_read_b128 v[140:143], v10 offset:63488
    v_mfma_f32_16x16x32_bf16 v[68:71], a[88:91], v[164:167], v[68:71]
    s_cmp_lt_u32 s68, 32
    s_cselect_b32 s64, s44, s46
    s_cselect_b32 s65, s45, s47
    v_mfma_f32_16x16x32_bf16 v[100:103], a[92:95], v[164:167], v[100:103]
    s_waitcnt lgkmcnt(9)
    v_mfma_f32_16x16x32_bf16 v[40:43], a[84:87], v[168:171], v[40:43]
    s_and_b32 s73, s68, 31
    v_mfma_f32_16x16x32_bf16 v[72:75], a[88:91], v[168:171], v[72:75]
    s_add_u32 s38, s38, s39
    s_cmp_eq_u32 s38, s63
    s_cselect_b32 s38, s62, s38
    v_mfma_f32_16x16x32_bf16 v[104:107], a[92:95], v[168:171], v[104:107]
    s_waitcnt lgkmcnt(8)
    s_lshl_b32 s73, s73, 7
    v_mfma_f32_16x16x32_bf16 v[44:47], a[84:87], v[172:175], v[44:47]
    v_mfma_f32_16x16x32_bf16 v[76:79], a[88:91], v[172:175], v[76:79]
    s_add_u32 s73, s73, s71
    v_mfma_f32_16x16x32_bf16 v[108:111], a[92:95], v[172:175], v[108:111]
    s_waitcnt vmcnt(17) lgkmcnt(7)
    v_mfma_f32_16x16x32_bf16 v[16:19], a[0:3], v[112:115], v[16:19]
    ds_read_b128 v[144:147], v11 offset:49152
    v_mfma_f32_16x16x32_bf16 v[48:51], a[4:7], v[112:115], v[48:51]
    s_add_u32 m0, s72, 131072
    buffer_load_dwordx4 a[48:51], v8, s[12:15], s38 offen offset:0 sc1
    v_mfma_f32_16x16x32_bf16 v[80:83], a[8:11], v[112:115], v[80:83]
    s_waitcnt lgkmcnt(7)
    ds_read_b128 v[148:151], v11 offset:51200
    v_mfma_f32_16x16x32_bf16 v[20:23], a[0:3], v[116:119], v[20:23]
    buffer_load_dwordx4 v208, s[64:67], s73 offen offset:0 lds
    v_mfma_f32_16x16x32_bf16 v[52:55], a[4:7], v[116:119], v[52:55]
    ds_read_b128 v[152:155], v11 offset:53248
    v_mfma_f32_16x16x32_bf16 v[84:87], a[8:11], v[116:119], v[84:87]
    s_waitcnt lgkmcnt(8)
    buffer_load_dwordx4 v209, s[64:67], s73 offen offset:1024 lds
    v_mfma_f32_16x16x32_bf16 v[24:27], a[0:3], v[120:123], v[24:27]
    ds_read_b128 v[156:159], v11 offset:55296
    v_mfma_f32_16x16x32_bf16 v[56:59], a[4:7], v[120:123], v[56:59]
    buffer_load_dwordx4 a[52:55], v8, s[12:15], s38 offen offset:1024 sc1
    v_mfma_f32_16x16x32_bf16 v[88:91], a[8:11], v[120:123], v[88:91]
    s_waitcnt lgkmcnt(8)
    buffer_load_dwordx4 v210, s[64:67], s73 offen offset:2048 lds
    v_mfma_f32_16x16x32_bf16 v[28:31], a[0:3], v[124:127], v[28:31]
    ds_read_b128 v[160:163], v11 offset:57344
    v_mfma_f32_16x16x32_bf16 v[60:63], a[4:7], v[124:127], v[60:63]
    buffer_load_dwordx4 v211, s[64:67], s73 offen offset:3072 lds
    v_mfma_f32_16x16x32_bf16 v[92:95], a[8:11], v[124:127], v[92:95]
    s_waitcnt lgkmcnt(8)
    ds_read_b128 v[164:167], v11 offset:59392
    v_mfma_f32_16x16x32_bf16 v[32:35], a[0:3], v[128:131], v[32:35]
    s_add_u32 s68, s68, 1
    s_cmp_eq_u32 s68, s70
    s_cselect_b32 s68, s69, s68
    v_mfma_f32_16x16x32_bf16 v[64:67], a[4:7], v[128:131], v[64:67]
    ds_read_b128 v[168:171], v11 offset:61440
    v_mfma_f32_16x16x32_bf16 v[96:99], a[8:11], v[128:131], v[96:99]
    s_waitcnt lgkmcnt(9)
    buffer_load_dwordx4 a[56:59], v8, s[12:15], s38 offen offset:2048 sc1
    v_mfma_f32_16x16x32_bf16 v[36:39], a[0:3], v[132:135], v[36:39]
    ds_read_b128 v[172:175], v11 offset:63488
    s_add_u32 s38, s38, s39
    v_mfma_f32_16x16x32_bf16 v[68:71], a[4:7], v[132:135], v[68:71]
    v_mfma_f32_16x16x32_bf16 v[100:103], a[8:11], v[132:135], v[100:103]
    s_waitcnt lgkmcnt(9)
    v_mfma_f32_16x16x32_bf16 v[40:43], a[0:3], v[136:139], v[40:43]
    v_mfma_f32_16x16x32_bf16 v[72:75], a[4:7], v[136:139], v[72:75]
    v_mfma_f32_16x16x32_bf16 v[104:107], a[8:11], v[136:139], v[104:107]
    s_waitcnt lgkmcnt(8)
    v_mfma_f32_16x16x32_bf16 v[44:47], a[0:3], v[140:143], v[44:47]
    v_mfma_f32_16x16x32_bf16 v[76:79], a[4:7], v[140:143], v[76:79]
    v_mfma_f32_16x16x32_bf16 v[108:111], a[8:11], v[140:143], v[108:111]
    s_waitcnt vmcnt(17) lgkmcnt(7)
    v_mfma_f32_16x16x32_bf16 v[16:19], a[12:15], v[144:147], v[16:19]
    ds_read_b128 v[112:115], v12 offset:0
    v_mfma_f32_16x16x32_bf16 v[48:51], a[16:19], v[144:147], v[48:51]
    buffer_load_dwordx4 a[60:63], v8, s[12:15], s38 offen offset:0 sc1
    v_mfma_f32_16x16x32_bf16 v[80:83], a[20:23], v[144:147], v[80:83]
    s_waitcnt lgkmcnt(7)
    ds_read_b128 v[116:119], v12 offset:2048
    v_mfma_f32_16x16x32_bf16 v[20:23], a[12:15], v[148:151], v[20:23]
    v_mfma_f32_16x16x32_bf16 v[52:55], a[16:19], v[148:151], v[52:55]
    ds_read_b128 v[120:123], v12 offset:4096
    v_mfma_f32_16x16x32_bf16 v[84:87], a[20:23], v[148:151], v[84:87]
    s_waitcnt lgkmcnt(8)
    buffer_load_dwordx4 a[64:67], v8, s[12:15], s38 offen offset:1024 sc1
    v_mfma_f32_16x16x32_bf16 v[24:27], a[12:15], v[152:155], v[24:27]
    ds_read_b128 v[124:127], v12 offset:6144
    v_mfma_f32_16x16x32_bf16 v[56:59], a[16:19], v[152:155], v[56:59]
    s_cmp_lt_u32 s68, 32
    s_cselect_b32 s64, s44, s46
    s_cselect_b32 s65, s45, s47
    v_mfma_f32_16x16x32_bf16 v[88:91], a[20:23], v[152:155], v[88:91]
    s_waitcnt lgkmcnt(8)
    s_and_b32 s73, s68, 31
    s_lshl_b32 s73, s73, 7
    v_mfma_f32_16x16x32_bf16 v[28:31], a[12:15], v[156:159], v[28:31]
    ds_read_b128 v[128:131], v12 offset:8192
    v_mfma_f32_16x16x32_bf16 v[60:63], a[16:19], v[156:159], v[60:63]
    s_add_u32 s73, s73, s71
    buffer_load_dwordx4 a[68:71], v8, s[12:15], s38 offen offset:2048 sc1
    v_mfma_f32_16x16x32_bf16 v[92:95], a[20:23], v[156:159], v[92:95]
    s_waitcnt lgkmcnt(8)
    ds_read_b128 v[132:135], v12 offset:10240
    v_mfma_f32_16x16x32_bf16 v[32:35], a[12:15], v[160:163], v[32:35]
    v_mfma_f32_16x16x32_bf16 v[64:67], a[16:19], v[160:163], v[64:67]
    ds_read_b128 v[136:139], v12 offset:12288
    s_add_u32 m0, s72, 147456
    v_mfma_f32_16x16x32_bf16 v[96:99], a[20:23], v[160:163], v[96:99]
    s_waitcnt lgkmcnt(9)
    v_mfma_f32_16x16x32_bf16 v[36:39], a[12:15], v[164:167], v[36:39]
    ds_read_b128 v[140:143], v12 offset:14336
    v_mfma_f32_16x16x32_bf16 v[68:71], a[16:19], v[164:167], v[68:71]
    buffer_load_dwordx4 v208, s[64:67], s73 offen offset:0 lds
    v_mfma_f32_16x16x32_bf16 v[100:103], a[20:23], v[164:167], v[100:103]
    s_waitcnt lgkmcnt(9)
    buffer_load_dwordx4 v209, s[64:67], s73 offen offset:1024 lds
    v_mfma_f32_16x16x32_bf16 v[40:43], a[12:15], v[168:171], v[40:43]
    s_add_u32 s38, s38, s39
    s_cmp_eq_u32 s38, s63
    s_cselect_b32 s38, s62, s38
    v_mfma_f32_16x16x32_bf16 v[72:75], a[16:19], v[168:171], v[72:75]
    v_mfma_f32_16x16x32_bf16 v[104:107], a[20:23], v[168:171], v[104:107]
    s_waitcnt lgkmcnt(8)
    buffer_load_dwordx4 v210, s[64:67], s73 offen offset:2048 lds
    v_mfma_f32_16x16x32_bf16 v[44:47], a[12:15], v[172:175], v[44:47]
    v_mfma_f32_16x16x32_bf16 v[76:79], a[16:19], v[172:175], v[76:79]
    buffer_load_dwordx4 v211, s[64:67], s73 offen offset:3072 lds
    v_mfma_f32_16x16x32_bf16 v[108:111], a[20:23], v[172:175], v[108:111]
    s_waitcnt vmcnt(21) lgkmcnt(7)
    v_mfma_f32_16x16x32_bf16 v[16:19], a[24:27], v[112:115], v[16:19]
    ds_read_b128 v[144:147], v13 offset:0
    v_mfma_f32_16x16x32_bf16 v[48:51], a[28:31], v[112:115], v[48:51]
    s_add_u32 s68, s68, 1
    s_cmp_eq_u32 s68, s70
    s_cselect_b32 s68, s69, s68
    v_mfma_f32_16x16x32_bf16 v[80:83], a[32:35], v[112:115], v[80:83]
    s_waitcnt lgkmcnt(7)
    ds_read_b128 v[148:151], v13 offset:2048
    v_mfma_f32_16x16x32_bf16 v[20:23], a[24:27], v[116:119], v[20:23]
    buffer_load_dwordx4 a[72:75], v8, s[12:15], s38 offen offset:0 sc1
    v_mfma_f32_16x16x32_bf16 v[52:55], a[28:31], v[116:119], v[52:55]
    ds_read_b128 v[152:155], v13 offset:4096
    v_mfma_f32_16x16x32_bf16 v[84:87], a[32:35], v[116:119], v[84:87]
    s_waitcnt lgkmcnt(8)
    buffer_load_dwordx4 a[76:79], v8, s[12:15], s38 offen offset:1024 sc1
    v_mfma_f32_16x16x32_bf16 v[24:27], a[24:27], v[120:123], v[24:27]
    ds_read_b128 v[156:159], v13 offset:6144
    v_mfma_f32_16x16x32_bf16 v[56:59], a[28:31], v[120:123], v[56:59]
    v_mfma_f32_16x16x32_bf16 v[88:91], a[32:35], v[120:123], v[88:91]
    s_waitcnt lgkmcnt(8)
    v_mfma_f32_16x16x32_bf16 v[28:31], a[24:27], v[124:127], v[28:31]
    ds_read_b128 v[160:163], v13 offset:8192
    v_mfma_f32_16x16x32_bf16 v[60:63], a[28:31], v[124:127], v[60:63]
    buffer_load_dwordx4 a[80:83], v8, s[12:15], s38 offen offset:2048 sc1
    v_mfma_f32_16x16x32_bf16 v[92:95], a[32:35], v[124:127], v[92:95]
    s_waitcnt lgkmcnt(8)
    ds_read_b128 v[164:167], v13 offset:10240
    v_mfma_f32_16x16x32_bf16 v[32:35], a[24:27], v[128:131], v[32:35]
    v_mfma_f32_16x16x32_bf16 v[64:67], a[28:31], v[128:131], v[64:67]
    ds_read_b128 v[168:171], v13 offset:12288
    v_mfma_f32_16x16x32_bf16 v[96:99], a[32:35], v[128:131], v[96:99]
    s_waitcnt lgkmcnt(9)
    v_mfma_f32_16x16x32_bf16 v[36:39], a[24:27], v[132:135], v[36:39]
    ds_read_b128 v[172:175], v13 offset:14336
    s_add_u32 s38, s38, s39
    v_mfma_f32_16x16x32_bf16 v[68:71], a[28:31], v[132:135], v[68:71]
    s_cmp_lt_u32 s68, 32
    s_cselect_b32 s64, s44, s46
    s_cselect_b32 s65, s45, s47
    v_mfma_f32_16x16x32_bf16 v[100:103], a[32:35], v[132:135], v[100:103]
    s_waitcnt lgkmcnt(9)
    v_mfma_f32_16x16x32_bf16 v[40:43], a[24:27], v[136:139], v[40:43]
    s_and_b32 s73, s68, 31
    v_mfma_f32_16x16x32_bf16 v[72:75], a[28:31], v[136:139], v[72:75]
    v_mfma_f32_16x16x32_bf16 v[104:107], a[32:35], v[136:139], v[104:107]
    s_waitcnt lgkmcnt(8)
    s_lshl_b32 s73, s73, 7
    v_mfma_f32_16x16x32_bf16 v[44:47], a[24:27], v[140:143], v[44:47]
    v_mfma_f32_16x16x32_bf16 v[76:79], a[28:31], v[140:143], v[76:79]
    s_add_u32 s73, s73, s71
    v_mfma_f32_16x16x32_bf16 v[108:111], a[32:35], v[140:143], v[108:111]
    s_waitcnt vmcnt(17) lgkmcnt(7)
    v_mfma_f32_16x16x32_bf16 v[16:19], a[36:39], v[144:147], v[16:19]
    s_barrier
    v_mfma_f32_16x16x32_bf16 v[48:51], a[40:43], v[144:147], v[48:51]
    ds_read_b128 v[112:115], v12 offset:16384
    s_add_u32 m0, s72, 0
    v_mfma_f32_16x16x32_bf16 v[80:83], a[44:47], v[144:147], v[80:83]
    s_waitcnt lgkmcnt(7)
    buffer_load_dwordx4 a[84:87], v8, s[12:15], s38 offen offset:0 sc1
    v_mfma_f32_16x16x32_bf16 v[20:23], a[36:39], v[148:151], v[20:23]
    ds_read_b128 v[116:119], v12 offset:18432
    v_mfma_f32_16x16x32_bf16 v[52:55], a[40:43], v[148:151], v[52:55]
    buffer_load_dwordx4 v208, s[64:67], s73 offen offset:0 lds
    v_mfma_f32_16x16x32_bf16 v[84:87], a[44:47], v[148:151], v[84:87]
    s_waitcnt lgkmcnt(7)
    ds_read_b128 v[120:123], v12 offset:20480
    v_mfma_f32_16x16x32_bf16 v[24:27], a[36:39], v[152:155], v[24:27]
    buffer_load_dwordx4 v209, s[64:67], s73 offen offset:1024 lds
    v_mfma_f32_16x16x32_bf16 v[56:59], a[40:43], v[152:155], v[56:59]
    ds_read_b128 v[124:127], v12 offset:22528
    v_mfma_f32_16x16x32_bf16 v[88:91], a[44:47], v[152:155], v[88:91]
    s_waitcnt lgkmcnt(8)
    buffer_load_dwordx4 v210, s[64:67], s73 offen offset:2048 lds
    v_mfma_f32_16x16x32_bf16 v[28:31], a[36:39], v[156:159], v[28:31]
    ds_read_b128 v[128:131], v12 offset:24576
    v_mfma_f32_16x16x32_bf16 v[60:63], a[40:43], v[156:159], v[60:63]
    buffer_load_dwordx4 v211, s[64:67], s73 offen offset:3072 lds
    v_mfma_f32_16x16x32_bf16 v[92:95], a[44:47], v[156:159], v[92:95]
    s_waitcnt lgkmcnt(8)
    ds_read_b128 v[132:135], v12 offset:26624
    v_mfma_f32_16x16x32_bf16 v[32:35], a[36:39], v[160:163], v[32:35]
    s_add_u32 s68, s68, 1
    s_cmp_eq_u32 s68, s70
    s_cselect_b32 s68, s69, s68
    v_mfma_f32_16x16x32_bf16 v[64:67], a[40:43], v[160:163], v[64:67]
    ds_read_b128 v[136:139], v12 offset:28672
    v_mfma_f32_16x16x32_bf16 v[96:99], a[44:47], v[160:163], v[96:99]
    s_waitcnt lgkmcnt(9)
    buffer_load_dwordx4 a[88:91], v8, s[12:15], s38 offen offset:1024 sc1
    v_mfma_f32_16x16x32_bf16 v[36:39], a[36:39], v[164:167], v[36:39]
    ds_read_b128 v[140:143], v12 offset:30720
    v_mfma_f32_16x16x32_bf16 v[68:71], a[40:43], v[164:167], v[68:71]
    buffer_load_dwordx4 a[92:95], v8, s[12:15], s38 offen offset:2048 sc1
    v_mfma_f32_16x16x32_bf16 v[100:103], a[44:47], v[164:167], v[100:103]
    s_waitcnt lgkmcnt(9)
    v_mfma_f32_16x16x32_bf16 v[40:43], a[36:39], v[168:171], v[40:43]
    s_add_u32 s38, s38, s39
    s_cmp_eq_u32 s38, s63
    s_cselect_b32 s38, s62, s38
    v_mfma_f32_16x16x32_bf16 v[72:75], a[40:43], v[168:171], v[72:75]
    v_mfma_f32_16x16x32_bf16 v[104:107], a[44:47], v[168:171], v[104:107]
    s_waitcnt lgkmcnt(8)
    v_mfma_f32_16x16x32_bf16 v[44:47], a[36:39], v[172:175], v[44:47]
    v_mfma_f32_16x16x32_bf16 v[76:79], a[40:43], v[172:175], v[76:79]
    v_mfma_f32_16x16x32_bf16 v[108:111], a[44:47], v[172:175], v[108:111]
    s_waitcnt vmcnt(17) lgkmcnt(7)
    v_mfma_f32_16x16x32_bf16 v[16:19], a[48:51], v[112:115], v[16:19]
    ds_read_b128 v[144:147], v13 offset:16384
    v_mfma_f32_16x16x32_bf16 v[48:51], a[52:55], v[112:115], v[48:51]
    buffer_load_dwordx4 a[0:3], v8, s[12:15], s38 offen offset:0 sc1
    v_mfma_f32_16x16x32_bf16 v[80:83], a[56:59], v[112:115], v[80:83]
    s_waitcnt lgkmcnt(7)
    ds_read_b128 v[148:151], v13 offset:18432
    v_mfma_f32_16x16x32_bf16 v[20:23], a[48:51], v[116:119], v[20:23]
    v_mfma_f32_16x16x32_bf16 v[52:55], a[52:55], v[116:119], v[52:55]
    ds_read_b128 v[152:155], v13 offset:20480
    v_mfma_f32_16x16x32_bf16 v[84:87], a[56:59], v[116:119], v[84:87]
    s_waitcnt lgkmcnt(8)
    buffer_load_dwordx4 a[4:7], v8, s[12:15], s38 offen offset:1024 sc1
    v_mfma_f32_16x16x32_bf16 v[24:27], a[48:51], v[120:123], v[24:27]
    ds_read_b128 v[156:159], v13 offset:22528
    v_mfma_f32_16x16x32_bf16 v[56:59], a[52:55], v[120:123], v[56:59]
    s_cmp_lt_u32 s68, 32
    s_cselect_b32 s64, s44, s46
    s_cselect_b32 s65, s45, s47
    v_mfma_f32_16x16x32_bf16 v[88:91], a[56:59], v[120:123], v[88:91]
    s_waitcnt lgkmcnt(8)
    s_and_b32 s73, s68, 31
    s_lshl_b32 s73, s73, 7
    v_mfma_f32_16x16x32_bf16 v[28:31], a[48:51], v[124:127], v[28:31]
    ds_read_b128 v[160:163], v13 offset:24576
    v_mfma_f32_16x16x32_bf16 v[60:63], a[52:55], v[124:127], v[60:63]
    s_add_u32 s73, s73, s71
    buffer_load_dwordx4 a[8:11], v8, s[12:15], s38 offen offset:2048 sc1
    v_mfma_f32_16x16x32_bf16 v[92:95], a[56:59], v[124:127], v[92:95]
    s_waitcnt lgkmcnt(8)
    ds_read_b128 v[164:167], v13 offset:26624
    v_mfma_f32_16x16x32_bf16 v[32:35], a[48:51], v[128:131], v[32:35]
    v_mfma_f32_16x16x32_bf16 v[64:67], a[52:55], v[128:131], v[64:67]
    ds_read_b128 v[168:171], v13 offset:28672
    s_add_u32 m0, s72, 16384
    v_mfma_f32_16x16x32_bf16 v[96:99], a[56:59], v[128:131], v[96:99]
    s_waitcnt lgkmcnt(9)
    v_mfma_f32_16x16x32_bf16 v[36:39], a[48:51], v[132:135], v[36:39]
    ds_read_b128 v[172:175], v13 offset:30720
    s_add_u32 s38, s38, s39
    v_mfma_f32_16x16x32_bf16 v[68:71], a[52:55], v[132:135], v[68:71]
    buffer_load_dwordx4 v208, s[64:67], s73 offen offset:0 lds
    v_mfma_f32_16x16x32_bf16 v[100:103], a[56:59], v[132:135], v[100:103]
    s_waitcnt lgkmcnt(9)
    buffer_load_dwordx4 v209, s[64:67], s73 offen offset:1024 lds
    v_mfma_f32_16x16x32_bf16 v[40:43], a[48:51], v[136:139], v[40:43]
    v_mfma_f32_16x16x32_bf16 v[72:75], a[52:55], v[136:139], v[72:75]
    v_mfma_f32_16x16x32_bf16 v[104:107], a[56:59], v[136:139], v[104:107]
    s_waitcnt lgkmcnt(8)
    buffer_load_dwordx4 v210, s[64:67], s73 offen offset:2048 lds
    v_mfma_f32_16x16x32_bf16 v[44:47], a[48:51], v[140:143], v[44:47]
    v_mfma_f32_16x16x32_bf16 v[76:79], a[52:55], v[140:143], v[76:79]
    buffer_load_dwordx4 v211, s[64:67], s73 offen offset:3072 lds
    v_mfma_f32_16x16x32_bf16 v[108:111], a[56:59], v[140:143], v[108:111]
    s_waitcnt vmcnt(21) lgkmcnt(7)
    v_mfma_f32_16x16x32_bf16 v[16:19], a[60:63], v[144:147], v[16:19]
    ds_read_b128 v[112:115], v12 offset:32768
    v_mfma_f32_16x16x32_bf16 v[48:51], a[64:67], v[144:147], v[48:51]
    s_add_u32 s68, s68, 1
    s_cmp_eq_u32 s68, s70
    s_cselect_b32 s68, s69, s68
    v_mfma_f32_16x16x32_bf16 v[80:83], a[68:71], v[144:147], v[80:83]
    s_waitcnt lgkmcnt(7)
    ds_read_b128 v[116:119], v12 offset:34816
    v_mfma_f32_16x16x32_bf16 v[20:23], a[60:63], v[148:151], v[20:23]
    buffer_load_dwordx4 a[12:15], v8, s[12:15], s38 offen offset:0 sc1
    v_mfma_f32_16x16x32_bf16 v[52:55], a[64:67], v[148:151], v[52:55]
    ds_read_b128 v[120:123], v12 offset:36864
    v_mfma_f32_16x16x32_bf16 v[84:87], a[68:71], v[148:151], v[84:87]
    s_waitcnt lgkmcnt(8)
    buffer_load_dwordx4 a[16:19], v8, s[12:15], s38 offen offset:1024 sc1
    v_mfma_f32_16x16x32_bf16 v[24:27], a[60:63], v[152:155], v[24:27]
    ds_read_b128 v[124:127], v12 offset:38912
    v_mfma_f32_16x16x32_bf16 v[56:59], a[64:67], v[152:155], v[56:59]
    v_mfma_f32_16x16x32_bf16 v[88:91], a[68:71], v[152:155], v[88:91]
    s_waitcnt lgkmcnt(8)
    v_mfma_f32_16x16x32_bf16 v[28:31], a[60:63], v[156:159], v[28:31]
    ds_read_b128 v[128:131], v12 offset:40960
    v_mfma_f32_16x16x32_bf16 v[60:63], a[64:67], v[156:159], v[60:63]
    buffer_load_dwordx4 a[20:23], v8, s[12:15], s38 offen offset:2048 sc1
    v_mfma_f32_16x16x32_bf16 v[92:95], a[68:71], v[156:159], v[92:95]
    s_waitcnt lgkmcnt(8)
    ds_read_b128 v[132:135], v12 offset:43008
    v_mfma_f32_16x16x32_bf16 v[32:35], a[60:63], v[160:163], v[32:35]
    v_mfma_f32_16x16x32_bf16 v[64:67], a[64:67], v[160:163], v[64:67]
    ds_read_b128 v[136:139], v12 offset:45056
    v_mfma_f32_16x16x32_bf16 v[96:99], a[68:71], v[160:163], v[96:99]
    s_waitcnt lgkmcnt(9)
    v_mfma_f32_16x16x32_bf16 v[36:39], a[60:63], v[164:167], v[36:39]
    ds_read_b128 v[140:143], v12 offset:47104
    v_mfma_f32_16x16x32_bf16 v[68:71], a[64:67], v[164:167], v[68:71]
    s_add_u32 s38, s38, s39
    s_cmp_eq_u32 s38, s63
    s_cselect_b32 s38, s62, s38
    v_mfma_f32_16x16x32_bf16 v[100:103], a[68:71], v[164:167], v[100:103]
    s_waitcnt lgkmcnt(9)
    v_mfma_f32_16x16x32_bf16 v[40:43], a[60:63], v[168:171], v[40:43]
    v_mfma_f32_16x16x32_bf16 v[72:75], a[64:67], v[168:171], v[72:75]
    v_mfma_f32_16x16x32_bf16 v[104:107], a[68:71], v[168:171], v[104:107]
    s_waitcnt lgkmcnt(8)
    v_mfma_f32_16x16x32_bf16 v[44:47], a[60:63], v[172:175], v[44:47]
    v_mfma_f32_16x16x32_bf16 v[76:79], a[64:67], v[172:175], v[76:79]
    v_mfma_f32_16x16x32_bf16 v[108:111], a[68:71], v[172:175], v[108:111]
    s_waitcnt vmcnt(17) lgkmcnt(7)
    v_mfma_f32_16x16x32_bf16 v[16:19], a[72:75], v[112:115], v[16:19]
    ds_read_b128 v[144:147], v13 offset:32768
    v_mfma_f32_16x16x32_bf16 v[48:51], a[76:79], v[112:115], v[48:51]
    buffer_load_dwordx4 a[24:27], v8, s[12:15], s38 offen offset:0 sc1
    v_mfma_f32_16x16x32_bf16 v[80:83], a[80:83], v[112:115], v[80:83]
    s_waitcnt lgkmcnt(7)
    ds_read_b128 v[148:151], v13 offset:34816
    v_mfma_f32_16x16x32_bf16 v[20:23], a[72:75], v[116:119], v[20:23]
    v_mfma_f32_16x16x32_bf16 v[52:55], a[76:79], v[116:119], v[52:55]
    ds_read_b128 v[152:155], v13 offset:36864
    v_mfma_f32_16x16x32_bf16 v[84:87], a[80:83], v[116:119], v[84:87]
    s_waitcnt lgkmcnt(8)
    buffer_load_dwordx4 a[28:31], v8, s[12:15], s38 offen offset:1024 sc1
    v_mfma_f32_16x16x32_bf16 v[24:27], a[72:75], v[120:123], v[24:27]
    ds_read_b128 v[156:159], v13 offset:38912
    v_mfma_f32_16x16x32_bf16 v[56:59], a[76:79], v[120:123], v[56:59]
    v_mfma_f32_16x16x32_bf16 v[88:91], a[80:83], v[120:123], v[88:91]
    s_waitcnt lgkmcnt(8)
    v_mfma_f32_16x16x32_bf16 v[28:31], a[72:75], v[124:127], v[28:31]
    ds_read_b128 v[160:163], v13 offset:40960
    v_mfma_f32_16x16x32_bf16 v[60:63], a[76:79], v[124:127], v[60:63]
    buffer_load_dwordx4 a[32:35], v8, s[12:15], s38 offen offset:2048 sc1
    v_mfma_f32_16x16x32_bf16 v[92:95], a[80:83], v[124:127], v[92:95]
    s_waitcnt lgkmcnt(8)
    ds_read_b128 v[164:167], v13 offset:43008
    v_mfma_f32_16x16x32_bf16 v[32:35], a[72:75], v[128:131], v[32:35]
    v_mfma_f32_16x16x32_bf16 v[64:67], a[76:79], v[128:131], v[64:67]
    ds_read_b128 v[168:171], v13 offset:45056
    v_mfma_f32_16x16x32_bf16 v[96:99], a[80:83], v[128:131], v[96:99]
    s_waitcnt lgkmcnt(9)
    v_mfma_f32_16x16x32_bf16 v[36:39], a[72:75], v[132:135], v[36:39]
    ds_read_b128 v[172:175], v13 offset:47104
    s_add_u32 s38, s38, s39
    v_mfma_f32_16x16x32_bf16 v[68:71], a[76:79], v[132:135], v[68:71]
    v_mfma_f32_16x16x32_bf16 v[100:103], a[80:83], v[132:135], v[100:103]
    s_waitcnt lgkmcnt(9)
    v_mfma_f32_16x16x32_bf16 v[40:43], a[72:75], v[136:139], v[40:43]
    v_mfma_f32_16x16x32_bf16 v[72:75], a[76:79], v[136:139], v[72:75]
    v_mfma_f32_16x16x32_bf16 v[104:107], a[80:83], v[136:139], v[104:107]
    s_waitcnt lgkmcnt(8)
    v_mfma_f32_16x16x32_bf16 v[44:47], a[72:75], v[140:143], v[44:47]
    v_mfma_f32_16x16x32_bf16 v[76:79], a[76:79], v[140:143], v[76:79]
    v_mfma_f32_16x16x32_bf16 v[108:111], a[80:83], v[140:143], v[108:111]
    s_waitcnt vmcnt(13) lgkmcnt(7)
    v_mfma_f32_16x16x32_bf16 v[16:19], a[84:87], v[144:147], v[16:19]
    s_barrier
    v_mfma_f32_16x16x32_bf16 v[48:51], a[88:91], v[144:147], v[48:51]
    ds_read_b128 v[112:115], v12 offset:49152
    v_mfma_f32_16x16x32_bf16 v[80:83], a[92:95], v[144:147], v[80:83]
    s_waitcnt lgkmcnt(7)
    buffer_load_dwordx4 a[36:39], v8, s[12:15], s38 offen offset:0 sc1
    v_mfma_f32_16x16x32_bf16 v[20:23], a[84:87], v[148:151], v[20:23]
    ds_read_b128 v[116:119], v12 offset:51200
    v_mfma_f32_16x16x32_bf16 v[52:55], a[88:91], v[148:151], v[52:55]
    v_mfma_f32_16x16x32_bf16 v[84:87], a[92:95], v[148:151], v[84:87]
    s_waitcnt lgkmcnt(7)
    ds_read_b128 v[120:123], v12 offset:53248
    v_mfma_f32_16x16x32_bf16 v[24:27], a[84:87], v[152:155], v[24:27]
    buffer_load_dwordx4 a[40:43], v8, s[12:15], s38 offen offset:1024 sc1
    v_mfma_f32_16x16x32_bf16 v[56:59], a[88:91], v[152:155], v[56:59]
    ds_read_b128 v[124:127], v12 offset:55296
    v_mfma_f32_16x16x32_bf16 v[88:91], a[92:95], v[152:155], v[88:91]
    s_waitcnt lgkmcnt(8)
    v_mfma_f32_16x16x32_bf16 v[28:31], a[84:87], v[156:159], v[28:31]
    ds_read_b128 v[128:131], v12 offset:57344
    v_mfma_f32_16x16x32_bf16 v[60:63], a[88:91], v[156:159], v[60:63]
    buffer_load_dwordx4 a[44:47], v8, s[12:15], s38 offen offset:2048 sc1
    v_mfma_f32_16x16x32_bf16 v[92:95], a[92:95], v[156:159], v[92:95]
    s_waitcnt lgkmcnt(8)
    ds_read_b128 v[132:135], v12 offset:59392
    v_mfma_f32_16x16x32_bf16 v[32:35], a[84:87], v[160:163], v[32:35]
    v_mfma_f32_16x16x32_bf16 v[64:67], a[88:91], v[160:163], v[64:67]
    ds_read_b128 v[136:139], v12 offset:61440
    v_mfma_f32_16x16x32_bf16 v[96:99], a[92:95], v[160:163], v[96:99]
    s_waitcnt lgkmcnt(9)
    v_mfma_f32_16x16x32_bf16 v[36:39], a[84:87], v[164:167], v[36:39]
    ds_read_b128 v[140:143], v12 offset:63488
    v_mfma_f32_16x16x32_bf16 v[68:71], a[88:91], v[164:167], v[68:71]
    s_add_u32 s38, s38, s39
    s_cmp_eq_u32 s38, s63
    s_cselect_b32 s38, s62, s38
    v_mfma_f32_16x16x32_bf16 v[100:103], a[92:95], v[164:167], v[100:103]
    s_waitcnt lgkmcnt(9)
    v_mfma_f32_16x16x32_bf16 v[40:43], a[84:87], v[168:171], v[40:43]
    v_mfma_f32_16x16x32_bf16 v[72:75], a[88:91], v[168:171], v[72:75]
    v_mfma_f32_16x16x32_bf16 v[104:107], a[92:95], v[168:171], v[104:107]
    s_waitcnt lgkmcnt(8)
    v_mfma_f32_16x16x32_bf16 v[44:47], a[84:87], v[172:175], v[44:47]
    v_mfma_f32_16x16x32_bf16 v[76:79], a[88:91], v[172:175], v[76:79]
    v_mfma_f32_16x16x32_bf16 v[108:111], a[92:95], v[172:175], v[108:111]
    s_waitcnt vmcnt(13) lgkmcnt(7)
    v_mfma_f32_16x16x32_bf16 v[16:19], a[0:3], v[112:115], v[16:19]
    ds_read_b128 v[144:147], v13 offset:49152
    v_mfma_f32_16x16x32_bf16 v[48:51], a[4:7], v[112:115], v[48:51]
    buffer_load_dwordx4 a[48:51], v8, s[12:15], s38 offen offset:0 sc1
    v_mfma_f32_16x16x32_bf16 v[80:83], a[8:11], v[112:115], v[80:83]
    s_waitcnt lgkmcnt(7)
    ds_read_b128 v[148:151], v13 offset:51200
    v_mfma_f32_16x16x32_bf16 v[20:23], a[0:3], v[116:119], v[20:23]
    v_mfma_f32_16x16x32_bf16 v[52:55], a[4:7], v[116:119], v[52:55]
    ds_read_b128 v[152:155], v13 offset:53248
    v_mfma_f32_16x16x32_bf16 v[84:87], a[8:11], v[116:119], v[84:87]
    s_waitcnt lgkmcnt(8)
    buffer_load_dwordx4 a[52:55], v8, s[12:15], s38 offen offset:1024 sc1
    v_mfma_f32_16x16x32_bf16 v[24:27], a[0:3], v[120:123], v[24:27]
    ds_read_b128 v[156:159], v13 offset:55296
    v_mfma_f32_16x16x32_bf16 v[56:59], a[4:7], v[120:123], v[56:59]
    v_mfma_f32_16x16x32_bf16 v[88:91], a[8:11], v[120:123], v[88:91]
    s_waitcnt lgkmcnt(8)
    v_mfma_f32_16x16x32_bf16 v[28:31], a[0:3], v[124:127], v[28:31]
    ds_read_b128 v[160:163], v13 offset:57344
    v_mfma_f32_16x16x32_bf16 v[60:63], a[4:7], v[124:127], v[60:63]
    buffer_load_dwordx4 a[56:59], v8, s[12:15], s38 offen offset:2048 sc1
    v_mfma_f32_16x16x32_bf16 v[92:95], a[8:11], v[124:127], v[92:95]
    s_waitcnt lgkmcnt(8)
    ds_read_b128 v[164:167], v13 offset:59392
    v_mfma_f32_16x16x32_bf16 v[32:35], a[0:3], v[128:131], v[32:35]
    v_mfma_f32_16x16x32_bf16 v[64:67], a[4:7], v[128:131], v[64:67]
    ds_read_b128 v[168:171], v13 offset:61440
    v_mfma_f32_16x16x32_bf16 v[96:99], a[8:11], v[128:131], v[96:99]
    s_waitcnt lgkmcnt(9)
    v_mfma_f32_16x16x32_bf16 v[36:39], a[0:3], v[132:135], v[36:39]
    ds_read_b128 v[172:175], v13 offset:63488
    s_add_u32 s38, s38, s39
    v_mfma_f32_16x16x32_bf16 v[68:71], a[4:7], v[132:135], v[68:71]
    v_mfma_f32_16x16x32_bf16 v[100:103], a[8:11], v[132:135], v[100:103]
    s_waitcnt lgkmcnt(9)
    v_mfma_f32_16x16x32_bf16 v[40:43], a[0:3], v[136:139], v[40:43]
    v_mfma_f32_16x16x32_bf16 v[72:75], a[4:7], v[136:139], v[72:75]
    v_mfma_f32_16x16x32_bf16 v[104:107], a[8:11], v[136:139], v[104:107]
    s_waitcnt lgkmcnt(8)
    v_mfma_f32_16x16x32_bf16 v[44:47], a[0:3], v[140:143], v[44:47]
    v_mfma_f32_16x16x32_bf16 v[76:79], a[4:7], v[140:143], v[76:79]
    v_mfma_f32_16x16x32_bf16 v[108:111], a[8:11], v[140:143], v[108:111]
    s_waitcnt vmcnt(9) lgkmcnt(7)
    v_mfma_f32_16x16x32_bf16 v[16:19], a[12:15], v[144:147], v[16:19]
    ds_read_b128 v[112:115], v14 offset:0
    v_mfma_f32_16x16x32_bf16 v[48:51], a[16:19], v[144:147], v[48:51]
    buffer_load_dwordx4 a[60:63], v8, s[12:15], s38 offen offset:0 sc1
    v_mfma_f32_16x16x32_bf16 v[80:83], a[20:23], v[144:147], v[80:83]
    s_waitcnt lgkmcnt(7)
    ds_read_b128 v[116:119], v14 offset:2048
    v_mfma_f32_16x16x32_bf16 v[20:23], a[12:15], v[148:151], v[20:23]
    v_mfma_f32_16x16x32_bf16 v[52:55], a[16:19], v[148:151], v[52:55]
    ds_read_b128 v[120:123], v14 offset:4096
    v_mfma_f32_16x16x32_bf16 v[84:87], a[20:23], v[148:151], v[84:87]
    s_waitcnt lgkmcnt(8)
    buffer_load_dwordx4 a[64:67], v8, s[12:15], s38 offen offset:1024 sc1
    v_mfma_f32_16x16x32_bf16 v[24:27], a[12:15], v[152:155], v[24:27]
    ds_read_b128 v[124:127], v14 offset:6144
    v_mfma_f32_16x16x32_bf16 v[56:59], a[16:19], v[152:155], v[56:59]
    v_mfma_f32_16x16x32_bf16 v[88:91], a[20:23], v[152:155], v[88:91]
    s_waitcnt lgkmcnt(8)
    v_mfma_f32_16x16x32_bf16 v[28:31], a[12:15], v[156:159], v[28:31]
    ds_read_b128 v[128:131], v14 offset:8192
    v_mfma_f32_16x16x32_bf16 v[60:63], a[16:19], v[156:159], v[60:63]
    buffer_load_dwordx4 a[68:71], v8, s[12:15], s38 offen offset:2048 sc1
    v_mfma_f32_16x16x32_bf16 v[92:95], a[20:23], v[156:159], v[92:95]
    s_waitcnt lgkmcnt(8)
    ds_read_b128 v[132:135], v14 offset:10240
    v_mfma_f32_16x16x32_bf16 v[32:35], a[12:15], v[160:163], v[32:35]
    v_mfma_f32_16x16x32_bf16 v[64:67], a[16:19], v[160:163], v[64:67]
    ds_read_b128 v[136:139], v14 offset:12288
    v_mfma_f32_16x16x32_bf16 v[96:99], a[20:23], v[160:163], v[96:99]
    s_waitcnt lgkmcnt(9)
    v_mfma_f32_16x16x32_bf16 v[36:39], a[12:15], v[164:167], v[36:39]
    ds_read_b128 v[140:143], v14 offset:14336
    v_mfma_f32_16x16x32_bf16 v[68:71], a[16:19], v[164:167], v[68:71]
    s_add_u32 s38, s38, s39
    s_cmp_eq_u32 s38, s63
    s_cselect_b32 s38, s62, s38
    v_mfma_f32_16x16x32_bf16 v[100:103], a[20:23], v[164:167], v[100:103]
    s_waitcnt lgkmcnt(9)
    v_mfma_f32_16x16x32_bf16 v[40:43], a[12:15], v[168:171], v[40:43]
    v_mfma_f32_16x16x32_bf16 v[72:75], a[16:19], v[168:171], v[72:75]
    v_mfma_f32_16x16x32_bf16 v[104:107], a[20:23], v[168:171], v[104:107]
    s_waitcnt lgkmcnt(8)
    v_mfma_f32_16x16x32_bf16 v[44:47], a[12:15], v[172:175], v[44:47]
    v_mfma_f32_16x16x32_bf16 v[76:79], a[16:19], v[172:175], v[76:79]
    v_mfma_f32_16x16x32_bf16 v[108:111], a[20:23], v[172:175], v[108:111]
    s_waitcnt vmcnt(9) lgkmcnt(7)
    v_mfma_f32_16x16x32_bf16 v[16:19], a[24:27], v[112:115], v[16:19]
    ds_read_b128 v[144:147], v15 offset:0
    v_mfma_f32_16x16x32_bf16 v[48:51], a[28:31], v[112:115], v[48:51]
    buffer_load_dwordx4 a[72:75], v8, s[12:15], s38 offen offset:0 sc1
    v_mfma_f32_16x16x32_bf16 v[80:83], a[32:35], v[112:115], v[80:83]
    s_waitcnt lgkmcnt(7)
    ds_read_b128 v[148:151], v15 offset:2048
    v_mfma_f32_16x16x32_bf16 v[20:23], a[24:27], v[116:119], v[20:23]
    buffer_load_dwordx4 a[76:79], v8, s[12:15], s38 offen offset:1024 sc1
    v_mfma_f32_16x16x32_bf16 v[52:55], a[28:31], v[116:119], v[52:55]
    ds_read_b128 v[152:155], v15 offset:4096
    v_mfma_f32_16x16x32_bf16 v[84:87], a[32:35], v[116:119], v[84:87]
    s_waitcnt lgkmcnt(8)
    v_mfma_f32_16x16x32_bf16 v[24:27], a[24:27], v[120:123], v[24:27]
    ds_read_b128 v[156:159], v15 offset:6144
    v_mfma_f32_16x16x32_bf16 v[56:59], a[28:31], v[120:123], v[56:59]
    buffer_load_dwordx4 a[80:83], v8, s[12:15], s38 offen offset:2048 sc1
    v_mfma_f32_16x16x32_bf16 v[88:91], a[32:35], v[120:123], v[88:91]
    s_waitcnt lgkmcnt(8)
    v_mfma_f32_16x16x32_bf16 v[28:31], a[24:27], v[124:127], v[28:31]
    ds_read_b128 v[160:163], v15 offset:8192
    s_add_u32 s38, s38, s39
    v_mfma_f32_16x16x32_bf16 v[60:63], a[28:31], v[124:127], v[60:63]
    v_mfma_f32_16x16x32_bf16 v[92:95], a[32:35], v[124:127], v[92:95]
    s_waitcnt lgkmcnt(8)
    ds_read_b128 v[164:167], v15 offset:10240
    v_mfma_f32_16x16x32_bf16 v[32:35], a[24:27], v[128:131], v[32:35]
    buffer_load_dwordx4 a[84:87], v8, s[12:15], s38 offen offset:0 sc1
    v_mfma_f32_16x16x32_bf16 v[64:67], a[28:31], v[128:131], v[64:67]
    ds_read_b128 v[168:171], v15 offset:12288
    v_mfma_f32_16x16x32_bf16 v[96:99], a[32:35], v[128:131], v[96:99]
    s_waitcnt lgkmcnt(9)
    v_mfma_f32_16x16x32_bf16 v[36:39], a[24:27], v[132:135], v[36:39]
    ds_read_b128 v[172:175], v15 offset:14336
    v_mfma_f32_16x16x32_bf16 v[68:71], a[28:31], v[132:135], v[68:71]
    buffer_load_dwordx4 a[88:91], v8, s[12:15], s38 offen offset:1024 sc1
    v_mfma_f32_16x16x32_bf16 v[100:103], a[32:35], v[132:135], v[100:103]
    s_waitcnt lgkmcnt(9)
    v_mfma_f32_16x16x32_bf16 v[40:43], a[24:27], v[136:139], v[40:43]
    buffer_load_dwordx4 a[92:95], v8, s[12:15], s38 offen offset:2048 sc1
    v_mfma_f32_16x16x32_bf16 v[72:75], a[28:31], v[136:139], v[72:75]
    v_mfma_f32_16x16x32_bf16 v[104:107], a[32:35], v[136:139], v[104:107]
    s_waitcnt lgkmcnt(8)
    v_mfma_f32_16x16x32_bf16 v[44:47], a[24:27], v[140:143], v[44:47]
    s_add_u32 s38, s38, s39
    s_cmp_eq_u32 s38, s63
    s_cselect_b32 s38, s62, s38
    v_mfma_f32_16x16x32_bf16 v[76:79], a[28:31], v[140:143], v[76:79]
    v_mfma_f32_16x16x32_bf16 v[108:111], a[32:35], v[140:143], v[108:111]
    s_waitcnt vmcnt(12) lgkmcnt(7)
    v_mfma_f32_16x16x32_bf16 v[16:19], a[36:39], v[144:147], v[16:19]
    s_waitcnt lgkmcnt(0)
    s_barrier
    v_mfma_f32_16x16x32_bf16 v[48:51], a[40:43], v[144:147], v[48:51]
    ds_read_b128 v[112:115], v14 offset:16384
    v_mfma_f32_16x16x32_bf16 v[80:83], a[44:47], v[144:147], v[80:83]
    buffer_load_dwordx4 a[0:3], v8, s[12:15], s38 offen offset:0 sc1
    v_mfma_f32_16x16x32_bf16 v[20:23], a[36:39], v[148:151], v[20:23]
    ds_read_b128 v[116:119], v14 offset:18432
    v_mfma_f32_16x16x32_bf16 v[52:55], a[40:43], v[148:151], v[52:55]
    buffer_load_dwordx4 a[4:7], v8, s[12:15], s38 offen offset:1024 sc1
    v_mfma_f32_16x16x32_bf16 v[84:87], a[44:47], v[148:151], v[84:87]
    ds_read_b128 v[120:123], v14 offset:20480
    v_mfma_f32_16x16x32_bf16 v[24:27], a[36:39], v[152:155], v[24:27]
    buffer_load_dwordx4 a[8:11], v8, s[12:15], s38 offen offset:2048 sc1
    v_mfma_f32_16x16x32_bf16 v[56:59], a[40:43], v[152:155], v[56:59]
    ds_read_b128 v[124:127], v14 offset:22528
    v_mfma_f32_16x16x32_bf16 v[88:91], a[44:47], v[152:155], v[88:91]
    v_mfma_f32_16x16x32_bf16 v[28:31], a[36:39], v[156:159], v[28:31]
    ds_read_b128 v[128:131], v14 offset:24576
    s_add_u32 s38, s38, s39
    v_mfma_f32_16x16x32_bf16 v[60:63], a[40:43], v[156:159], v[60:63]
    v_mfma_f32_16x16x32_bf16 v[92:95], a[44:47], v[156:159], v[92:95]
    ds_read_b128 v[132:135], v14 offset:26624
    v_mfma_f32_16x16x32_bf16 v[32:35], a[36:39], v[160:163], v[32:35]
    buffer_load_dwordx4 a[12:15], v8, s[12:15], s38 offen offset:0 sc1
    v_mfma_f32_16x16x32_bf16 v[64:67], a[40:43], v[160:163], v[64:67]
    ds_read_b128 v[136:139], v14 offset:28672
    v_mfma_f32_16x16x32_bf16 v[96:99], a[44:47], v[160:163], v[96:99]
    v_mfma_f32_16x16x32_bf16 v[36:39], a[36:39], v[164:167], v[36:39]
    ds_read_b128 v[140:143], v14 offset:30720
    v_mfma_f32_16x16x32_bf16 v[68:71], a[40:43], v[164:167], v[68:71]
    buffer_load_dwordx4 a[16:19], v8, s[12:15], s38 offen offset:1024 sc1
    v_mfma_f32_16x16x32_bf16 v[100:103], a[44:47], v[164:167], v[100:103]
    v_mfma_f32_16x16x32_bf16 v[40:43], a[36:39], v[168:171], v[40:43]
    buffer_load_dwordx4 a[20:23], v8, s[12:15], s38 offen offset:2048 sc1
    v_mfma_f32_16x16x32_bf16 v[72:75], a[40:43], v[168:171], v[72:75]
    v_mfma_f32_16x16x32_bf16 v[104:107], a[44:47], v[168:171], v[104:107]
    v_mfma_f32_16x16x32_bf16 v[44:47], a[36:39], v[172:175], v[44:47]
    s_add_u32 s38, s38, s39
    s_cmp_eq_u32 s38, s63
    s_cselect_b32 s38, s62, s38
    v_mfma_f32_16x16x32_bf16 v[76:79], a[40:43], v[172:175], v[76:79]
    v_mfma_f32_16x16x32_bf16 v[108:111], a[44:47], v[172:175], v[108:111]
    s_waitcnt vmcnt(15) lgkmcnt(7)
    v_mfma_f32_16x16x32_bf16 v[16:19], a[48:51], v[112:115], v[16:19]
    ds_read_b128 v[144:147], v15 offset:16384
    v_mfma_f32_16x16x32_bf16 v[48:51], a[52:55], v[112:115], v[48:51]
    s_getpc_b64 s[56:57]
fnet_glu_kernel_pc_10:
    s_sub_u32 s56, s56, fnet_glu_kernel_pc_10-Lfnet_glu_kernel_beg
    s_subb_u32 s57, s57, 0
    v_mov_b32 v181, s57
    v_mov_b32 v180, s2
    v_bfe_u32 v180, v180, 3, 3
    v_lshl_add_u32 v180, v180, 2, s3
    v_and_b32 v182, 15, v0
    v_lshl_add_u32 v180, v180, 4, v182
    v_lshlrev_b32 v180, 7, v180
    v_min_u32 v180, fnet_glu_kernel_end-Lfnet_glu_kernel_beg, v180
    v_add_co_u32 v180, vcc, s56, v180
    v_addc_co_u32 v181, vcc, 0, v181, vcc
    global_load_dword v205, v[180:181], off
    v_mfma_f32_16x16x32_bf16 v[80:83], a[56:59], v[112:115], v[80:83]
    s_waitcnt lgkmcnt(7)
    ds_read_b128 v[148:151], v15 offset:18432
    v_mfma_f32_16x16x32_bf16 v[20:23], a[48:51], v[116:119], v[20:23]
    v_mfma_f32_16x16x32_bf16 v[52:55], a[52:55], v[116:119], v[52:55]
    ds_read_b128 v[152:155], v15 offset:20480
    v_mfma_f32_16x16x32_bf16 v[84:87], a[56:59], v[116:119], v[84:87]
    s_waitcnt lgkmcnt(8)
    v_mfma_f32_16x16x32_bf16 v[24:27], a[48:51], v[120:123], v[24:27]
    ds_read_b128 v[156:159], v15 offset:22528
    v_mfma_f32_16x16x32_bf16 v[56:59], a[52:55], v[120:123], v[56:59]
    v_mfma_f32_16x16x32_bf16 v[88:91], a[56:59], v[120:123], v[88:91]
    s_waitcnt lgkmcnt(8)
    v_mfma_f32_16x16x32_bf16 v[28:31], a[48:51], v[124:127], v[28:31]
    ds_read_b128 v[160:163], v15 offset:24576
    v_mfma_f32_16x16x32_bf16 v[60:63], a[52:55], v[124:127], v[60:63]
    v_mfma_f32_16x16x32_bf16 v[92:95], a[56:59], v[124:127], v[92:95]
    s_waitcnt lgkmcnt(8)
    ds_read_b128 v[164:167], v15 offset:26624
    v_mfma_f32_16x16x32_bf16 v[32:35], a[48:51], v[128:131], v[32:35]
    v_mfma_f32_16x16x32_bf16 v[64:67], a[52:55], v[128:131], v[64:67]
    ds_read_b128 v[168:171], v15 offset:28672
    v_mfma_f32_16x16x32_bf16 v[96:99], a[56:59], v[128:131], v[96:99]
    s_waitcnt lgkmcnt(9)
    v_mfma_f32_16x16x32_bf16 v[36:39], a[48:51], v[132:135], v[36:39]
    ds_read_b128 v[172:175], v15 offset:30720
    v_mfma_f32_16x16x32_bf16 v[68:71], a[52:55], v[132:135], v[68:71]
    v_mfma_f32_16x16x32_bf16 v[100:103], a[56:59], v[132:135], v[100:103]
    s_waitcnt lgkmcnt(9)
    v_mfma_f32_16x16x32_bf16 v[40:43], a[48:51], v[136:139], v[40:43]
    v_mfma_f32_16x16x32_bf16 v[72:75], a[52:55], v[136:139], v[72:75]
    v_mfma_f32_16x16x32_bf16 v[104:107], a[56:59], v[136:139], v[104:107]
    s_waitcnt lgkmcnt(8)
    v_mfma_f32_16x16x32_bf16 v[44:47], a[48:51], v[140:143], v[44:47]
    v_mfma_f32_16x16x32_bf16 v[76:79], a[52:55], v[140:143], v[76:79]
    v_mfma_f32_16x16x32_bf16 v[108:111], a[56:59], v[140:143], v[108:111]
    s_waitcnt vmcnt(13) lgkmcnt(7)
    v_mfma_f32_16x16x32_bf16 v[16:19], a[60:63], v[144:147], v[16:19]
    ds_read_b128 v[112:115], v10 offset:0
    v_mfma_f32_16x16x32_bf16 v[48:51], a[64:67], v[144:147], v[48:51]
    v_mfma_f32_16x16x32_bf16 v[80:83], a[68:71], v[144:147], v[80:83]
    s_waitcnt lgkmcnt(7)
    ds_read_b128 v[116:119], v10 offset:2048
    v_mfma_f32_16x16x32_bf16 v[20:23], a[60:63], v[148:151], v[20:23]
    v_mfma_f32_16x16x32_bf16 v[52:55], a[64:67], v[148:151], v[52:55]
    ds_read_b128 v[120:123], v11 offset:0
    v_mfma_f32_16x16x32_bf16 v[84:87], a[68:71], v[148:151], v[84:87]
    s_waitcnt lgkmcnt(8)
    v_mfma_f32_16x16x32_bf16 v[24:27], a[60:63], v[152:155], v[24:27]
    ds_read_b128 v[124:127], v11 offset:2048
    v_mfma_f32_16x16x32_bf16 v[56:59], a[64:67], v[152:155], v[56:59]
    v_mfma_f32_16x16x32_bf16 v[88:91], a[68:71], v[152:155], v[88:91]
    s_waitcnt lgkmcnt(8)
    v_mfma_f32_16x16x32_bf16 v[28:31], a[60:63], v[156:159], v[28:31]
    ds_read_b128 v[128:131], v10 offset:16384
    v_mfma_f32_16x16x32_bf16 v[60:63], a[64:67], v[156:159], v[60:63]
    v_mfma_f32_16x16x32_bf16 v[92:95], a[68:71], v[156:159], v[92:95]
    s_waitcnt lgkmcnt(8)
    ds_read_b128 v[132:135], v10 offset:18432
    v_mfma_f32_16x16x32_bf16 v[32:35], a[60:63], v[160:163], v[32:35]
    v_mfma_f32_16x16x32_bf16 v[64:67], a[64:67], v[160:163], v[64:67]
    ds_read_b128 v[136:139], v11 offset:16384
    v_mfma_f32_16x16x32_bf16 v[96:99], a[68:71], v[160:163], v[96:99]
    s_waitcnt lgkmcnt(9)
    v_mfma_f32_16x16x32_bf16 v[36:39], a[60:63], v[164:167], v[36:39]
    ds_read_b128 v[140:143], v11 offset:18432
    v_mfma_f32_16x16x32_bf16 v[68:71], a[64:67], v[164:167], v[68:71]
    v_mfma_f32_16x16x32_bf16 v[100:103], a[68:71], v[164:167], v[100:103]
    s_waitcnt lgkmcnt(9)
    v_mfma_f32_16x16x32_bf16 v[40:43], a[60:63], v[168:171], v[40:43]
    v_mfma_f32_16x16x32_bf16 v[72:75], a[64:67], v[168:171], v[72:75]
    v_mfma_f32_16x16x32_bf16 v[104:107], a[68:71], v[168:171], v[104:107]
    s_waitcnt lgkmcnt(8)
    v_mfma_f32_16x16x32_bf16 v[44:47], a[60:63], v[172:175], v[44:47]
    v_mfma_f32_16x16x32_bf16 v[76:79], a[64:67], v[172:175], v[76:79]
    v_mfma_f32_16x16x32_bf16 v[108:111], a[68:71], v[172:175], v[108:111]
    s_waitcnt vmcnt(10) lgkmcnt(7)
    v_mfma_f32_16x16x32_bf16 v[16:19], a[72:75], v[112:115], v[16:19]
    ds_read_b128 v[144:147], v10 offset:4096
    v_mfma_f32_16x16x32_bf16 v[48:51], a[76:79], v[112:115], v[48:51]
    v_mfma_f32_16x16x32_bf16 v[80:83], a[80:83], v[112:115], v[80:83]
    s_waitcnt lgkmcnt(7)
    ds_read_b128 v[148:151], v10 offset:6144
    v_mfma_f32_16x16x32_bf16 v[20:23], a[72:75], v[116:119], v[20:23]
    v_mfma_f32_16x16x32_bf16 v[52:55], a[76:79], v[116:119], v[52:55]
    ds_read_b128 v[152:155], v11 offset:4096
    v_mfma_f32_16x16x32_bf16 v[84:87], a[80:83], v[116:119], v[84:87]
    s_waitcnt vmcnt(7) lgkmcnt(8)
    v_mfma_f32_16x16x32_bf16 v[16:19], a[84:87], v[120:123], v[16:19]
    ds_read_b128 v[156:159], v11 offset:6144
    v_mfma_f32_16x16x32_bf16 v[48:51], a[88:91], v[120:123], v[48:51]
    v_mfma_f32_16x16x32_bf16 v[80:83], a[92:95], v[120:123], v[80:83]
    s_waitcnt lgkmcnt(8)
    v_mfma_f32_16x16x32_bf16 v[20:23], a[84:87], v[124:127], v[20:23]
    ds_read_b128 v[160:163], v10 offset:20480
    v_mfma_f32_16x16x32_bf16 v[52:55], a[88:91], v[124:127], v[52:55]
    v_mfma_f32_16x16x32_bf16 v[84:87], a[92:95], v[124:127], v[84:87]
    s_waitcnt vmcnt(4) lgkmcnt(8)
    ds_read_b128 v[164:167], v10 offset:22528
    v_mfma_f32_16x16x32_bf16 v[16:19], a[0:3], v[128:131], v[16:19]
    v_mfma_f32_16x16x32_bf16 v[48:51], a[4:7], v[128:131], v[48:51]
    ds_read_b128 v[168:171], v11 offset:20480
    v_mfma_f32_16x16x32_bf16 v[80:83], a[8:11], v[128:131], v[80:83]
    s_waitcnt lgkmcnt(9)
    v_mfma_f32_16x16x32_bf16 v[20:23], a[0:3], v[132:135], v[20:23]
    ds_read_b128 v[172:175], v11 offset:22528
    v_mfma_f32_16x16x32_bf16 v[52:55], a[4:7], v[132:135], v[52:55]
    v_mfma_f32_16x16x32_bf16 v[84:87], a[8:11], v[132:135], v[84:87]
    s_waitcnt vmcnt(1) lgkmcnt(9)
    v_mfma_f32_16x16x32_bf16 v[16:19], a[12:15], v[136:139], v[16:19]
    v_mfma_f32_16x16x32_bf16 v[48:51], a[16:19], v[136:139], v[48:51]
    v_mfma_f32_16x16x32_bf16 v[80:83], a[20:23], v[136:139], v[80:83]
    s_waitcnt lgkmcnt(8)
    v_mfma_f32_16x16x32_bf16 v[20:23], a[12:15], v[140:143], v[20:23]
    v_mfma_f32_16x16x32_bf16 v[52:55], a[16:19], v[140:143], v[52:55]
    v_mfma_f32_16x16x32_bf16 v[84:87], a[20:23], v[140:143], v[84:87]
    s_waitcnt lgkmcnt(7)
    v_mfma_f32_16x16x32_bf16 v[24:27], a[72:75], v[144:147], v[24:27]
    ds_read_b128 v[112:115], v10 offset:8192
    v_mfma_f32_16x16x32_bf16 v[56:59], a[76:79], v[144:147], v[56:59]
    v_mfma_f32_16x16x32_bf16 v[88:91], a[80:83], v[144:147], v[88:91]
    s_waitcnt lgkmcnt(7)
    ds_read_b128 v[116:119], v10 offset:10240
    v_mfma_f32_16x16x32_bf16 v[28:31], a[72:75], v[148:151], v[28:31]
    v_mfma_f32_16x16x32_bf16 v[60:63], a[76:79], v[148:151], v[60:63]
    ds_read_b128 v[120:123], v11 offset:8192
    v_cvt_pk_bf16_f32 v16, v16, v17
    v_mfma_f32_16x16x32_bf16 v[92:95], a[80:83], v[148:151], v[92:95]
    s_waitcnt lgkmcnt(8)
    v_cvt_pk_bf16_f32 v17, v18, v19
    v_mfma_f32_16x16x32_bf16 v[24:27], a[84:87], v[152:155], v[24:27]
    ds_read_b128 v[124:127], v11 offset:10240
    v_cvt_pk_bf16_f32 v18, v20, v21
    v_mfma_f32_16x16x32_bf16 v[56:59], a[88:91], v[152:155], v[56:59]
    v_cvt_pk_bf16_f32 v19, v22, v23
    v_mfma_f32_16x16x32_bf16 v[88:91], a[92:95], v[152:155], v[88:91]
    s_waitcnt lgkmcnt(8)
    v_permlane16_swap_b32 v16, v18
    v_mfma_f32_16x16x32_bf16 v[28:31], a[84:87], v[156:159], v[28:31]
    ds_read_b128 v[128:131], v10 offset:24576
    v_permlane16_swap_b32 v17, v19
    v_mfma_f32_16x16x32_bf16 v[60:63], a[88:91], v[156:159], v[60:63]
    buffer_store_dwordx4 v[16:19], v8, s[16:19], s40 offen offset:0 sc1
    v_mfma_f32_16x16x32_bf16 v[92:95], a[92:95], v[156:159], v[92:95]
    s_waitcnt lgkmcnt(8)
    ds_read_b128 v[132:135], v10 offset:26624
    v_mfma_f32_16x16x32_bf16 v[24:27], a[0:3], v[160:163], v[24:27]
    v_cvt_pk_bf16_f32 v48, v48, v49
    v_mfma_f32_16x16x32_bf16 v[56:59], a[4:7], v[160:163], v[56:59]
    ds_read_b128 v[136:139], v11 offset:24576
    v_cvt_pk_bf16_f32 v49, v50, v51
    v_mfma_f32_16x16x32_bf16 v[88:91], a[8:11], v[160:163], v[88:91]
    s_waitcnt lgkmcnt(9)
    v_cvt_pk_bf16_f32 v50, v52, v53
    v_mfma_f32_16x16x32_bf16 v[28:31], a[0:3], v[164:167], v[28:31]
    ds_read_b128 v[140:143], v11 offset:26624
    v_cvt_pk_bf16_f32 v51, v54, v55
    v_mfma_f32_16x16x32_bf16 v[60:63], a[4:7], v[164:167], v[60:63]
    v_permlane16_swap_b32 v48, v50
    v_mfma_f32_16x16x32_bf16 v[92:95], a[8:11], v[164:167], v[92:95]
    s_waitcnt lgkmcnt(9)
    v_permlane16_swap_b32 v49, v51
    v_mfma_f32_16x16x32_bf16 v[24:27], a[12:15], v[168:171], v[24:27]
    buffer_store_dwordx4 v[48:51], v8, s[16:19], s40 offen offset:1024 sc1
    v_mfma_f32_16x16x32_bf16 v[56:59], a[16:19], v[168:171], v[56:59]
    v_mfma_f32_16x16x32_bf16 v[88:91], a[20:23], v[168:171], v[88:91]
    s_waitcnt lgkmcnt(8)
    v_cvt_pk_bf16_f32 v80, v80, v81
    v_mfma_f32_16x16x32_bf16 v[28:31], a[12:15], v[172:175], v[28:31]
    v_cvt_pk_bf16_f32 v81, v82, v83
    v_mfma_f32_16x16x32_bf16 v[60:63], a[16:19], v[172:175], v[60:63]
    v_cvt_pk_bf16_f32 v82, v84, v85
    v_mfma_f32_16x16x32_bf16 v[92:95], a[20:23], v[172:175], v[92:95]
    s_waitcnt lgkmcnt(7)
    v_cvt_pk_bf16_f32 v83, v86, v87
    v_mfma_f32_16x16x32_bf16 v[32:35], a[72:75], v[112:115], v[32:35]
    ds_read_b128 v[144:147], v10 offset:12288
    v_permlane16_swap_b32 v80, v82
    v_mfma_f32_16x16x32_bf16 v[64:67], a[76:79], v[112:115], v[64:67]
    v_permlane16_swap_b32 v81, v83
    v_mfma_f32_16x16x32_bf16 v[96:99], a[80:83], v[112:115], v[96:99]
    s_waitcnt lgkmcnt(7)
    ds_read_b128 v[148:151], v10 offset:14336
    v_mfma_f32_16x16x32_bf16 v[36:39], a[72:75], v[116:119], v[36:39]
    buffer_store_dwordx4 v[80:83], v8, s[16:19], s40 offen offset:2048 sc1
    v_mfma_f32_16x16x32_bf16 v[68:71], a[76:79], v[116:119], v[68:71]
    ds_read_b128 v[152:155], v11 offset:12288
    v_cvt_pk_bf16_f32 v24, v24, v25
    v_mfma_f32_16x16x32_bf16 v[100:103], a[80:83], v[116:119], v[100:103]
    s_waitcnt lgkmcnt(8)
    v_cvt_pk_bf16_f32 v25, v26, v27
    v_mfma_f32_16x16x32_bf16 v[32:35], a[84:87], v[120:123], v[32:35]
    ds_read_b128 v[156:159], v11 offset:14336
    v_cvt_pk_bf16_f32 v26, v28, v29
    v_mfma_f32_16x16x32_bf16 v[64:67], a[88:91], v[120:123], v[64:67]
    v_cvt_pk_bf16_f32 v27, v30, v31
    v_mfma_f32_16x16x32_bf16 v[96:99], a[92:95], v[120:123], v[96:99]
    s_waitcnt lgkmcnt(8)
    v_permlane16_swap_b32 v24, v26
    v_mfma_f32_16x16x32_bf16 v[36:39], a[84:87], v[124:127], v[36:39]
    ds_read_b128 v[160:163], v10 offset:28672
    v_permlane16_swap_b32 v25, v27
    v_mfma_f32_16x16x32_bf16 v[68:71], a[88:91], v[124:127], v[68:71]
    buffer_store_dwordx4 v[24:27], v8, s[16:19], s41 offen offset:0 sc1
    v_mfma_f32_16x16x32_bf16 v[100:103], a[92:95], v[124:127], v[100:103]
    s_waitcnt lgkmcnt(8)
    ds_read_b128 v[164:167], v10 offset:30720
    v_mfma_f32_16x16x32_bf16 v[32:35], a[0:3], v[128:131], v[32:35]
    v_cvt_pk_bf16_f32 v56, v56, v57
    v_mfma_f32_16x16x32_bf16 v[64:67], a[4:7], v[128:131], v[64:67]
    ds_read_b128 v[168:171], v11 offset:28672
    v_cvt_pk_bf16_f32 v57, v58, v59
    v_mfma_f32_16x16x32_bf16 v[96:99], a[8:11], v[128:131], v[96:99]
    s_waitcnt lgkmcnt(9)
    v_cvt_pk_bf16_f32 v58, v60, v61
    v_mfma_f32_16x16x32_bf16 v[36:39], a[0:3], v[132:135], v[36:39]
    ds_read_b128 v[172:175], v11 offset:30720
    v_cvt_pk_bf16_f32 v59, v62, v63
    v_mfma_f32_16x16x32_bf16 v[68:71], a[4:7], v[132:135], v[68:71]
    v_permlane16_swap_b32 v56, v58
    v_mfma_f32_16x16x32_bf16 v[100:103], a[8:11], v[132:135], v[100:103]
    s_waitcnt lgkmcnt(9)
    v_permlane16_swap_b32 v57, v59
    v_mfma_f32_16x16x32_bf16 v[32:35], a[12:15], v[136:139], v[32:35]
    buffer_store_dwordx4 v[56:59], v8, s[16:19], s41 offen offset:1024 sc1
    v_mfma_f32_16x16x32_bf16 v[64:67], a[16:19], v[136:139], v[64:67]
    v_mfma_f32_16x16x32_bf16 v[96:99], a[20:23], v[136:139], v[96:99]
    s_waitcnt lgkmcnt(8)
    v_cvt_pk_bf16_f32 v88, v88, v89
    v_mfma_f32_16x16x32_bf16 v[36:39], a[12:15], v[140:143], v[36:39]
    v_cvt_pk_bf16_f32 v89, v90, v91
    v_mfma_f32_16x16x32_bf16 v[68:71], a[16:19], v[140:143], v[68:71]
    v_cvt_pk_bf16_f32 v90, v92, v93
    v_mfma_f32_16x16x32_bf16 v[100:103], a[20:23], v[140:143], v[100:103]
    s_waitcnt lgkmcnt(7)
    v_cvt_pk_bf16_f32 v91, v94, v95
    v_mfma_f32_16x16x32_bf16 v[40:43], a[72:75], v[144:147], v[40:43]
    v_permlane16_swap_b32 v88, v90
    v_mfma_f32_16x16x32_bf16 v[72:75], a[76:79], v[144:147], v[72:75]
    v_permlane16_swap_b32 v89, v91
    v_mfma_f32_16x16x32_bf16 v[104:107], a[80:83], v[144:147], v[104:107]
    s_waitcnt lgkmcnt(6)
    buffer_store_dwordx4 v[88:91], v8, s[16:19], s41 offen offset:2048 sc1
    v_mfma_f32_16x16x32_bf16 v[44:47], a[72:75], v[148:151], v[44:47]
    v_mfma_f32_16x16x32_bf16 v[76:79], a[76:79], v[148:151], v[76:79]
    v_cvt_pk_bf16_f32 v32, v32, v33
    v_mfma_f32_16x16x32_bf16 v[108:111], a[80:83], v[148:151], v[108:111]
    s_waitcnt lgkmcnt(5)
    v_cvt_pk_bf16_f32 v33, v34, v35
    v_mfma_f32_16x16x32_bf16 v[40:43], a[84:87], v[152:155], v[40:43]
    v_cvt_pk_bf16_f32 v34, v36, v37
    v_mfma_f32_16x16x32_bf16 v[72:75], a[88:91], v[152:155], v[72:75]
    v_cvt_pk_bf16_f32 v35, v38, v39
    v_mfma_f32_16x16x32_bf16 v[104:107], a[92:95], v[152:155], v[104:107]
    s_waitcnt lgkmcnt(4)
    v_permlane16_swap_b32 v32, v34
    v_mfma_f32_16x16x32_bf16 v[44:47], a[84:87], v[156:159], v[44:47]
    v_permlane16_swap_b32 v33, v35
    v_mfma_f32_16x16x32_bf16 v[76:79], a[88:91], v[156:159], v[76:79]
    buffer_store_dwordx4 v[32:35], v8, s[16:19], s42 offen offset:0 sc1
    v_cvt_pk_bf16_f32 v64, v64, v65
    v_mfma_f32_16x16x32_bf16 v[108:111], a[92:95], v[156:159], v[108:111]
    s_waitcnt lgkmcnt(3)
    v_cvt_pk_bf16_f32 v65, v66, v67
    v_mfma_f32_16x16x32_bf16 v[40:43], a[0:3], v[160:163], v[40:43]
    v_cvt_pk_bf16_f32 v66, v68, v69
    v_mfma_f32_16x16x32_bf16 v[72:75], a[4:7], v[160:163], v[72:75]
    v_cvt_pk_bf16_f32 v67, v70, v71
    v_mfma_f32_16x16x32_bf16 v[104:107], a[8:11], v[160:163], v[104:107]
    s_waitcnt lgkmcnt(2)
    v_permlane16_swap_b32 v64, v66
    v_mfma_f32_16x16x32_bf16 v[44:47], a[0:3], v[164:167], v[44:47]
    v_permlane16_swap_b32 v65, v67
    v_mfma_f32_16x16x32_bf16 v[76:79], a[4:7], v[164:167], v[76:79]
    buffer_store_dwordx4 v[64:67], v8, s[16:19], s42 offen offset:1024 sc1
    v_mfma_f32_16x16x32_bf16 v[108:111], a[8:11], v[164:167], v[108:111]
    s_waitcnt lgkmcnt(1)
    v_cvt_pk_bf16_f32 v96, v96, v97
    v_mfma_f32_16x16x32_bf16 v[40:43], a[12:15], v[168:171], v[40:43]
    v_cvt_pk_bf16_f32 v97, v98, v99
    v_mfma_f32_16x16x32_bf16 v[72:75], a[16:19], v[168:171], v[72:75]
    v_cvt_pk_bf16_f32 v98, v100, v101
    v_mfma_f32_16x16x32_bf16 v[104:107], a[20:23], v[168:171], v[104:107]
    s_waitcnt lgkmcnt(0)
    v_cvt_pk_bf16_f32 v99, v102, v103
    v_mfma_f32_16x16x32_bf16 v[44:47], a[12:15], v[172:175], v[44:47]
    v_permlane16_swap_b32 v96, v98
    v_mfma_f32_16x16x32_bf16 v[76:79], a[16:19], v[172:175], v[76:79]
    v_permlane16_swap_b32 v97, v99
    v_mfma_f32_16x16x32_bf16 v[108:111], a[20:23], v[172:175], v[108:111]
    buffer_store_dwordx4 v[96:99], v8, s[16:19], s42 offen offset:2048 sc1
    s_nop 7
    v_cvt_pk_bf16_f32 v40, v40, v41
    v_cvt_pk_bf16_f32 v41, v42, v43
    v_cvt_pk_bf16_f32 v42, v44, v45
    v_cvt_pk_bf16_f32 v43, v46, v47
    s_nop 0
    v_permlane16_swap_b32 v40, v42
    v_permlane16_swap_b32 v41, v43
    buffer_store_dwordx4 v[40:43], v8, s[16:19], s43 offen offset:0 sc1
    v_cvt_pk_bf16_f32 v72, v72, v73
    v_cvt_pk_bf16_f32 v73, v74, v75
    v_cvt_pk_bf16_f32 v74, v76, v77
    v_cvt_pk_bf16_f32 v75, v78, v79
    s_nop 0
    v_permlane16_swap_b32 v72, v74
    v_permlane16_swap_b32 v73, v75
    buffer_store_dwordx4 v[72:75], v8, s[16:19], s43 offen offset:1024 sc1
    v_cvt_pk_bf16_f32 v104, v104, v105
    v_cvt_pk_bf16_f32 v105, v106, v107
    v_cvt_pk_bf16_f32 v106, v108, v109
    v_cvt_pk_bf16_f32 v107, v110, v111
    s_nop 0
    v_permlane16_swap_b32 v104, v106
    v_permlane16_swap_b32 v105, v107
    buffer_store_dwordx4 v[104:107], v8, s[16:19], s43 offen offset:2048 sc1
    s_branch fnet_glu_kernel_j2_11
fnet_glu_kernel_skip2_5:
fnet_glu_kernel_j2_11:
    s_and_b32 s76, s2, 7
    s_lshl_b32 s76, s76, 5
    s_lshr_b32 s77, s2, 3
    s_add_u32 s76, s76, s77
    s_mul_i32 s77, s76, 293
    s_lshr_b32 s77, s77, 11
    s_mul_i32 s78, s77, 7
    s_sub_u32 s78, s76, s78
    s_mul_i32 s79, s78, 37450
    s_lshr_b32 s79, s79, 11
    s_add_u32 s80, s78, 1
    s_mul_i32 s80, s80, 37450
    s_lshr_b32 s80, s80, 11
    s_sub_u32 s80, s80, s79
    v_lshrrev_b32 v186, 4, v1
    v_and_b32 v187, 15, v1
    s_and_b32 s82, s3, 1
    s_lshl_b32 s82, s82, 3
    v_lshlrev_b32 v188, 1, v186
    v_or_b32 v188, s82, v188
    v_xor_b32 v187, v187, v188
    v_mul_u32_u24 v186, 9216, v186
    v_lshl_add_u32 v184, v187, 4, v186
    s_mul_i32 s82, s3, 73728
    s_lshl_b32 s83, s77, 8
    s_add_u32 s82, s82, s83
    v_add_u32 v184, s82, v184
    v_add_u32 v185, 35840, v184
    s_lshl_b32 s75, s3, 11
    s_mov_b32 s73, 294912
    s_mov_b32 s74, 5308416
    s_mul_i32 s81, s78, 5
    s_lshr_b32 s81, s81, 1
    s_and_b32 s82, s77, 1
    s_add_u32 s81, s81, s82
    s_mul_i32 s72, s81, s73
    s_mov_b32 s64, s84
    s_and_b32 s65, s85, 0xffff
    s_mov_b32 s66, 0x510000
    s_mov_b32 s67, 0x00020000
    s_mov_b32 s68, s86
    s_and_b32 s69, s87, 0xffff
    s_mov_b32 s70, 0x510000
    s_mov_b32 s71, 0x00020000
    s_mov_b32 s60, s61
    s_load_dwordx2 s[4:5], s[0:1], 0
    s_load_dwordx2 s[44:45], s[0:1], 64
    s_mov_b32 s57, s60
    s_and_b32 s27, s2, 7
    s_lshr_b32 s28, s2, 3
    s_mul_i32 s29, s28, 43
    s_lshr_b32 s29, s29, 7
    s_mul_i32 s30, s29, 3
    s_sub_u32 s26, s28, s30
    s_mul_i32 s27, s27, 10
    s_add_u32 s27, s27, s29
    s_lshr_b32 s24, s27, 4
    s_and_b32 s25, s27, 15
    s_mul_i32 s31, s3, 9216
    s_mul_i32 s32, s26, 384
    s_add_u32 s31, s31, s32
    v_add_u32 v2, 0, v1
    v_mul_u32_u24 v3, 171, v2
    v_lshrrev_b32 v3, 12, v3
    v_mul_u32_u24 v7, 24, v3
    v_sub_u32 v2, v2, v7
    v_and_b32 v7, 6, v3
    v_xor_b32 v2, v2, v7
    v_mul_u32_u24 v3, 1152, v3
    v_lshl_add_u32 v2, v2, 4, v3
    v_add_u32 v2, s31, v2
    v_subrev_u32 v220, 0, v2
    v_add_u32 v2, 64, v1
    v_mul_u32_u24 v3, 171, v2
    v_lshrrev_b32 v3, 12, v3
    v_mul_u32_u24 v7, 24, v3
    v_sub_u32 v2, v2, v7
    v_and_b32 v7, 6, v3
    v_xor_b32 v2, v2, v7
    v_mul_u32_u24 v3, 1152, v3
    v_lshl_add_u32 v2, v2, 4, v3
    v_add_u32 v2, s31, v2
    v_subrev_u32 v221, 1024, v2
    v_add_u32 v2, 128, v1
    v_mul_u32_u24 v3, 171, v2
    v_lshrrev_b32 v3, 12, v3
    v_mul_u32_u24 v7, 24, v3
    v_sub_u32 v2, v2, v7
    v_and_b32 v7, 6, v3
    v_xor_b32 v2, v2, v7
    v_mul_u32_u24 v3, 1152, v3
    v_lshl_add_u32 v2, v2, 4, v3
    v_add_u32 v2, s31, v2
    v_subrev_u32 v222, 2048, v2
    s_waitcnt vmcnt(0) lgkmcnt(0)
    s_barrier
    v_mov_b32 v2, s92
    buffer_store_dword v2, v223, s[52:55], s57 offen sc1
    s_and_b32 s24, s2, 7
    s_lshr_b32 s25, s2, 3
    s_and_b32 s26, s25, 3
    s_lshr_b32 s25, s25, 2
    s_lshl_b32 s24, s24, 3
    s_add_u32 s24, s24, s25
    v_and_b32 v40, 7, v1
    v_bfe_u32 v45, v1, 3, 1
    v_lshrrev_b32 v42, 4, v1
    s_lshl_b32 s27, s26, 3
    v_add_u32 v40, s27, v40
    s_mul_i32 s27, s3, 9
    v_add_u32 v43, s27, v42
    v_lshl_add_u32 v32, v45, 5, v40
    v_lshlrev_b32 v32, 4, v32
    v_lshl_add_u32 v32, v43, 10, v32
    v_mul_u32_u24 v33, 1152, v40
    v_lshl_add_u32 v33, v43, 5, v33
    v_lshl_add_u32 v33, v45, 4, v33
    v_cmp_gt_u32 vcc, 3, v42
    v_mov_b32 v39, 0x40000000
    s_mul_i32 s28, s24, 36864
    v_cndmask_b32 v32, v39, v32, vcc
    v_cndmask_b32 v33, v39, v33, vcc
    s_lshr_b32 s27, s26, 1
    s_mul_i32 s27, s27, 18432
    v_and_b32 v41, 15, v40
    v_lshl_add_u32 v35, v43, 9, s27
    v_lshl_add_u32 v35, v45, 8, v35
    v_lshl_add_u32 v35, v41, 4, v35
    v_cndmask_b32 v35, v39, v35, vcc
    v_cndmask_b32 v38, 0, 1.0, vcc
    s_mov_b32 s8, s4
    s_and_b32 s9, s5, 0xffff
    s_mov_b32 s10, 0x240000
    s_mov_b32 s11, 0x00020000
    buffer_load_dwordx4 v[124:127], v33, s[8:11], s28 offen offset:0
    buffer_load_dwordx4 v[128:131], v33, s[8:11], s28 offen offset:96
    buffer_load_dwordx4 v[132:135], v33, s[8:11], s28 offen offset:192
    s_lshl_b32 s29, s24, 2
    s_add_u32 s29, s29, s26
    s_lshl_b32 s29, s29, 7
    v_and_b32 v24, 1, v1
    v_lshlrev_b32 v24, 3, v24
    s_mul_i32 s30, s3, 9
    v_add_u32 v24, s30, v24
    v_mul_u32_u24 v24, 43, v24
    v_lshrrev_b32 v24, 9, v24
    v_lshrrev_b32 v25, 1, v1
    v_min_u32 v25, 4, v25
    v_mad_u32_u24 v24, v25, 3, v24
    s_lshr_b32 s30, s24, 2
    s_lshl_b32 s30, s30, 4
    v_add_u32 v24, s30, v24
    v_lshlrev_b32 v24, 7, v24
    v_add_u32 v24, 0x18000, v24
    s_mov_b32 s56, s76
    s_mov_b32 s25, s77
    s_mov_b32 s26, s78
    s_mov_b32 s27, s79
    s_mov_b32 s63, s80
    s_mov_b32 s60, s81
    buffer_load_dword v25, v24, s[52:55], 0 offen sc1
    s_add_u32 s16, s6, 0x1100000
    s_addc_u32 s17, s7, 0
    s_and_b32 s17, s17, 0xffff
    s_mov_b32 s18, 0x240000
    s_mov_b32 s19, 0x00020000
    s_add_u32 s40, s6, 0x500000
    s_addc_u32 s41, s7, 0
    s_and_b32 s41, s41, 0xffff
    s_mov_b32 s42, 0xb40000
    s_mov_b32 s43, 0x00020000
    v_lshlrev_b32 v10, 4, v1
    s_lshl_b32 s31, s25, 2
    s_add_u32 s31, s31, s3
    s_lshl_b32 s31, s31, 10
    v_add_u32 v9, s31, v10
    v_lshrrev_b32 v2, 4, v1
    v_bfe_u32 v3, v1, 2, 2
    v_lshl_add_u32 v2, v2, 3, v3
    v_lshlrev_b32 v2, 8, v2
    v_and_b32 v3, 3, v1
    v_lshl_add_u32 v2, v3, 3, v2
    v_bfe_u32 v3, v1, 2, 3
    s_lshl_b32 s31, s3, 1
    v_xor_b32 v3, s31, v3
    v_lshl_add_u32 v13, v3, 5, v2
    v_add_u32 v14, 0x10000, v13
    v_add_u32 v15, 0x20000, v13
    v_xor_b32 v3, 1, v3
    v_lshl_add_u32 v16, v3, 5, v2
    v_add_u32 v17, 0x10000, v16
    v_add_u32 v18, 0x20000, v16
    s_mul_i32 s32, s27, 18432
    s_and_b32 s31, s3, 1
    s_mul_i32 s31, s31, 9
    s_add_u32 s31, s31, s60
    s_lshr_b32 s30, s3, 1
    s_mul_i32 s30, s30, 18432
    s_add_u32 s30, s30, s32
    s_add_u32 s93, s31, 0
    s_sub_u32 s62, s93, 18
    s_cmp_ge_u32 s93, 18
    s_cselect_b32 s93, s62, s93
    s_lshl_b32 s93, s93, 10
    s_add_u32 s93, s93, s30
    s_add_u32 s94, s31, 1
    s_sub_u32 s62, s94, 18
    s_cmp_ge_u32 s94, 18
    s_cselect_b32 s94, s62, s94
    s_lshl_b32 s94, s94, 10
    s_add_u32 s94, s94, s30
    s_add_u32 s95, s31, 2
    s_sub_u32 s62, s95, 18
    s_cmp_ge_u32 s95, 18
    s_cselect_b32 s95, s62, s95
    s_lshl_b32 s95, s95, 10
    s_add_u32 s95, s95, s30
    s_add_u32 s96, s31, 3
    s_sub_u32 s62, s96, 18
    s_cmp_ge_u32 s96, 18
    s_cselect_b32 s96, s62, s96
    s_lshl_b32 s96, s96, 10
    s_add_u32 s96, s96, s30
    s_add_u32 s97, s31, 4
    s_sub_u32 s62, s97, 18
    s_cmp_ge_u32 s97, 18
    s_cselect_b32 s97, s62, s97
    s_lshl_b32 s97, s97, 10
    s_add_u32 s97, s97, s30
    s_add_u32 s98, s31, 5
    s_sub_u32 s62, s98, 18
    s_cmp_ge_u32 s98, 18
    s_cselect_b32 s98, s62, s98
    s_lshl_b32 s98, s98, 10
    s_add_u32 s98, s98, s30
    s_add_u32 s99, s31, 6
    s_sub_u32 s62, s99, 18
    s_cmp_ge_u32 s99, 18
    s_cselect_b32 s99, s62, s99
    s_lshl_b32 s99, s99, 10
    s_add_u32 s99, s99, s30
    s_add_u32 s100, s31, 7
    s_sub_u32 s62, s100, 18
    s_cmp_ge_u32 s100, 18
    s_cselect_b32 s100, s62, s100
    s_lshl_b32 s100, s100, 10
    s_add_u32 s100, s100, s30
    s_add_u32 s101, s31, 8
    s_sub_u32 s62, s101, 18
    s_cmp_ge_u32 s101, 18
    s_cselect_b32 s101, s62, s101
    s_lshl_b32 s101, s101, 10
    s_add_u32 s101, s101, s30
    s_lshl_b32 s31, s27, 1
    v_add_u32 v8, s31, v1
    s_add_u32 s30, s31, 7
    v_min_u32 v26, s30, v8
    v_lshlrev_b32 v26, 7, v26
    s_add_u32 s31, s27, s63
    s_lshl_b32 s31, s31, 1
    s_sub_u32 s31, s31, 1
    v_min_u32 v8, s31, v8
    v_lshlrev_b32 v8, 7, v8
    v_and_b32 v37, 7, v1
    v_lshlrev_b32 v37, 5, v37
    s_lshl_b32 s31, s3, 3
    v_add_u32 v36, s31, v37
    s_mul_i32 s36, s27, 147456
    s_mov_b32 s39, 147456
    s_mul_i32 s38, s3, 9216
    s_and_b32 s31, s2, 7
    s_mul_i32 s31, s31, 10
    s_lshr_b32 s46, s31, 4
    s_add_u32 s31, s31, 9
    s_lshr_b32 s47, s31, 4
    s_add_u32 s47, s47, 1
    s_mul_i32 s46, s46, 1069056
    s_mul_i32 s47, s47, 1069056
    s_min_u32 s47, s47, 5308416
    s_add_u32 s48, s44, s46
    s_addc_u32 s49, s45, 0
    s_and_b32 s49, s49, 0xffff
    s_sub_u32 s47, s47, s46
    s_mov_b32 s50, 0
    s_mov_b32 s51, 0x00020000
    s_lshr_b32 s31, s2, 3
    s_lshl_b32 s31, s31, 8
    v_add_u32 v19, s31, v0
    v_lshlrev_b32 v19, 5, v19
    s_mov_b32 s4, 0
    s_mov_b32 s5, 0
    s_waitcnt vmcnt(0)
    s_mov_b32 s30, 0
fnet_glu_kernel_poll_12:
    v_cmp_eq_u32 vcc, s92, v25
    s_cmp_eq_u64 vcc, -1
    s_cbranch_scc1 fnet_glu_kernel_pok_13
    s_add_u32 s30, s30, 1
    s_cmp_gt_u32 s30, 0x40000
    s_cbranch_scc1 fnet_glu_kernel_pok_13
    buffer_load_dword v25, v24, s[52:55], 0 offen sc1
    s_waitcnt vmcnt(0)
    s_branch fnet_glu_kernel_poll_12
fnet_glu_kernel_pok_13:
    s_add_u32 s30, s28, 0
    buffer_load_dwordx4 v[64:67], v32, s[40:43], s30 offen sc1
    s_add_u32 s30, s28, 2359296
    buffer_load_dwordx4 v[68:71], v32, s[40:43], s30 offen sc1
    s_add_u32 s30, s28, 4718592
    buffer_load_dwordx4 v[72:75], v32, s[40:43], s30 offen sc1
    s_add_u32 s30, s28, 7077888
    buffer_load_dwordx4 v[76:79], v32, s[40:43], s30 offen sc1
    s_add_u32 s30, s28, 9437184
    buffer_load_dwordx4 v[80:83], v32, s[40:43], s30 offen sc1
    s_add_u32 s30, s28, 3072
    buffer_load_dwordx4 v[84:87], v32, s[40:43], s30 offen sc1
    s_add_u32 s30, s28, 2362368
    buffer_load_dwordx4 v[88:91], v32, s[40:43], s30 offen sc1
    s_add_u32 s30, s28, 4721664
    buffer_load_dwordx4 v[92:95], v32, s[40:43], s30 offen sc1
    s_add_u32 s30, s28, 7080960
    buffer_load_dwordx4 v[96:99], v32, s[40:43], s30 offen sc1
    s_add_u32 s30, s28, 9440256
    buffer_load_dwordx4 v[100:103], v32, s[40:43], s30 offen sc1
    s_add_u32 s30, s28, 6144
    buffer_load_dwordx4 v[104:107], v32, s[40:43], s30 offen sc1
    s_add_u32 s30, s28, 2365440
    buffer_load_dwordx4 v[108:111], v32, s[40:43], s30 offen sc1
    s_add_u32 s30, s28, 4724736
    buffer_load_dwordx4 v[112:115], v32, s[40:43], s30 offen sc1
    s_add_u32 s30, s28, 7084032
    buffer_load_dwordx4 v[116:119], v32, s[40:43], s30 offen sc1
    s_add_u32 s30, s28, 9443328
    buffer_load_dwordx4 v[120:123], v32, s[40:43], s30 offen sc1
    s_add_u32 s40, s6, 0x1700000
    s_addc_u32 s41, s7, 0
    s_and_b32 s41, s41, 0xffff
    s_mov_b32 s42, 0x1200000
    s_mov_b32 s43, 0x00020000
    s_mov_b32 s30, 0x00003f80
    s_mov_b32 s31, 0x3f800000
    s_waitcnt vmcnt(10)
    v_lshlrev_b32 v136, 16, v64
    v_and_b32 v137, 0xffff0000, v64
    v_lshlrev_b32 v138, 16, v65
    v_and_b32 v139, 0xffff0000, v65
    v_lshlrev_b32 v140, 16, v66
    v_and_b32 v141, 0xffff0000, v66
    v_lshlrev_b32 v142, 16, v67
    v_and_b32 v143, 0xffff0000, v67
    v_dot2_f32_bf16 v136, v68, s30, v136
    v_dot2_f32_bf16 v137, v68, s31, v137
    v_dot2_f32_bf16 v138, v69, s30, v138
    v_dot2_f32_bf16 v139, v69, s31, v139
    v_dot2_f32_bf16 v140, v70, s30, v140
    v_dot2_f32_bf16 v141, v70, s31, v141
    v_dot2_f32_bf16 v142, v71, s30, v142
    v_dot2_f32_bf16 v143, v71, s31, v143
    v_dot2_f32_bf16 v136, v72, s30, v136
    v_dot2_f32_bf16 v137, v72, s31, v137
    v_dot2_f32_bf16 v138, v73, s30, v138
    v_dot2_f32_bf16 v139, v73, s31, v139
    v_dot2_f32_bf16 v140, v74, s30, v140
    v_dot2_f32_bf16 v141, v74, s31, v141
    v_dot2_f32_bf16 v142, v75, s30, v142
    v_dot2_f32_bf16 v143, v75, s31, v143
    v_dot2_f32_bf16 v136, v76, s30, v136
    v_dot2_f32_bf16 v137, v76, s31, v137
    v_dot2_f32_bf16 v138, v77, s30, v138
    v_dot2_f32_bf16 v139, v77, s31, v139
    v_dot2_f32_bf16 v140, v78, s30, v140
    v_dot2_f32_bf16 v141, v78, s31, v141
    v_dot2_f32_bf16 v142, v79, s30, v142
    v_dot2_f32_bf16 v143, v79, s31, v143
    v_dot2_f32_bf16 v136, v80, s30, v136
    v_dot2_f32_bf16 v137, v80, s31, v137
    v_dot2_f32_bf16 v138, v81, s30, v138
    v_dot2_f32_bf16 v139, v81, s31, v139
    v_dot2_f32_bf16 v140, v82, s30, v140
    v_dot2_f32_bf16 v141, v82, s31, v141
    v_dot2_f32_bf16 v142, v83, s30, v142
    v_dot2_f32_bf16 v143, v83, s31, v143
    s_waitcnt vmcnt(5)
    v_lshlrev_b32 v144, 16, v84
    v_and_b32 v145, 0xffff0000, v84
    v_lshlrev_b32 v146, 16, v85
    v_and_b32 v147, 0xffff0000, v85
    v_lshlrev_b32 v148, 16, v86
    v_and_b32 v149, 0xffff0000, v86
    v_lshlrev_b32 v150, 16, v87
    v_and_b32 v151, 0xffff0000, v87
    v_dot2_f32_bf16 v144, v88, s30, v144
    v_dot2_f32_bf16 v145, v88, s31, v145
    v_dot2_f32_bf16 v146, v89, s30, v146
    v_dot2_f32_bf16 v147, v89, s31, v147
    v_dot2_f32_bf16 v148, v90, s30, v148
    v_dot2_f32_bf16 v149, v90, s31, v149
    v_dot2_f32_bf16 v150, v91, s30, v150
    v_dot2_f32_bf16 v151, v91, s31, v151
    v_dot2_f32_bf16 v144, v92, s30, v144
    v_dot2_f32_bf16 v145, v92, s31, v145
    v_dot2_f32_bf16 v146, v93, s30, v146
    v_dot2_f32_bf16 v147, v93, s31, v147
    v_dot2_f32_bf16 v148, v94, s30, v148
    v_dot2_f32_bf16 v149, v94, s31, v149
    v_dot2_f32_bf16 v150, v95, s30, v150
    v_dot2_f32_bf16 v151, v95, s31, v151
    v_dot2_f32_bf16 v144, v96, s30, v144
    v_dot2_f32_bf16 v145, v96, s31, v145
    v_dot2_f32_bf16 v146, v97, s30, v146
    v_dot2_f32_bf16 v147, v97, s31, v147
    v_dot2_f32_bf16 v148, v98, s30, v148
    v_dot2_f32_bf16 v149, v98, s31, v149
    v_dot2_f32_bf16 v150, v99, s30, v150
    v_dot2_f32_bf16 v151, v99, s31, v151
    v_dot2_f32_bf16 v144, v100, s30, v144
    v_dot2_f32_bf16 v145, v100, s31, v145
    v_dot2_f32_bf16 v146, v101, s30, v146
    v_dot2_f32_bf16 v147, v101, s31, v147
    v_dot2_f32_bf16 v148, v102, s30, v148
    v_dot2_f32_bf16 v149, v102, s31, v149
    v_dot2_f32_bf16 v150, v103, s30, v150
    v_dot2_f32_bf16 v151, v103, s31, v151
    s_waitcnt vmcnt(0)
    v_lshlrev_b32 v152, 16, v104
    v_and_b32 v153, 0xffff0000, v104
    v_lshlrev_b32 v154, 16, v105
    v_and_b32 v155, 0xffff0000, v105
    v_lshlrev_b32 v156, 16, v106
    v_and_b32 v157, 0xffff0000, v106
    v_lshlrev_b32 v158, 16, v107
    v_and_b32 v159, 0xffff0000, v107
    v_dot2_f32_bf16 v152, v108, s30, v152
    v_dot2_f32_bf16 v153, v108, s31, v153
    v_dot2_f32_bf16 v154, v109, s30, v154
    v_dot2_f32_bf16 v155, v109, s31, v155
    v_dot2_f32_bf16 v156, v110, s30, v156
    v_dot2_f32_bf16 v157, v110, s31, v157
    v_dot2_f32_bf16 v158, v111, s30, v158
    v_dot2_f32_bf16 v159, v111, s31, v159
    v_dot2_f32_bf16 v152, v112, s30, v152
    v_dot2_f32_bf16 v153, v112, s31, v153
    v_dot2_f32_bf16 v154, v113, s30, v154
    v_dot2_f32_bf16 v155, v113, s31, v155
    v_dot2_f32_bf16 v156, v114, s30, v156
    v_dot2_f32_bf16 v157, v114, s31, v157
    v_dot2_f32_bf16 v158, v115, s30, v158
    v_dot2_f32_bf16 v159, v115, s31, v159
    v_dot2_f32_bf16 v152, v116, s30, v152
    v_dot2_f32_bf16 v153, v116, s31, v153
    v_dot2_f32_bf16 v154, v117, s30, v154
    v_dot2_f32_bf16 v155, v117, s31, v155
    v_dot2_f32_bf16 v156, v118, s30, v156
    v_dot2_f32_bf16 v157, v118, s31, v157
    v_dot2_f32_bf16 v158, v119, s30, v158
    v_dot2_f32_bf16 v159, v119, s31, v159
    v_dot2_f32_bf16 v152, v120, s30, v152
    v_dot2_f32_bf16 v153, v120, s31, v153
    v_dot2_f32_bf16 v154, v121, s30, v154
    v_dot2_f32_bf16 v155, v121, s31, v155
    v_dot2_f32_bf16 v156, v122, s30, v156
    v_dot2_f32_bf16 v157, v122, s31, v157
    v_dot2_f32_bf16 v158, v123, s30, v158
    v_dot2_f32_bf16 v159, v123, s31, v159
    v_dot2_f32_bf16 v136, v124, s30, v136
    v_dot2_f32_bf16 v137, v124, s31, v137
    v_dot2_f32_bf16 v138, v125, s30, v138
    v_dot2_f32_bf16 v139, v125, s31, v139
    v_dot2_f32_bf16 v140, v126, s30, v140
    v_dot2_f32_bf16 v141, v126, s31, v141
    v_dot2_f32_bf16 v142, v127, s30, v142
    v_dot2_f32_bf16 v143, v127, s31, v143
    v_dot2_f32_bf16 v144, v128, s30, v144
    v_dot2_f32_bf16 v145, v128, s31, v145
    v_dot2_f32_bf16 v146, v129, s30, v146
    v_dot2_f32_bf16 v147, v129, s31, v147
    v_dot2_f32_bf16 v148, v130, s30, v148
    v_dot2_f32_bf16 v149, v130, s31, v149
    v_dot2_f32_bf16 v150, v131, s30, v150
    v_dot2_f32_bf16 v151, v131, s31, v151
    v_dot2_f32_bf16 v152, v132, s30, v152
    v_dot2_f32_bf16 v153, v132, s31, v153
    v_dot2_f32_bf16 v154, v133, s30, v154
    v_dot2_f32_bf16 v155, v133, s31, v155
    v_dot2_f32_bf16 v156, v134, s30, v156
    v_dot2_f32_bf16 v157, v134, s31, v157
    v_dot2_f32_bf16 v158, v135, s30, v158
    v_dot2_f32_bf16 v159, v135, s31, v159
    v_cvt_pk_bf16_f32 v208, v136, v137
    v_cvt_pk_bf16_f32 v209, v138, v139
    v_cvt_pk_bf16_f32 v210, v140, v141
    v_cvt_pk_bf16_f32 v211, v142, v143
    v_cvt_pk_bf16_f32 v212, v144, v145
    v_cvt_pk_bf16_f32 v213, v146, v147
    v_cvt_pk_bf16_f32 v214, v148, v149
    v_cvt_pk_bf16_f32 v215, v150, v151
    v_cvt_pk_bf16_f32 v216, v152, v153
    v_cvt_pk_bf16_f32 v217, v154, v155
    v_cvt_pk_bf16_f32 v218, v156, v157
    v_cvt_pk_bf16_f32 v219, v158, v159
    s_add_u32 m0, s75, 65536
    s_nop 0
    buffer_load_dwordx4 v184, s[64:67], s72 offen offset:0 lds
    buffer_load_dwordx4 v185, s[64:67], s72 offen offset:1024 lds
    s_add_u32 m0, s75, 73728
    s_nop 0
    buffer_load_dwordx4 v184, s[68:71], s72 offen offset:0 lds
    buffer_load_dwordx4 v185, s[68:71], s72 offen offset:1024 lds
    s_add_u32 s72, s72, s73
    s_cmp_eq_u32 s72, s74
    s_cselect_b32 s72, 0, s72
    s_add_u32 m0, s75, 81920
    s_nop 0
    buffer_load_dwordx4 v184, s[64:67], s72 offen offset:0 lds
    buffer_load_dwordx4 v185, s[64:67], s72 offen offset:1024 lds
    s_add_u32 m0, s75, 90112
    s_nop 0
    buffer_load_dwordx4 v184, s[68:71], s72 offen offset:0 lds
    buffer_load_dwordx4 v185, s[68:71], s72 offen offset:1024 lds
    s_add_u32 s72, s72, s73
    s_cmp_eq_u32 s72, s74
    s_cselect_b32 s72, 0, s72
    v_lshlrev_b32 v136, 16, v208
    v_and_b32 v137, 0xffff0000, v208
    v_lshlrev_b32 v138, 16, v209
    v_and_b32 v139, 0xffff0000, v209
    v_lshlrev_b32 v140, 16, v210
    v_and_b32 v141, 0xffff0000, v210
    v_lshlrev_b32 v142, 16, v211
    v_and_b32 v143, 0xffff0000, v211
    v_lshlrev_b32 v144, 16, v212
    v_and_b32 v145, 0xffff0000, v212
    v_lshlrev_b32 v146, 16, v213
    v_and_b32 v147, 0xffff0000, v213
    v_lshlrev_b32 v148, 16, v214
    v_and_b32 v149, 0xffff0000, v214
    v_lshlrev_b32 v150, 16, v215
    v_and_b32 v151, 0xffff0000, v215
    v_lshlrev_b32 v152, 16, v216
    v_and_b32 v153, 0xffff0000, v216
    v_lshlrev_b32 v154, 16, v217
    v_and_b32 v155, 0xffff0000, v217
    v_lshlrev_b32 v156, 16, v218
    v_and_b32 v157, 0xffff0000, v218
    v_lshlrev_b32 v158, 16, v219
    v_and_b32 v159, 0xffff0000, v219
    v_pk_add_f32 v[50:51], v[136:137], v[138:139]
    v_pk_add_f32 v[52:53], v[140:141], v[142:143]
    v_pk_add_f32 v[50:51], v[50:51], v[144:145]
    v_pk_add_f32 v[52:53], v[52:53], v[146:147]
    v_pk_add_f32 v[50:51], v[50:51], v[148:149]
    v_pk_add_f32 v[52:53], v[52:53], v[150:151]
    v_pk_add_f32 v[50:51], v[50:51], v[152:153]
    v_pk_add_f32 v[52:53], v[52:53], v[154:155]
    v_pk_add_f32 v[50:51], v[50:51], v[156:157]
    v_pk_add_f32 v[52:53], v[52:53], v[158:159]
    v_pk_add_f32 v[50:51], v[50:51], v[52:53]
    s_nop 0
    v_add_f32 v50, v50, v51
    s_nop 1
    v_add_f32_dpp v50, v50, v50 row_ror:8 row_mask:0xf bank_mask:0xf
    v_mov_b32 v51, v50
    s_nop 1
    v_permlane16_swap_b32 v50, v51
    s_nop 0
    v_add_f32 v50, v50, v51
    v_mov_b32 v51, v50
    s_nop 1
    v_permlane32_swap_b32 v50, v51
    s_nop 0
    v_add_f32 v50, v50, v51
    v_mul_f32 v46, 0x3be38e39, v50
    v_mul_f32 v58, 0xbbe38e39, v50
    v_mov_b32 v59, v58
    v_pk_add_f32 v[160:161], v[136:137], v[58:59]
    v_pk_add_f32 v[162:163], v[138:139], v[58:59]
    v_pk_mul_f32 v[50:51], v[160:161], v[160:161]
    v_pk_add_f32 v[164:165], v[140:141], v[58:59]
    v_pk_mul_f32 v[52:53], v[162:163], v[162:163]
    v_pk_add_f32 v[166:167], v[142:143], v[58:59]
    v_pk_fma_f32 v[50:51], v[164:165], v[164:165], v[50:51]
    v_pk_add_f32 v[160:161], v[144:145], v[58:59]
    v_pk_fma_f32 v[52:53], v[166:167], v[166:167], v[52:53]
    v_pk_add_f32 v[162:163], v[146:147], v[58:59]
    v_pk_fma_f32 v[50:51], v[160:161], v[160:161], v[50:51]
    v_pk_add_f32 v[164:165], v[148:149], v[58:59]
    v_pk_fma_f32 v[52:53], v[162:163], v[162:163], v[52:53]
    v_pk_add_f32 v[166:167], v[150:151], v[58:59]
    v_pk_fma_f32 v[50:51], v[164:165], v[164:165], v[50:51]
    v_pk_add_f32 v[160:161], v[152:153], v[58:59]
    v_pk_fma_f32 v[52:53], v[166:167], v[166:167], v[52:53]
    v_pk_add_f32 v[162:163], v[154:155], v[58:59]
    v_pk_fma_f32 v[50:51], v[160:161], v[160:161], v[50:51]
    v_pk_add_f32 v[164:165], v[156:157], v[58:59]
    v_pk_fma_f32 v[52:53], v[162:163], v[162:163], v[52:53]
    v_pk_add_f32 v[166:167], v[158:159], v[58:59]
    v_pk_fma_f32 v[50:51], v[164:165], v[164:165], v[50:51]
    v_pk_fma_f32 v[52:53], v[166:167], v[166:167], v[52:53]
    s_nop 0
    v_pk_add_f32 v[50:51], v[50:51], v[52:53]
    s_nop 0
    v_add_f32 v50, v50, v51
    v_mul_f32 v50, v50, v38
    s_nop 1
    v_add_f32_dpp v50, v50, v50 row_ror:8 row_mask:0xf bank_mask:0xf
    v_mov_b32 v51, v50
    s_nop 1
    v_permlane16_swap_b32 v50, v51
    s_nop 0
    v_add_f32 v50, v50, v51
    v_mov_b32 v51, v50
    s_nop 1
    v_permlane32_swap_b32 v50, v51
    s_nop 0
    v_add_f32 v50, v50, v51
    v_mov_b32 v47, v50
    ds_write_b64 v36, v[46:47]
    s_waitcnt lgkmcnt(0)
    s_barrier
    ds_read_b128 v[48:51], v37
    ds_read_b128 v[52:55], v37 offset:16
    s_waitcnt lgkmcnt(0)
    v_pk_add_f32 v[46:47], v[48:49], v[50:51]
    v_pk_add_f32 v[56:57], v[52:53], v[54:55]
    s_nop 0
    v_pk_add_f32 v[46:47], v[46:47], v[56:57]
    s_nop 0
    v_mul_f32 v46, 0.25, v46
    v_sub_f32 v48, v48, v46
    v_sub_f32 v50, v50, v46
    v_sub_f32 v52, v52, v46
    v_sub_f32 v54, v54, v46
    v_mul_f32 v56, v48, v48
    v_fmac_f32 v56, v50, v50
    v_fmac_f32 v56, v52, v52
    v_fmac_f32 v56, v54, v54
    v_mul_f32 v47, 0x3ae38e39, v47
    v_fmac_f32 v47, 0.25, v56
    v_cvt_pk_bf16_f32 v46, v46, v46
    v_lshlrev_b32 v46, 16, v46
    v_cvt_pk_bf16_f32 v47, v47, v47
    v_lshlrev_b32 v47, 16, v47
    v_add_f32 v47, 0x3727c5ac, v47
    v_cvt_pk_bf16_f32 v47, v47, v47
    v_lshlrev_b32 v47, 16, v47
    v_sqrt_f32 v47, v47
    s_nop 0
    v_cvt_pk_bf16_f32 v47, v47, v47
    v_lshlrev_b32 v47, 16, v47
    v_rcp_f32 v47, v47
    s_nop 0
    v_mul_f32 v48, 0xbfb8aa3b, v47
    v_mul_f32 v50, -v46, v48
    v_mov_b32 v49, v48
    v_mov_b32 v51, v50
    v_pk_fma_f32 v[136:137], v[136:137], v[48:49], v[50:51]
    v_pk_fma_f32 v[138:139], v[138:139], v[48:49], v[50:51]
    v_pk_fma_f32 v[140:141], v[140:141], v[48:49], v[50:51]
    v_pk_fma_f32 v[142:143], v[142:143], v[48:49], v[50:51]
    v_cvt_pk_bf16_f32 v64, v136, v137
    v_cvt_pk_bf16_f32 v65, v138, v139
    v_cvt_pk_bf16_f32 v66, v140, v141
    v_cvt_pk_bf16_f32 v67, v142, v143
    buffer_store_dwordx4 v[64:67], v35, s[16:19], s28 offen offset:0 sc1
    v_pk_fma_f32 v[144:145], v[144:145], v[48:49], v[50:51]
    v_pk_fma_f32 v[146:147], v[146:147], v[48:49], v[50:51]
    v_pk_fma_f32 v[148:149], v[148:149], v[48:49], v[50:51]
    v_pk_fma_f32 v[150:151], v[150:151], v[48:49], v[50:51]
    v_cvt_pk_bf16_f32 v68, v144, v145
    v_cvt_pk_bf16_f32 v69, v146, v147
    v_cvt_pk_bf16_f32 v70, v148, v149
    v_cvt_pk_bf16_f32 v71, v150, v151
    buffer_store_dwordx4 v[68:71], v35, s[16:19], s28 offen offset:1536 sc1
    v_pk_fma_f32 v[152:153], v[152:153], v[48:49], v[50:51]
    v_pk_fma_f32 v[154:155], v[154:155], v[48:49], v[50:51]
    v_pk_fma_f32 v[156:157], v[156:157], v[48:49], v[50:51]
    v_pk_fma_f32 v[158:159], v[158:159], v[48:49], v[50:51]
    v_cvt_pk_bf16_f32 v72, v152, v153
    v_cvt_pk_bf16_f32 v73, v154, v155
    v_cvt_pk_bf16_f32 v74, v156, v157
    v_cvt_pk_bf16_f32 v75, v158, v159
    buffer_store_dwordx4 v[72:75], v35, s[16:19], s28 offen offset:3072 sc1
    s_add_u32 m0, s75, 131072
    s_nop 0
    buffer_load_dwordx4 v184, s[64:67], s72 offen offset:0 lds
    buffer_load_dwordx4 v185, s[64:67], s72 offen offset:1024 lds
    s_add_u32 m0, s75, 139264
    s_nop 0
    buffer_load_dwordx4 v184, s[68:71], s72 offen offset:0 lds
    buffer_load_dwordx4 v185, s[68:71], s72 offen offset:1024 lds
    s_add_u32 s72, s72, s73
    s_cmp_eq_u32 s72, s74
    s_cselect_b32 s72, 0, s72
    s_add_u32 m0, s75, 147456
    s_nop 0
    buffer_load_dwordx4 v184, s[64:67], s72 offen offset:0 lds
    buffer_load_dwordx4 v185, s[64:67], s72 offen offset:1024 lds
    s_add_u32 m0, s75, 155648
    s_nop 0
    buffer_load_dwordx4 v184, s[68:71], s72 offen offset:0 lds
    buffer_load_dwordx4 v185, s[68:71], s72 offen offset:1024 lds
    s_add_u32 s72, s72, s73
    s_cmp_eq_u32 s72, s74
    s_cselect_b32 s72, 0, s72
    s_waitcnt vmcnt(8)
    s_barrier
    v_mov_b32 v2, s92
    buffer_store_dword v2, v223, s[52:55], s29 offen sc1
    s_cmp_ge_u32 s56, 252
    s_cbranch_scc1 fnet_glu_kernel_skip4_14
    s_mov_b32 s59, s38
    v_mov_b32 v7, v10
    s_add_u32 s58, s38, 147456
    s_add_u32 s18, s27, s63
    s_mul_i32 s18, s18, 18432
    s_add_u32 m0, s75, 98304
    s_nop 0
    buffer_load_dwordx4 v184, s[64:67], s72 offen offset:0 lds
    buffer_load_dwordx4 v185, s[64:67], s72 offen offset:1024 lds
    s_add_u32 m0, s75, 106496
    s_nop 0
    buffer_load_dwordx4 v184, s[68:71], s72 offen offset:0 lds
    buffer_load_dwordx4 v185, s[68:71], s72 offen offset:1024 lds
    s_add_u32 s72, s72, s73
    s_cmp_eq_u32 s72, s74
    s_cselect_b32 s72, 0, s72
    s_add_u32 m0, s75, 114688
    s_nop 0
    buffer_load_dwordx4 v184, s[64:67], s72 offen offset:0 lds
    buffer_load_dwordx4 v185, s[64:67], s72 offen offset:1024 lds
    s_add_u32 m0, s75, 122880
    s_nop 0
    buffer_load_dwordx4 v184, s[68:71], s72 offen offset:0 lds
    buffer_load_dwordx4 v185, s[68:71], s72 offen offset:1024 lds
    s_add_u32 s72, s72, s73
    s_cmp_eq_u32 s72, s74
    s_cselect_b32 s72, 0, s72
    ds_read_b64_tr_b16 a[0:1], v14 offset:0
    ds_read_b64_tr_b16 a[2:3], v14 offset:1024
    ds_read_b64_tr_b16 a[4:5], v17 offset:0
    ds_read_b64_tr_b16 a[6:7], v17 offset:1024
    ds_read_b64_tr_b16 a[8:9], v14 offset:8192
    ds_read_b64_tr_b16 a[10:11], v14 offset:9216
    ds_read_b64_tr_b16 a[12:13], v17 offset:8192
    ds_read_b64_tr_b16 a[14:15], v17 offset:9216
    ds_read_b64_tr_b16 a[16:17], v14 offset:16384
    ds_read_b64_tr_b16 a[18:19], v14 offset:17408
    ds_read_b64_tr_b16 a[20:21], v17 offset:16384
    ds_read_b64_tr_b16 a[22:23], v17 offset:17408
    ds_read_b64_tr_b16 a[24:25], v14 offset:24576
    ds_read_b64_tr_b16 a[26:27], v14 offset:25600
    ds_read_b64_tr_b16 a[28:29], v17 offset:24576
    ds_read_b64_tr_b16 a[30:31], v17 offset:25600
    s_waitcnt vmcnt(9) lgkmcnt(0)
    s_barrier
    s_add_u32 m0, s75, 65536
    s_nop 0
    buffer_load_dwordx4 v184, s[64:67], s72 offen offset:0 lds
    buffer_load_dwordx4 v185, s[64:67], s72 offen offset:1024 lds
    s_add_u32 m0, s75, 73728
    s_nop 0
    buffer_load_dwordx4 v184, s[68:71], s72 offen offset:0 lds
    buffer_load_dwordx4 v185, s[68:71], s72 offen offset:1024 lds
    s_add_u32 s72, s72, s73
    s_cmp_eq_u32 s72, s74
    s_cselect_b32 s72, 0, s72
    s_add_u32 m0, s75, 81920
    s_nop 0
    buffer_load_dwordx4 v184, s[64:67], s72 offen offset:0 lds
    buffer_load_dwordx4 v185, s[64:67], s72 offen offset:1024 lds
    s_add_u32 m0, s75, 90112
    s_nop 0
    buffer_load_dwordx4 v184, s[68:71], s72 offen offset:0 lds
    buffer_load_dwordx4 v185, s[68:71], s72 offen offset:1024 lds
    s_add_u32 s72, s72, s73
    s_cmp_eq_u32 s72, s74
    s_cselect_b32 s72, 0, s72
    ds_read_b64_tr_b16 a[32:33], v15 offset:0
    ds_read_b64_tr_b16 a[34:35], v15 offset:1024
    ds_read_b64_tr_b16 a[36:37], v18 offset:0
    ds_read_b64_tr_b16 a[38:39], v18 offset:1024
    ds_read_b64_tr_b16 a[40:41], v15 offset:8192
    ds_read_b64_tr_b16 a[42:43], v15 offset:9216
    ds_read_b64_tr_b16 a[44:45], v18 offset:8192
    ds_read_b64_tr_b16 a[46:47], v18 offset:9216
    ds_read_b64_tr_b16 a[48:49], v15 offset:16384
    ds_read_b64_tr_b16 a[50:51], v15 offset:17408
    ds_read_b64_tr_b16 a[52:53], v18 offset:16384
    ds_read_b64_tr_b16 a[54:55], v18 offset:17408
    ds_read_b64_tr_b16 a[56:57], v15 offset:24576
    ds_read_b64_tr_b16 a[58:59], v15 offset:25600
    ds_read_b64_tr_b16 a[60:61], v18 offset:24576
    ds_read_b64_tr_b16 a[62:63], v18 offset:25600
    s_waitcnt vmcnt(8) lgkmcnt(0)
    s_barrier
    s_add_u32 m0, s75, 131072
    s_nop 0
    buffer_load_dwordx4 v184, s[64:67], s72 offen offset:0 lds
    buffer_load_dwordx4 v185, s[64:67], s72 offen offset:1024 lds
    s_add_u32 m0, s75, 139264
    s_nop 0
    buffer_load_dwordx4 v184, s[68:71], s72 offen offset:0 lds
    buffer_load_dwordx4 v185, s[68:71], s72 offen offset:1024 lds
    s_add_u32 s72, s72, s73
    s_cmp_eq_u32 s72, s74
    s_cselect_b32 s72, 0, s72
    s_add_u32 m0, s75, 147456
    s_nop 0
    buffer_load_dwordx4 v184, s[64:67], s72 offen offset:0 lds
    buffer_load_dwordx4 v185, s[64:67], s72 offen offset:1024 lds
    s_add_u32 m0, s75, 155648
    s_nop 0
    buffer_load_dwordx4 v184, s[68:71], s72 offen offset:0 lds
    buffer_load_dwordx4 v185, s[68:71], s72 offen offset:1024 lds
    s_add_u32 s72, s72, s73
    s_cmp_eq_u32 s72, s74
    s_cselect_b32 s72, 0, s72
    ds_read_b64_tr_b16 a[64:65], v14 offset:32768
    ds_read_b64_tr_b16 a[66:67], v14 offset:33792
    ds_read_b64_tr_b16 a[68:69], v17 offset:32768
    ds_read_b64_tr_b16 a[70:71], v17 offset:33792
    ds_read_b64_tr_b16 a[72:73], v14 offset:40960
    ds_read_b64_tr_b16 a[74:75], v14 offset:41984
    ds_read_b64_tr_b16 a[76:77], v17 offset:40960
    ds_read_b64_tr_b16 a[78:79], v17 offset:41984
    ds_read_b64_tr_b16 a[80:81], v14 offset:49152
    ds_read_b64_tr_b16 a[82:83], v14 offset:50176
    ds_read_b64_tr_b16 a[84:85], v17 offset:49152
    ds_read_b64_tr_b16 a[86:87], v17 offset:50176
    ds_read_b64_tr_b16 a[88:89], v14 offset:57344
    ds_read_b64_tr_b16 a[90:91], v14 offset:58368
    ds_read_b64_tr_b16 a[92:93], v17 offset:57344
    ds_read_b64_tr_b16 a[94:95], v17 offset:58368
    s_waitcnt vmcnt(8) lgkmcnt(0)
    s_barrier
    buffer_load_dword v2, v26, s[52:55], 0 offen sc1
    s_add_u32 m0, s75, 98304
    s_nop 0
    buffer_load_dwordx4 v184, s[64:67], s72 offen offset:0 lds
    buffer_load_dwordx4 v185, s[64:67], s72 offen offset:1024 lds
    s_add_u32 m0, s75, 106496
    s_nop 0
    buffer_load_dwordx4 v184, s[68:71], s72 offen offset:0 lds
    buffer_load_dwordx4 v185, s[68:71], s72 offen offset:1024 lds
    s_add_u32 s72, s72, s73
    s_cmp_eq_u32 s72, s74
    s_cselect_b32 s72, 0, s72
    s_add_u32 m0, s75, 114688
    s_nop 0
    buffer_load_dwordx4 v184, s[64:67], s72 offen offset:0 lds
    buffer_load_dwordx4 v185, s[64:67], s72 offen offset:1024 lds
    s_add_u32 m0, s75, 122880
    s_nop 0
    buffer_load_dwordx4 v184, s[68:71], s72 offen offset:0 lds
    buffer_load_dwordx4 v185, s[68:71], s72 offen offset:1024 lds
    s_add_u32 s72, s72, s73
    s_cmp_eq_u32 s72, s74
    s_cselect_b32 s72, 0, s72
    ds_read_b64_tr_b16 a[96:97], v14 offset:0
    ds_read_b64_tr_b16 a[98:99], v14 offset:1024
    ds_read_b64_tr_b16 a[100:101], v17 offset:0
    ds_read_b64_tr_b16 a[102:103], v17 offset:1024
    ds_read_b64_tr_b16 a[104:105], v14 offset:8192
    ds_read_b64_tr_b16 a[106:107], v14 offset:9216
    ds_read_b64_tr_b16 a[108:109], v17 offset:8192
    ds_read_b64_tr_b16 a[110:111], v17 offset:9216
    ds_read_b64_tr_b16 a[112:113], v14 offset:16384
    ds_read_b64_tr_b16 a[114:115], v14 offset:17408
    ds_read_b64_tr_b16 a[116:117], v17 offset:16384
    ds_read_b64_tr_b16 a[118:119], v17 offset:17408
    ds_read_b64_tr_b16 a[120:121], v14 offset:24576
    ds_read_b64_tr_b16 a[122:123], v14 offset:25600
    ds_read_b64_tr_b16 a[124:125], v17 offset:24576
    ds_read_b64_tr_b16 a[126:127], v17 offset:25600
    s_waitcnt vmcnt(9) lgkmcnt(0)
    s_barrier
    s_waitcnt vmcnt(8)
    s_mov_b32 s30, 0
fnet_glu_kernel_poll_15:
    v_cmp_eq_u32 vcc, s92, v2
    s_cmp_eq_u64 vcc, -1
    s_cbranch_scc1 fnet_glu_kernel_pok_16
    s_add_u32 s30, s30, 1
    s_cmp_gt_u32 s30, 0x40000
    s_cbranch_scc1 fnet_glu_kernel_pok_16
    buffer_load_dword v2, v26, s[52:55], 0 offen sc1
    s_waitcnt vmcnt(0)
    s_branch fnet_glu_kernel_poll_15
fnet_glu_kernel_pok_16:
    s_add_u32 m0, s59, 0
    s_nop 0
    buffer_load_dwordx4 v7, s[16:19], s93 offen sc1 lds
    s_add_u32 m0, s59, 1024
    s_nop 0
    buffer_load_dwordx4 v7, s[16:19], s94 offen sc1 lds
    s_add_u32 m0, s59, 2048
    s_nop 0
    buffer_load_dwordx4 v7, s[16:19], s95 offen sc1 lds
    s_add_u32 m0, s59, 3072
    s_nop 0
    buffer_load_dwordx4 v7, s[16:19], s96 offen sc1 lds
    s_add_u32 m0, s59, 4096
    s_nop 0
    buffer_load_dwordx4 v7, s[16:19], s97 offen sc1 lds
    s_add_u32 m0, s59, 5120
    s_nop 0
    buffer_load_dwordx4 v7, s[16:19], s98 offen sc1 lds
    s_add_u32 m0, s59, 6144
    s_nop 0
    buffer_load_dwordx4 v7, s[16:19], s99 offen sc1 lds
    s_add_u32 m0, s59, 7168
    s_nop 0
    buffer_load_dwordx4 v7, s[16:19], s100 offen sc1 lds
    s_add_u32 m0, s59, 8192
    s_nop 0
    buffer_load_dwordx4 v7, s[16:19], s101 offen sc1 lds
    s_add_u32 s59, s59, 36864
    s_cmp_eq_u32 s59, s58
    s_cselect_b32 s59, s38, s59
    v_add_u32 v7, 36864, v7
    ds_read_b64_tr_b16 a[128:129], v15 offset:0
    ds_read_b64_tr_b16 a[130:131], v15 offset:1024
    ds_read_b64_tr_b16 a[132:133], v18 offset:0
    ds_read_b64_tr_b16 a[134:135], v18 offset:1024
    ds_read_b64_tr_b16 a[136:137], v15 offset:8192
    ds_read_b64_tr_b16 a[138:139], v15 offset:9216
    ds_read_b64_tr_b16 a[140:141], v18 offset:8192
    ds_read_b64_tr_b16 a[142:143], v18 offset:9216
    ds_read_b64_tr_b16 a[144:145], v15 offset:16384
    ds_read_b64_tr_b16 a[146:147], v15 offset:17408
    ds_read_b64_tr_b16 a[148:149], v18 offset:16384
    ds_read_b64_tr_b16 a[150:151], v18 offset:17408
    ds_read_b64_tr_b16 a[152:153], v15 offset:24576
    ds_read_b64_tr_b16 a[154:155], v15 offset:25600
    ds_read_b64_tr_b16 a[156:157], v18 offset:24576
    ds_read_b64_tr_b16 a[158:159], v18 offset:25600
    s_waitcnt vmcnt(9) lgkmcnt(0)
    s_barrier
    s_add_u32 m0, s75, 131072
    s_nop 0
    buffer_load_dwordx4 v184, s[64:67], s72 offen offset:0 lds
    buffer_load_dwordx4 v185, s[64:67], s72 offen offset:1024 lds
    s_add_u32 m0, s75, 139264
    s_nop 0
    buffer_load_dwordx4 v184, s[68:71], s72 offen offset:0 lds
    buffer_load_dwordx4 v185, s[68:71], s72 offen offset:1024 lds
    s_add_u32 s72, s72, s73
    s_cmp_eq_u32 s72, s74
    s_cselect_b32 s72, 0, s72
    s_add_u32 m0, s75, 147456
    s_nop 0
    buffer_load_dwordx4 v184, s[64:67], s72 offen offset:0 lds
    buffer_load_dwordx4 v185, s[64:67], s72 offen offset:1024 lds
    s_add_u32 m0, s75, 155648
    s_nop 0
    buffer_load_dwordx4 v184, s[68:71], s72 offen offset:0 lds
    buffer_load_dwordx4 v185, s[68:71], s72 offen offset:1024 lds
    s_add_u32 s72, s72, s73
    s_cmp_eq_u32 s72, s74
    s_cselect_b32 s72, 0, s72
    ds_read_b64_tr_b16 a[160:161], v14 offset:32768
    ds_read_b64_tr_b16 a[162:163], v14 offset:33792
    ds_read_b64_tr_b16 a[164:165], v17 offset:32768
    ds_read_b64_tr_b16 a[166:167], v17 offset:33792
    ds_read_b64_tr_b16 a[168:169], v14 offset:40960
    ds_read_b64_tr_b16 a[170:171], v14 offset:41984
    ds_read_b64_tr_b16 a[172:173], v17 offset:40960
    ds_read_b64_tr_b16 a[174:175], v17 offset:41984
    ds_read_b64_tr_b16 a[176:177], v14 offset:49152
    ds_read_b64_tr_b16 a[178:179], v14 offset:50176
    ds_read_b64_tr_b16 a[180:181], v17 offset:49152
    ds_read_b64_tr_b16 a[182:183], v17 offset:50176
    ds_read_b64_tr_b16 a[184:185], v14 offset:57344
    ds_read_b64_tr_b16 a[186:187], v14 offset:58368
    ds_read_b64_tr_b16 a[188:189], v17 offset:57344
    ds_read_b64_tr_b16 a[190:191], v17 offset:58368
    s_waitcnt vmcnt(8) lgkmcnt(0)
    s_barrier
    ds_read_b128 v[32:35], v10 offset:0
    ds_read_b128 v[36:39], v10 offset:1024
    ds_read_b128 v[40:43], v10 offset:18432
    ds_read_b128 v[44:47], v10 offset:19456
    ds_read_b128 v[48:51], v10 offset:2048
    ds_read_b128 v[52:55], v10 offset:3072
    v_mov_b32 v11, v10
    v_add_u32 v12, 36864, v10
    s_mov_b32 s57, 36864
    s_mov_b32 s35, s36
    s_add_u32 s36, s36, s39
    s_sub_u32 s63, s63, 2
    s_getpc_b64 s[30:31]
fnet_glu_kernel_pc_17:
    s_sub_u32 s30, s30, fnet_glu_kernel_pc_17-Lfnet_glu_kernel_beg
    s_subb_u32 s31, s31, 0
    v_mov_b32 v23, s31
    v_mov_b32 v22, s2
    v_bfe_u32 v22, v22, 3, 3
    v_lshl_add_u32 v22, v22, 2, s3
    v_and_b32 v24, 15, v0
    v_lshl_add_u32 v22, v22, 4, v24
    v_lshlrev_b32 v22, 7, v22
    v_min_u32 v22, fnet_glu_kernel_end-Lfnet_glu_kernel_beg, v22
    v_add_co_u32 v22, vcc, s30, v22
    v_addc_co_u32 v23, vcc, 0, v23, vcc
    global_load_dword v21, v[22:23], off
    s_waitcnt lgkmcnt(4)
    v_mfma_f32_16x16x32_bf16 v[96:99], a[0:3], v[32:35], 0
    s_add_u32 m0, s75, 98304
    v_mfma_f32_16x16x32_bf16 v[96:99], a[16:19], v[36:39], v[96:99]
    buffer_load_dwordx4 v184, s[64:67], s72 offen offset:0 lds
    v_mfma_f32_16x16x32_bf16 v[100:103], a[4:7], v[32:35], 0
    buffer_load_dwordx4 v185, s[64:67], s72 offen offset:1024 lds
    v_mfma_f32_16x16x32_bf16 v[100:103], a[20:23], v[36:39], v[100:103]
    s_add_u32 m0, s75, 106496
    v_mfma_f32_16x16x32_bf16 v[104:107], a[8:11], v[32:35], 0
    s_waitcnt vmcnt(3) lgkmcnt(0)
    s_barrier
    v_mfma_f32_16x16x32_bf16 v[104:107], a[24:27], v[36:39], v[104:107]
    ds_read_b64_tr_b16 a[192:193], v15 offset:0
    v_mfma_f32_16x16x32_bf16 v[108:111], a[12:15], v[32:35], 0
    ds_read_b128 v[32:35], v11 offset:20480
    v_mfma_f32_16x16x32_bf16 v[108:111], a[28:31], v[36:39], v[108:111]
    ds_read_b128 v[36:39], v11 offset:21504
    v_mfma_f32_16x16x32_bf16 v[80:83], a[0:3], v[40:43], 0
    ds_read_b64_tr_b16 a[194:195], v15 offset:1024
    v_mfma_f32_16x16x32_bf16 v[80:83], a[16:19], v[44:47], v[80:83]
    ds_read_b64_tr_b16 a[196:197], v18 offset:0
    v_mfma_f32_16x16x32_bf16 v[84:87], a[4:7], v[40:43], 0
    ds_read_b64_tr_b16 a[198:199], v18 offset:1024
    v_mfma_f32_16x16x32_bf16 v[84:87], a[20:23], v[44:47], v[84:87]
    ds_read_b64_tr_b16 a[200:201], v15 offset:8192
    v_mfma_f32_16x16x32_bf16 v[88:91], a[8:11], v[40:43], 0
    buffer_load_dwordx4 v184, s[68:71], s72 offen offset:0 lds
    v_mfma_f32_16x16x32_bf16 v[88:91], a[24:27], v[44:47], v[88:91]
    ds_read_b64_tr_b16 a[202:203], v15 offset:9216
    v_mfma_f32_16x16x32_bf16 v[92:95], a[12:15], v[40:43], 0
    ds_read_b128 v[40:43], v11 offset:4096
    v_mfma_f32_16x16x32_bf16 v[92:95], a[28:31], v[44:47], v[92:95]
    ds_read_b128 v[44:47], v11 offset:5120
    v_mfma_f32_16x16x32_bf16 v[96:99], a[32:35], v[48:51], v[96:99]
    ds_read_b64_tr_b16 a[204:205], v18 offset:8192
    v_mfma_f32_16x16x32_bf16 v[96:99], a[48:51], v[52:55], v[96:99]
    ds_read_b64_tr_b16 a[206:207], v18 offset:9216
    v_mfma_f32_16x16x32_bf16 v[100:103], a[36:39], v[48:51], v[100:103]
    ds_read_b64_tr_b16 a[208:209], v15 offset:16384
    v_mfma_f32_16x16x32_bf16 v[100:103], a[52:55], v[52:55], v[100:103]
    ds_read_b64_tr_b16 a[210:211], v15 offset:17408
    v_mfma_f32_16x16x32_bf16 v[104:107], a[40:43], v[48:51], v[104:107]
    buffer_load_dwordx4 v185, s[68:71], s72 offen offset:1024 lds
    s_add_u32 s72, s72, s73
    s_cmp_eq_u32 s72, s74
    s_cselect_b32 s72, 0, s72
    v_mfma_f32_16x16x32_bf16 v[104:107], a[56:59], v[52:55], v[104:107]
    ds_read_b64_tr_b16 a[212:213], v18 offset:16384
    s_add_u32 m0, s75, 114688
    v_mfma_f32_16x16x32_bf16 v[108:111], a[44:47], v[48:51], v[108:111]
    ds_read_b128 v[48:51], v11 offset:22528
    buffer_load_dwordx4 v184, s[64:67], s72 offen offset:0 lds
    v_mfma_f32_16x16x32_bf16 v[108:111], a[60:63], v[52:55], v[108:111]
    s_waitcnt lgkmcnt(13)
    ds_read_b128 v[52:55], v11 offset:23552
    v_mfma_f32_16x16x32_bf16 v[80:83], a[32:35], v[32:35], v[80:83]
    ds_read_b64_tr_b16 a[214:215], v18 offset:17408
    buffer_load_dwordx4 v185, s[64:67], s72 offen offset:1024 lds
    v_mfma_f32_16x16x32_bf16 v[80:83], a[48:51], v[36:39], v[80:83]
    ds_read_b64_tr_b16 a[216:217], v15 offset:24576
    s_add_u32 m0, s75, 122880
    v_mfma_f32_16x16x32_bf16 v[84:87], a[36:39], v[32:35], v[84:87]
    ds_read_b64_tr_b16 a[218:219], v15 offset:25600
    buffer_load_dwordx4 v184, s[68:71], s72 offen offset:0 lds
    buffer_load_dwordx4 v185, s[68:71], s72 offen offset:1024 lds
    s_add_u32 s72, s72, s73
    s_cmp_eq_u32 s72, s74
    s_cselect_b32 s72, 0, s72
    s_add_u32 m0, s59, 0
    v_mfma_f32_16x16x32_bf16 v[84:87], a[52:55], v[36:39], v[84:87]
    ds_read_b64_tr_b16 a[220:221], v18 offset:24576
    buffer_load_dwordx4 v7, s[16:19], s93 offen sc1 lds
    s_add_u32 m0, s59, 1024
    v_mfma_f32_16x16x32_bf16 v[88:91], a[40:43], v[32:35], v[88:91]
    buffer_load_dwordx4 v7, s[16:19], s94 offen sc1 lds
    s_add_u32 m0, s59, 2048
    v_mfma_f32_16x16x32_bf16 v[88:91], a[56:59], v[36:39], v[88:91]
    ds_read_b64_tr_b16 a[222:223], v18 offset:25600
    buffer_load_dwordx4 v7, s[16:19], s95 offen sc1 lds
    s_add_u32 m0, s59, 3072
    v_mfma_f32_16x16x32_bf16 v[92:95], a[44:47], v[32:35], v[92:95]
    ds_read_b128 v[32:35], v11 offset:6144
    buffer_load_dwordx4 v7, s[16:19], s96 offen sc1 lds
    s_add_u32 m0, s59, 4096
    v_mfma_f32_16x16x32_bf16 v[92:95], a[60:63], v[36:39], v[92:95]
    s_waitcnt lgkmcnt(13)
    ds_read_b128 v[36:39], v11 offset:7168
    buffer_load_dwordx4 v7, s[16:19], s97 offen sc1 lds
    s_add_u32 m0, s59, 5120
    v_mfma_f32_16x16x32_bf16 v[96:99], a[64:67], v[40:43], v[96:99]
    buffer_load_dwordx4 v7, s[16:19], s98 offen sc1 lds
    s_add_u32 m0, s59, 6144
    v_mfma_f32_16x16x32_bf16 v[96:99], a[80:83], v[44:47], v[96:99]
    buffer_load_dwordx4 v7, s[16:19], s99 offen sc1 lds
    s_add_u32 m0, s59, 7168
    v_mfma_f32_16x16x32_bf16 v[100:103], a[68:71], v[40:43], v[100:103]
    buffer_load_dwordx4 v7, s[16:19], s100 offen sc1 lds
    s_add_u32 m0, s59, 8192
    v_mfma_f32_16x16x32_bf16 v[100:103], a[84:87], v[44:47], v[100:103]
    buffer_load_dwordx4 v7, s[16:19], s101 offen sc1 lds
    s_add_u32 s59, s59, 36864
    s_cmp_eq_u32 s59, s58
    s_cselect_b32 s59, s38, s59
    v_add_u32 v7, 36864, v7
    v_mfma_f32_16x16x32_bf16 v[104:107], a[72:75], v[40:43], v[104:107]
    s_waitcnt vmcnt(9) lgkmcnt(0)
    s_barrier
    v_mfma_f32_16x16x32_bf16 v[104:107], a[88:91], v[44:47], v[104:107]
    ds_read_b64_tr_b16 a[224:225], v14 offset:32768
    s_add_u32 m0, s75, 131072
    v_mfma_f32_16x16x32_bf16 v[108:111], a[76:79], v[40:43], v[108:111]
    ds_read_b128 v[40:43], v11 offset:24576
    v_mfma_f32_16x16x32_bf16 v[108:111], a[92:95], v[44:47], v[108:111]
    ds_read_b128 v[44:47], v11 offset:25600
    v_mfma_f32_16x16x32_bf16 v[80:83], a[64:67], v[48:51], v[80:83]
    ds_read_b64_tr_b16 a[226:227], v14 offset:33792
    v_mfma_f32_16x16x32_bf16 v[80:83], a[80:83], v[52:55], v[80:83]
    ds_read_b64_tr_b16 a[228:229], v17 offset:32768
    v_mfma_f32_16x16x32_bf16 v[84:87], a[68:71], v[48:51], v[84:87]
    buffer_load_dwordx4 v184, s[64:67], s72 offen offset:0 lds
    v_mfma_f32_16x16x32_bf16 v[84:87], a[84:87], v[52:55], v[84:87]
    ds_read_b64_tr_b16 a[230:231], v17 offset:33792
    v_mfma_f32_16x16x32_bf16 v[88:91], a[72:75], v[48:51], v[88:91]
    buffer_load_dwordx4 v185, s[64:67], s72 offen offset:1024 lds
    s_add_u32 m0, s75, 139264
    v_mfma_f32_16x16x32_bf16 v[88:91], a[88:91], v[52:55], v[88:91]
    buffer_load_dwordx4 v184, s[68:71], s72 offen offset:0 lds
    v_mfma_f32_16x16x32_bf16 v[92:95], a[76:79], v[48:51], v[92:95]
    ds_read_b128 v[48:51], v11 offset:8192
    v_mfma_f32_16x16x32_bf16 v[92:95], a[92:95], v[52:55], v[92:95]
    ds_read_b128 v[52:55], v11 offset:9216
    v_mfma_f32_16x16x32_bf16 v[96:99], a[96:99], v[32:35], v[96:99]
    ds_read_b64_tr_b16 a[232:233], v14 offset:40960
    v_mfma_f32_16x16x32_bf16 v[96:99], a[112:115], v[36:39], v[96:99]
    ds_read_b64_tr_b16 a[234:235], v14 offset:41984
    v_mfma_f32_16x16x32_bf16 v[100:103], a[100:103], v[32:35], v[100:103]
    ds_read_b64_tr_b16 a[236:237], v17 offset:40960
    v_mfma_f32_16x16x32_bf16 v[100:103], a[116:119], v[36:39], v[100:103]
    buffer_load_dwordx4 v185, s[68:71], s72 offen offset:1024 lds
    v_mfma_f32_16x16x32_bf16 v[104:107], a[104:107], v[32:35], v[104:107]
    ds_read_b64_tr_b16 a[238:239], v17 offset:41984
    v_mfma_f32_16x16x32_bf16 v[104:107], a[120:123], v[36:39], v[104:107]
    s_add_u32 s72, s72, s73
    s_cmp_eq_u32 s72, s74
    s_cselect_b32 s72, 0, s72
    v_mfma_f32_16x16x32_bf16 v[108:111], a[108:111], v[32:35], v[108:111]
    ds_read_b128 v[32:35], v11 offset:26624
    s_add_u32 m0, s75, 147456
    v_mfma_f32_16x16x32_bf16 v[108:111], a[124:127], v[36:39], v[108:111]
    s_waitcnt lgkmcnt(10)
    ds_read_b128 v[36:39], v11 offset:27648
    v_mfma_f32_16x16x32_bf16 v[80:83], a[96:99], v[40:43], v[80:83]
    ds_read_b64_tr_b16 a[240:241], v14 offset:49152
    v_mfma_f32_16x16x32_bf16 v[80:83], a[112:115], v[44:47], v[80:83]
    ds_read_b64_tr_b16 a[242:243], v14 offset:50176
    v_mfma_f32_16x16x32_bf16 v[84:87], a[100:103], v[40:43], v[84:87]
    buffer_load_dwordx4 v184, s[64:67], s72 offen offset:0 lds
    buffer_load_dwordx4 v185, s[64:67], s72 offen offset:1024 lds
    v_mfma_f32_16x16x32_bf16 v[84:87], a[116:119], v[44:47], v[84:87]
    ds_read_b64_tr_b16 a[244:245], v17 offset:49152
    s_add_u32 m0, s75, 155648
    v_mfma_f32_16x16x32_bf16 v[88:91], a[104:107], v[40:43], v[88:91]
    buffer_load_dwordx4 v184, s[68:71], s72 offen offset:0 lds
    buffer_load_dwordx4 v185, s[68:71], s72 offen offset:1024 lds
    s_add_u32 s72, s72, s73
    s_cmp_eq_u32 s72, s74
    s_cselect_b32 s72, 0, s72
    v_mfma_f32_16x16x32_bf16 v[88:91], a[120:123], v[44:47], v[88:91]
    ds_read_b64_tr_b16 a[246:247], v17 offset:50176
    v_mfma_f32_16x16x32_bf16 v[92:95], a[108:111], v[40:43], v[92:95]
    ds_read_b128 v[40:43], v11 offset:10240
    v_mfma_f32_16x16x32_bf16 v[92:95], a[124:127], v[44:47], v[92:95]
    s_waitcnt lgkmcnt(11)
    ds_read_b128 v[44:47], v11 offset:11264
    v_mfma_f32_16x16x32_bf16 v[96:99], a[128:131], v[48:51], v[96:99]
    ds_read_b64_tr_b16 a[248:249], v14 offset:57344
    v_mfma_f32_16x16x32_bf16 v[96:99], a[144:147], v[52:55], v[96:99]
    buffer_load_dword v2, v8, s[52:55], 0 offen sc1
    v_mfma_f32_16x16x32_bf16 v[100:103], a[132:135], v[48:51], v[100:103]
    ds_read_b64_tr_b16 a[250:251], v14 offset:58368
    v_mfma_f32_16x16x32_bf16 v[100:103], a[148:151], v[52:55], v[100:103]
    v_mfma_f32_16x16x32_bf16 v[104:107], a[136:139], v[48:51], v[104:107]
    ds_read_b64_tr_b16 a[252:253], v17 offset:57344
    v_mfma_f32_16x16x32_bf16 v[104:107], a[152:155], v[52:55], v[104:107]
    v_mfma_f32_16x16x32_bf16 v[108:111], a[140:143], v[48:51], v[108:111]
    ds_read_b128 v[48:51], v11 offset:28672
    v_mfma_f32_16x16x32_bf16 v[108:111], a[156:159], v[52:55], v[108:111]
    s_waitcnt lgkmcnt(10)
    ds_read_b128 v[52:55], v11 offset:29696
    v_mfma_f32_16x16x32_bf16 v[80:83], a[128:131], v[32:35], v[80:83]
    ds_read_b64_tr_b16 a[254:255], v17 offset:58368
    v_mfma_f32_16x16x32_bf16 v[80:83], a[144:147], v[36:39], v[80:83]
    v_mfma_f32_16x16x32_bf16 v[84:87], a[132:135], v[32:35], v[84:87]
    v_mfma_f32_16x16x32_bf16 v[84:87], a[148:151], v[36:39], v[84:87]
    v_mfma_f32_16x16x32_bf16 v[88:91], a[136:139], v[32:35], v[88:91]
    v_mfma_f32_16x16x32_bf16 v[88:91], a[152:155], v[36:39], v[88:91]
    v_mfma_f32_16x16x32_bf16 v[92:95], a[140:143], v[32:35], v[92:95]
    ds_read_b128 v[32:35], v11 offset:12288
    v_mfma_f32_16x16x32_bf16 v[92:95], a[156:159], v[36:39], v[92:95]
    s_waitcnt lgkmcnt(7)
    ds_read_b128 v[36:39], v11 offset:13312
    v_mfma_f32_16x16x32_bf16 v[96:99], a[160:163], v[40:43], v[96:99]
    v_mfma_f32_16x16x32_bf16 v[96:99], a[176:179], v[44:47], v[96:99]
    v_mfma_f32_16x16x32_bf16 v[100:103], a[164:167], v[40:43], v[100:103]
    v_mfma_f32_16x16x32_bf16 v[100:103], a[180:183], v[44:47], v[100:103]
    v_mfma_f32_16x16x32_bf16 v[104:107], a[168:171], v[40:43], v[104:107]
    v_mfma_f32_16x16x32_bf16 v[104:107], a[184:187], v[44:47], v[104:107]
    v_mfma_f32_16x16x32_bf16 v[108:111], a[172:175], v[40:43], v[108:111]
    ds_read_b128 v[40:43], v11 offset:30720
    v_mfma_f32_16x16x32_bf16 v[108:111], a[188:191], v[44:47], v[108:111]
    s_waitcnt lgkmcnt(4)
    ds_read_b128 v[44:47], v11 offset:31744
    v_mfma_f32_16x16x32_bf16 v[80:83], a[160:163], v[48:51], v[80:83]
    v_mfma_f32_16x16x32_bf16 v[80:83], a[176:179], v[52:55], v[80:83]
    v_mfma_f32_16x16x32_bf16 v[84:87], a[164:167], v[48:51], v[84:87]
    v_mfma_f32_16x16x32_bf16 v[84:87], a[180:183], v[52:55], v[84:87]
    v_mfma_f32_16x16x32_bf16 v[88:91], a[168:171], v[48:51], v[88:91]
    v_mfma_f32_16x16x32_bf16 v[88:91], a[184:187], v[52:55], v[88:91]
    v_mfma_f32_16x16x32_bf16 v[92:95], a[172:175], v[48:51], v[92:95]
    ds_read_b128 v[48:51], v11 offset:14336
    v_mfma_f32_16x16x32_bf16 v[92:95], a[188:191], v[52:55], v[92:95]
    s_waitcnt lgkmcnt(3)
    ds_read_b128 v[52:55], v11 offset:15360
    v_mfma_f32_16x16x32_bf16 v[96:99], a[192:195], v[32:35], v[96:99]
    v_mfma_f32_16x16x32_bf16 v[96:99], a[208:211], v[36:39], v[96:99]
    v_mfma_f32_16x16x32_bf16 v[100:103], a[196:199], v[32:35], v[100:103]
    v_mfma_f32_16x16x32_bf16 v[100:103], a[212:215], v[36:39], v[100:103]
    v_mfma_f32_16x16x32_bf16 v[104:107], a[200:203], v[32:35], v[104:107]
    s_waitcnt vmcnt(1) lgkmcnt(0)
    s_barrier
    v_mfma_f32_16x16x32_bf16 v[104:107], a[216:219], v[36:39], v[104:107]
    ds_read_b64_tr_b16 v[224:225], v15 offset:0
    v_mfma_f32_16x16x32_bf16 v[108:111], a[204:207], v[32:35], v[108:111]
    ds_read_b128 v[32:35], v11 offset:32768
    v_mfma_f32_16x16x32_bf16 v[108:111], a[220:223], v[36:39], v[108:111]
    ds_read_b128 v[36:39], v11 offset:33792
    v_mfma_f32_16x16x32_bf16 v[80:83], a[192:195], v[40:43], v[80:83]
    ds_read_b64_tr_b16 v[226:227], v15 offset:1024
    v_mfma_f32_16x16x32_bf16 v[80:83], a[208:211], v[44:47], v[80:83]
    ds_read_b64_tr_b16 v[228:229], v18 offset:0
    v_mfma_f32_16x16x32_bf16 v[84:87], a[196:199], v[40:43], v[84:87]
    ds_read_b64_tr_b16 v[230:231], v18 offset:1024
    v_mfma_f32_16x16x32_bf16 v[84:87], a[212:215], v[44:47], v[84:87]
    ds_read_b64_tr_b16 v[232:233], v15 offset:8192
    v_mfma_f32_16x16x32_bf16 v[88:91], a[200:203], v[40:43], v[88:91]
    ds_read_b64_tr_b16 v[234:235], v15 offset:9216
    v_mfma_f32_16x16x32_bf16 v[88:91], a[216:219], v[44:47], v[88:91]
    ds_read_b64_tr_b16 v[236:237], v18 offset:8192
    v_mfma_f32_16x16x32_bf16 v[92:95], a[204:207], v[40:43], v[92:95]
    ds_read_b128 v[40:43], v11 offset:16384
    v_mfma_f32_16x16x32_bf16 v[92:95], a[220:223], v[44:47], v[92:95]
    ds_read_b128 v[44:47], v11 offset:17408
    v_mfma_f32_16x16x32_bf16 v[96:99], a[224:227], v[48:51], v[96:99]
    ds_read_b64_tr_b16 v[238:239], v18 offset:9216
    v_mfma_f32_16x16x32_bf16 v[96:99], a[240:243], v[52:55], v[96:99]
    ds_read_b64_tr_b16 v[240:241], v15 offset:16384
    v_mfma_f32_16x16x32_bf16 v[100:103], a[228:231], v[48:51], v[100:103]
    ds_read_b64_tr_b16 v[242:243], v15 offset:17408
    v_mfma_f32_16x16x32_bf16 v[100:103], a[244:247], v[52:55], v[100:103]
    ds_read_b64_tr_b16 v[244:245], v18 offset:16384
    v_mfma_f32_16x16x32_bf16 v[104:107], a[232:235], v[48:51], v[104:107]
    ds_read_b64_tr_b16 v[246:247], v18 offset:17408
    v_mfma_f32_16x16x32_bf16 v[104:107], a[248:251], v[52:55], v[104:107]
    ds_read_b64_tr_b16 v[248:249], v15 offset:24576
    v_mfma_f32_16x16x32_bf16 v[108:111], a[236:239], v[48:51], v[108:111]
    ds_read_b128 v[48:51], v11 offset:34816
    v_mfma_f32_16x16x32_bf16 v[108:111], a[252:255], v[52:55], v[108:111]
    s_waitcnt lgkmcnt(15)
    ds_read_b128 v[52:55], v11 offset:35840
    v_mfma_f32_16x16x32_bf16 v[80:83], a[224:227], v[32:35], v[80:83]
    ds_read_b64_tr_b16 v[250:251], v15 offset:25600
    v_mfma_f32_16x16x32_bf16 v[80:83], a[240:243], v[36:39], v[80:83]
    ds_read_b64_tr_b16 v[252:253], v18 offset:24576
    ds_read_b64_tr_b16 v[254:255], v18 offset:25600
    v_mfma_f32_16x16x32_bf16 v[84:87], a[228:231], v[32:35], v[84:87]
    s_waitcnt vmcnt(0)
    s_mov_b32 s30, 0
fnet_glu_kernel_poll_18:
    v_cmp_eq_u32 vcc, s92, v2
    s_cmp_eq_u64 vcc, -1
    s_cbranch_scc1 fnet_glu_kernel_pok_19
    s_add_u32 s30, s30, 1
    s_cmp_gt_u32 s30, 0x40000
    s_cbranch_scc1 fnet_glu_kernel_pok_19
    buffer_load_dword v2, v8, s[52:55], 0 offen sc1
    s_waitcnt vmcnt(0)
    s_branch fnet_glu_kernel_poll_18
fnet_glu_kernel_pok_19:
    v_mfma_f32_16x16x32_bf16 v[84:87], a[244:247], v[36:39], v[84:87]
    s_add_u32 m0, s59, 0
    v_mfma_f32_16x16x32_bf16 v[88:91], a[232:235], v[32:35], v[88:91]
    buffer_load_dwordx4 v7, s[16:19], s93 offen sc1 lds
    s_add_u32 m0, s59, 1024
    v_mfma_f32_16x16x32_bf16 v[88:91], a[248:251], v[36:39], v[88:91]
    s_waitcnt lgkmcnt(0)
    s_barrier
    v_mfma_f32_16x16x32_bf16 v[92:95], a[236:239], v[32:35], v[92:95]
    ds_read_b128 v[32:35], v12 offset:0
    v_mfma_f32_16x16x32_bf16 v[92:95], a[252:255], v[36:39], v[92:95]
    ds_read_b128 v[36:39], v12 offset:1024
    v_mfma_f32_16x16x32_bf16 v[96:99], v[224:227], v[40:43], v[96:99]
    buffer_load_dwordx4 v7, s[16:19], s94 offen sc1 lds
    s_add_u32 m0, s59, 2048
    v_mfma_f32_16x16x32_bf16 v[96:99], v[240:243], v[44:47], v[96:99]
    buffer_load_dwordx4 v7, s[16:19], s95 offen sc1 lds
    s_add_u32 m0, s59, 3072
    v_mfma_f32_16x16x32_bf16 v[100:103], v[228:231], v[40:43], v[100:103]
    buffer_load_dwordx4 v7, s[16:19], s96 offen sc1 lds
    s_add_u32 m0, s59, 4096
    v_mfma_f32_16x16x32_bf16 v[100:103], v[244:247], v[44:47], v[100:103]
    buffer_load_dwordx4 v7, s[16:19], s97 offen sc1 lds
    s_add_u32 m0, s59, 5120
    v_mfma_f32_16x16x32_bf16 v[104:107], v[232:235], v[40:43], v[104:107]
    buffer_load_dwordx4 v7, s[16:19], s98 offen sc1 lds
    s_add_u32 m0, s59, 6144
    v_mfma_f32_16x16x32_bf16 v[104:107], v[248:251], v[44:47], v[104:107]
    buffer_load_dwordx4 v7, s[16:19], s99 offen sc1 lds
    s_add_u32 m0, s59, 7168
    v_mfma_f32_16x16x32_bf16 v[108:111], v[236:239], v[40:43], v[108:111]
    ds_read_b128 v[40:43], v12 offset:2048
    v_mfma_f32_16x16x32_bf16 v[108:111], v[252:255], v[44:47], v[108:111]
    ds_read_b128 v[44:47], v12 offset:3072
    v_mfma_f32_16x16x32_bf16 v[80:83], v[224:227], v[48:51], v[80:83]
    buffer_load_dwordx4 v7, s[16:19], s100 offen sc1 lds
    s_add_u32 m0, s59, 8192
    v_mfma_f32_16x16x32_bf16 v[80:83], v[240:243], v[52:55], v[80:83]
    buffer_load_dwordx4 v7, s[16:19], s101 offen sc1 lds
    v_mfma_f32_16x16x32_bf16 v[84:87], v[228:231], v[48:51], v[84:87]
    v_mfma_f32_16x16x32_bf16 v[84:87], v[244:247], v[52:55], v[84:87]
    s_add_u32 s59, s59, 36864
    s_cmp_eq_u32 s59, s58
    s_cselect_b32 s59, s38, s59
    v_mfma_f32_16x16x32_bf16 v[88:91], v[232:235], v[48:51], v[88:91]
    v_mfma_f32_16x16x32_bf16 v[88:91], v[248:251], v[52:55], v[88:91]
    v_add_u32 v7, 36864, v7
    v_mfma_f32_16x16x32_bf16 v[92:95], v[236:239], v[48:51], v[92:95]
    ds_read_b128 v[48:51], v12 offset:4096
    v_mfma_f32_16x16x32_bf16 v[92:95], v[252:255], v[52:55], v[92:95]
    ds_read_b128 v[52:55], v12 offset:5120
    .p2align 6
fnet_glu_kernel_loop_20:
    s_waitcnt lgkmcnt(4)
    v_mfma_f32_16x16x32_bf16 v[64:67], a[0:3], v[32:35], 0
    v_mov_b32 v11, v12
    v_mfma_f32_16x16x32_bf16 v[64:67], a[16:19], v[36:39], v[64:67]
    s_add_u32 s57, s57, 36864
    s_cmp_eq_u32 s57, 147456
    s_cselect_b32 s57, 0, s57
    v_mfma_f32_16x16x32_bf16 v[68:71], a[4:7], v[32:35], 0
    s_add_u32 m0, s59, 0
    v_mfma_f32_16x16x32_bf16 v[68:71], a[20:23], v[36:39], v[68:71]
    s_cmp_le_u32 s63, 5
    s_cselect_b32 s50, s47, 0
    s_cselect_b32 s5, 229376, 0
    v_mfma_f32_16x16x32_bf16 v[72:75], a[8:11], v[32:35], 0
    v_mfma_f32_16x16x32_bf16 v[72:75], a[24:27], v[36:39], v[72:75]
    v_exp_f32 v80, v80
    v_mfma_f32_16x16x32_bf16 v[76:79], a[12:15], v[32:35], 0
    ds_read_b128 v[32:35], v11 offset:6144
    v_mfma_f32_16x16x32_bf16 v[76:79], a[28:31], v[36:39], v[76:79]
    s_waitcnt lgkmcnt(3)
    ds_read_b128 v[36:39], v11 offset:7168
    v_mfma_f32_16x16x32_bf16 v[64:67], a[32:35], v[40:43], v[64:67]
    buffer_load_dwordx4 v7, s[16:19], s93 offen sc1 lds
    v_add_u32 v12, s57, v10
    v_mfma_f32_16x16x32_bf16 v[64:67], a[48:51], v[44:47], v[64:67]
    v_exp_f32 v81, v81
    v_mfma_f32_16x16x32_bf16 v[68:71], a[36:39], v[40:43], v[68:71]
    buffer_load_dword v20, v19, s[48:51], s4 offen
    v_mfma_f32_16x16x32_bf16 v[68:71], a[52:55], v[44:47], v[68:71]
    v_exp_f32 v82, v82
    v_mfma_f32_16x16x32_bf16 v[72:75], a[40:43], v[40:43], v[72:75]
    v_exp_f32 v83, v83
    v_mfma_f32_16x16x32_bf16 v[72:75], a[56:59], v[44:47], v[72:75]
    s_add_u32 m0, s59, 1024
    v_exp_f32 v84, v84
    v_mfma_f32_16x16x32_bf16 v[76:79], a[44:47], v[40:43], v[76:79]
    ds_read_b128 v[40:43], v11 offset:8192
    v_mfma_f32_16x16x32_bf16 v[76:79], a[60:63], v[44:47], v[76:79]
    s_waitcnt lgkmcnt(3)
    ds_read_b128 v[44:47], v11 offset:9216
    v_mfma_f32_16x16x32_bf16 v[64:67], a[64:67], v[48:51], v[64:67]
    v_exp_f32 v85, v85
    v_mfma_f32_16x16x32_bf16 v[64:67], a[80:83], v[52:55], v[64:67]
    v_exp_f32 v86, v86
    v_mfma_f32_16x16x32_bf16 v[68:71], a[68:71], v[48:51], v[68:71]
    v_exp_f32 v87, v87
    v_mfma_f32_16x16x32_bf16 v[68:71], a[84:87], v[52:55], v[68:71]
    buffer_load_dwordx4 v7, s[16:19], s94 offen sc1 lds
    v_add_f32 v80, 1.0, v80
    v_mfma_f32_16x16x32_bf16 v[72:75], a[72:75], v[48:51], v[72:75]
    s_add_u32 s4, s4, s5
    v_add_f32 v81, 1.0, v81
    v_mfma_f32_16x16x32_bf16 v[72:75], a[88:91], v[52:55], v[72:75]
    v_add_f32 v82, 1.0, v82
    v_mfma_f32_16x16x32_bf16 v[76:79], a[76:79], v[48:51], v[76:79]
    ds_read_b128 v[48:51], v11 offset:10240
    v_mfma_f32_16x16x32_bf16 v[76:79], a[92:95], v[52:55], v[76:79]
    s_waitcnt lgkmcnt(3)
    ds_read_b128 v[52:55], v11 offset:11264
    v_mfma_f32_16x16x32_bf16 v[64:67], a[96:99], v[32:35], v[64:67]
    v_add_f32 v83, 1.0, v83
    v_mfma_f32_16x16x32_bf16 v[64:67], a[112:115], v[36:39], v[64:67]
    s_add_u32 m0, s59, 2048
    v_add_f32 v84, 1.0, v84
    v_mfma_f32_16x16x32_bf16 v[68:71], a[100:103], v[32:35], v[68:71]
    v_add_f32 v85, 1.0, v85
    v_mfma_f32_16x16x32_bf16 v[68:71], a[116:119], v[36:39], v[68:71]
    v_mfma_f32_16x16x32_bf16 v[72:75], a[104:107], v[32:35], v[72:75]
    v_add_f32 v86, 1.0, v86
    v_mfma_f32_16x16x32_bf16 v[72:75], a[120:123], v[36:39], v[72:75]
    v_add_f32 v87, 1.0, v87
    v_mfma_f32_16x16x32_bf16 v[76:79], a[108:111], v[32:35], v[76:79]
    ds_read_b128 v[32:35], v11 offset:12288
    v_mfma_f32_16x16x32_bf16 v[76:79], a[124:127], v[36:39], v[76:79]
    s_waitcnt lgkmcnt(3)
    ds_read_b128 v[36:39], v11 offset:13312
    v_mfma_f32_16x16x32_bf16 v[64:67], a[128:131], v[40:43], v[64:67]
    buffer_load_dwordx4 v7, s[16:19], s95 offen sc1 lds
    v_mfma_f32_16x16x32_bf16 v[64:67], a[144:147], v[44:47], v[64:67]
    buffer_load_dword v20, v19, s[48:51], s4 offen
    v_mfma_f32_16x16x32_bf16 v[68:71], a[132:135], v[40:43], v[68:71]
    v_rcp_f32 v80, v80
    v_mfma_f32_16x16x32_bf16 v[68:71], a[148:151], v[44:47], v[68:71]
    v_rcp_f32 v81, v81
    v_mfma_f32_16x16x32_bf16 v[72:75], a[136:139], v[40:43], v[72:75]
    v_rcp_f32 v82, v82
    v_mfma_f32_16x16x32_bf16 v[72:75], a[152:155], v[44:47], v[72:75]
    s_add_u32 m0, s59, 3072
    v_rcp_f32 v83, v83
    v_mfma_f32_16x16x32_bf16 v[76:79], a[140:143], v[40:43], v[76:79]
    ds_read_b128 v[40:43], v11 offset:14336
    v_mfma_f32_16x16x32_bf16 v[76:79], a[156:159], v[44:47], v[76:79]
    s_waitcnt lgkmcnt(3)
    ds_read_b128 v[44:47], v11 offset:15360
    v_mfma_f32_16x16x32_bf16 v[64:67], a[160:163], v[48:51], v[64:67]
    s_add_u32 s4, s4, s5
    v_rcp_f32 v84, v84
    v_mfma_f32_16x16x32_bf16 v[64:67], a[176:179], v[52:55], v[64:67]
    v_rcp_f32 v85, v85
    v_mfma_f32_16x16x32_bf16 v[68:71], a[164:167], v[48:51], v[68:71]
    v_rcp_f32 v86, v86
    v_mfma_f32_16x16x32_bf16 v[68:71], a[180:183], v[52:55], v[68:71]
    buffer_load_dwordx4 v7, s[16:19], s96 offen sc1 lds
    v_mfma_f32_16x16x32_bf16 v[72:75], a[168:171], v[48:51], v[72:75]
    v_rcp_f32 v87, v87
    v_mfma_f32_16x16x32_bf16 v[72:75], a[184:187], v[52:55], v[72:75]
    v_mul_f32 v80, v80, v88
    v_mfma_f32_16x16x32_bf16 v[76:79], a[172:175], v[48:51], v[76:79]
    ds_read_b128 v[48:51], v11 offset:16384
    v_mul_f32 v81, v81, v89
    v_mfma_f32_16x16x32_bf16 v[76:79], a[188:191], v[52:55], v[76:79]
    s_waitcnt lgkmcnt(3)
    ds_read_b128 v[52:55], v11 offset:17408
    v_mfma_f32_16x16x32_bf16 v[64:67], a[192:195], v[32:35], v[64:67]
    v_mul_f32 v82, v82, v90
    v_mfma_f32_16x16x32_bf16 v[64:67], a[208:211], v[36:39], v[64:67]
    s_add_u32 m0, s59, 4096
    v_mul_f32 v83, v83, v91
    v_mfma_f32_16x16x32_bf16 v[68:71], a[196:199], v[32:35], v[68:71]
    buffer_load_dword v20, v19, s[48:51], s4 offen
    v_mfma_f32_16x16x32_bf16 v[68:71], a[212:215], v[36:39], v[68:71]
    v_mul_f32 v84, v84, v92
    v_mfma_f32_16x16x32_bf16 v[72:75], a[200:203], v[32:35], v[72:75]
    v_mfma_f32_16x16x32_bf16 v[72:75], a[216:219], v[36:39], v[72:75]
    v_mul_f32 v85, v85, v93
    v_mfma_f32_16x16x32_bf16 v[76:79], a[204:207], v[32:35], v[76:79]
    ds_read_b128 v[32:35], v11 offset:18432
    v_mul_f32 v86, v86, v94
    v_mfma_f32_16x16x32_bf16 v[76:79], a[220:223], v[36:39], v[76:79]
    s_waitcnt lgkmcnt(3)
    ds_read_b128 v[36:39], v11 offset:19456
    v_mfma_f32_16x16x32_bf16 v[64:67], a[224:227], v[40:43], v[64:67]
    buffer_load_dwordx4 v7, s[16:19], s97 offen sc1 lds
    v_mul_f32 v87, v87, v95
    v_mfma_f32_16x16x32_bf16 v[64:67], a[240:243], v[44:47], v[64:67]
    v_mfma_f32_16x16x32_bf16 v[68:71], a[228:231], v[40:43], v[68:71]
    v_cvt_pk_bf16_f32 v88, v80, v81
    v_mfma_f32_16x16x32_bf16 v[68:71], a[244:247], v[44:47], v[68:71]
    v_cvt_pk_bf16_f32 v89, v82, v83
    v_mfma_f32_16x16x32_bf16 v[72:75], a[232:235], v[40:43], v[72:75]
    s_add_u32 s4, s4, s5
    v_mfma_f32_16x16x32_bf16 v[72:75], a[248:251], v[44:47], v[72:75]
    s_add_u32 m0, s59, 5120
    v_cvt_pk_bf16_f32 v90, v84, v85
    v_mfma_f32_16x16x32_bf16 v[76:79], a[236:239], v[40:43], v[76:79]
    ds_read_b128 v[40:43], v11 offset:20480
    v_mfma_f32_16x16x32_bf16 v[76:79], a[252:255], v[44:47], v[76:79]
    s_waitcnt lgkmcnt(3)
    ds_read_b128 v[44:47], v11 offset:21504
    v_mfma_f32_16x16x32_bf16 v[64:67], v[224:227], v[48:51], v[64:67]
    v_cvt_pk_bf16_f32 v91, v86, v87
    v_mfma_f32_16x16x32_bf16 v[64:67], v[240:243], v[52:55], v[64:67]
    buffer_store_dwordx4 v[88:91], v9, s[40:43], s36 offen sc1
    v_mfma_f32_16x16x32_bf16 v[68:71], v[228:231], v[48:51], v[68:71]
    s_add_u32 s36, s36, s39
    v_mfma_f32_16x16x32_bf16 v[68:71], v[244:247], v[52:55], v[68:71]
    buffer_load_dwordx4 v7, s[16:19], s98 offen sc1 lds
    v_mfma_f32_16x16x32_bf16 v[72:75], v[232:235], v[48:51], v[72:75]
    v_mfma_f32_16x16x32_bf16 v[72:75], v[248:251], v[52:55], v[72:75]
    v_mfma_f32_16x16x32_bf16 v[76:79], v[236:239], v[48:51], v[76:79]
    ds_read_b128 v[48:51], v11 offset:22528
    v_mfma_f32_16x16x32_bf16 v[76:79], v[252:255], v[52:55], v[76:79]
    s_waitcnt lgkmcnt(3)
    ds_read_b128 v[52:55], v11 offset:23552
    s_sub_u32 s63, s63, 1
    s_cmp_eq_u32 s63, 0
    s_cbranch_scc1 fnet_glu_kernel_tailA_21
    v_mfma_f32_16x16x32_bf16 v[80:83], a[0:3], v[32:35], 0
    buffer_load_dword v20, v19, s[48:51], s4 offen
    v_mfma_f32_16x16x32_bf16 v[80:83], a[16:19], v[36:39], v[80:83]
    s_add_u32 m0, s59, 6144
    v_mfma_f32_16x16x32_bf16 v[84:87], a[4:7], v[32:35], 0
    v_mfma_f32_16x16x32_bf16 v[84:87], a[20:23], v[36:39], v[84:87]
    v_mfma_f32_16x16x32_bf16 v[88:91], a[8:11], v[32:35], 0
    v_mfma_f32_16x16x32_bf16 v[88:91], a[24:27], v[36:39], v[88:91]
    v_exp_f32 v64, v64
    v_mfma_f32_16x16x32_bf16 v[92:95], a[12:15], v[32:35], 0
    ds_read_b128 v[32:35], v11 offset:24576
    v_mfma_f32_16x16x32_bf16 v[92:95], a[28:31], v[36:39], v[92:95]
    s_waitcnt lgkmcnt(3)
    ds_read_b128 v[36:39], v11 offset:25600
    v_mfma_f32_16x16x32_bf16 v[80:83], a[32:35], v[40:43], v[80:83]
    buffer_load_dwordx4 v7, s[16:19], s99 offen sc1 lds
    s_add_u32 s4, s4, s5
    v_mfma_f32_16x16x32_bf16 v[80:83], a[48:51], v[44:47], v[80:83]
    v_exp_f32 v65, v65
    v_mfma_f32_16x16x32_bf16 v[84:87], a[36:39], v[40:43], v[84:87]
    v_exp_f32 v66, v66
    v_mfma_f32_16x16x32_bf16 v[84:87], a[52:55], v[44:47], v[84:87]
    v_exp_f32 v67, v67
    v_mfma_f32_16x16x32_bf16 v[88:91], a[40:43], v[40:43], v[88:91]
    v_exp_f32 v68, v68
    v_mfma_f32_16x16x32_bf16 v[88:91], a[56:59], v[44:47], v[88:91]
    s_add_u32 m0, s59, 7168
    v_exp_f32 v69, v69
    v_mfma_f32_16x16x32_bf16 v[92:95], a[44:47], v[40:43], v[92:95]
    ds_read_b128 v[40:43], v11 offset:26624
    v_mfma_f32_16x16x32_bf16 v[92:95], a[60:63], v[44:47], v[92:95]
    s_waitcnt lgkmcnt(3)
    ds_read_b128 v[44:47], v11 offset:27648
    v_mfma_f32_16x16x32_bf16 v[80:83], a[64:67], v[48:51], v[80:83]
    v_exp_f32 v70, v70
    v_mfma_f32_16x16x32_bf16 v[80:83], a[80:83], v[52:55], v[80:83]
    v_exp_f32 v71, v71
    v_mfma_f32_16x16x32_bf16 v[84:87], a[68:71], v[48:51], v[84:87]
    buffer_load_dword v20, v19, s[48:51], s4 offen
    v_add_f32 v64, 1.0, v64
    v_mfma_f32_16x16x32_bf16 v[84:87], a[84:87], v[52:55], v[84:87]
    buffer_load_dwordx4 v7, s[16:19], s100 offen sc1 lds
    v_add_f32 v65, 1.0, v65
    v_mfma_f32_16x16x32_bf16 v[88:91], a[72:75], v[48:51], v[88:91]
    v_mfma_f32_16x16x32_bf16 v[88:91], a[88:91], v[52:55], v[88:91]
    v_add_f32 v66, 1.0, v66
    v_mfma_f32_16x16x32_bf16 v[92:95], a[76:79], v[48:51], v[92:95]
    ds_read_b128 v[48:51], v11 offset:28672
    v_mfma_f32_16x16x32_bf16 v[92:95], a[92:95], v[52:55], v[92:95]
    s_waitcnt lgkmcnt(3)
    ds_read_b128 v[52:55], v11 offset:29696
    v_mfma_f32_16x16x32_bf16 v[80:83], a[96:99], v[32:35], v[80:83]
    v_add_f32 v67, 1.0, v67
    v_mfma_f32_16x16x32_bf16 v[80:83], a[112:115], v[36:39], v[80:83]
    s_add_u32 m0, s59, 8192
    v_add_f32 v68, 1.0, v68
    v_mfma_f32_16x16x32_bf16 v[84:87], a[100:103], v[32:35], v[84:87]
    v_add_f32 v69, 1.0, v69
    v_mfma_f32_16x16x32_bf16 v[84:87], a[116:119], v[36:39], v[84:87]
    v_mfma_f32_16x16x32_bf16 v[88:91], a[104:107], v[32:35], v[88:91]
    s_add_u32 s4, s4, s5
    v_add_f32 v70, 1.0, v70
    v_mfma_f32_16x16x32_bf16 v[88:91], a[120:123], v[36:39], v[88:91]
    v_add_f32 v71, 1.0, v71
    v_mfma_f32_16x16x32_bf16 v[92:95], a[108:111], v[32:35], v[92:95]
    ds_read_b128 v[32:35], v11 offset:30720
    v_mfma_f32_16x16x32_bf16 v[92:95], a[124:127], v[36:39], v[92:95]
    s_waitcnt lgkmcnt(3)
    ds_read_b128 v[36:39], v11 offset:31744
    v_mfma_f32_16x16x32_bf16 v[80:83], a[128:131], v[40:43], v[80:83]
    buffer_load_dwordx4 v7, s[16:19], s101 offen sc1 lds
    v_mfma_f32_16x16x32_bf16 v[80:83], a[144:147], v[44:47], v[80:83]
    v_rcp_f32 v64, v64
    v_mfma_f32_16x16x32_bf16 v[84:87], a[132:135], v[40:43], v[84:87]
    v_rcp_f32 v65, v65
    v_mfma_f32_16x16x32_bf16 v[84:87], a[148:151], v[44:47], v[84:87]
    v_rcp_f32 v66, v66
    v_mfma_f32_16x16x32_bf16 v[88:91], a[136:139], v[40:43], v[88:91]
    v_rcp_f32 v67, v67
    v_mfma_f32_16x16x32_bf16 v[88:91], a[152:155], v[44:47], v[88:91]
    s_add_u32 s59, s59, 36864
    s_cmp_eq_u32 s59, s58
    s_cselect_b32 s59, s38, s59
    v_mfma_f32_16x16x32_bf16 v[92:95], a[140:143], v[40:43], v[92:95]
    ds_read_b128 v[40:43], v11 offset:32768
    v_mfma_f32_16x16x32_bf16 v[92:95], a[156:159], v[44:47], v[92:95]
    s_waitcnt lgkmcnt(3)
    ds_read_b128 v[44:47], v11 offset:33792
    v_mfma_f32_16x16x32_bf16 v[80:83], a[160:163], v[48:51], v[80:83]
    global_load_dword v21, v[22:23], off
    v_mfma_f32_16x16x32_bf16 v[80:83], a[176:179], v[52:55], v[80:83]
    v_rcp_f32 v68, v68
    v_mfma_f32_16x16x32_bf16 v[84:87], a[164:167], v[48:51], v[84:87]
    v_rcp_f32 v69, v69
    v_mfma_f32_16x16x32_bf16 v[84:87], a[180:183], v[52:55], v[84:87]
    v_add_u32 v7, 36864, v7
    v_mfma_f32_16x16x32_bf16 v[88:91], a[168:171], v[48:51], v[88:91]
    v_rcp_f32 v70, v70
    v_mfma_f32_16x16x32_bf16 v[88:91], a[184:187], v[52:55], v[88:91]
    v_rcp_f32 v71, v71
    v_mfma_f32_16x16x32_bf16 v[92:95], a[172:175], v[48:51], v[92:95]
    ds_read_b128 v[48:51], v11 offset:34816
    v_mul_f32 v64, v64, v72
    v_mfma_f32_16x16x32_bf16 v[92:95], a[188:191], v[52:55], v[92:95]
    s_waitcnt lgkmcnt(3)
    ds_read_b128 v[52:55], v11 offset:35840
    v_mfma_f32_16x16x32_bf16 v[80:83], a[192:195], v[32:35], v[80:83]
    v_mul_f32 v65, v65, v73
    v_mfma_f32_16x16x32_bf16 v[80:83], a[208:211], v[36:39], v[80:83]
    v_mul_f32 v66, v66, v74
    v_mfma_f32_16x16x32_bf16 v[84:87], a[196:199], v[32:35], v[84:87]
    v_mul_f32 v67, v67, v75
    v_mfma_f32_16x16x32_bf16 v[84:87], a[212:215], v[36:39], v[84:87]
    v_mul_f32 v68, v68, v76
    v_mfma_f32_16x16x32_bf16 v[88:91], a[200:203], v[32:35], v[88:91]
    v_mfma_f32_16x16x32_bf16 v[88:91], a[216:219], v[36:39], v[88:91]
    s_waitcnt vmcnt(16) lgkmcnt(0)
    s_barrier
    v_mul_f32 v69, v69, v77
    v_mfma_f32_16x16x32_bf16 v[92:95], a[204:207], v[32:35], v[92:95]
    ds_read_b128 v[32:35], v12 offset:0
    v_mul_f32 v70, v70, v78
    v_mfma_f32_16x16x32_bf16 v[92:95], a[220:223], v[36:39], v[92:95]
    ds_read_b128 v[36:39], v12 offset:1024
    v_mfma_f32_16x16x32_bf16 v[80:83], a[224:227], v[40:43], v[80:83]
    v_mul_f32 v71, v71, v79
    v_mfma_f32_16x16x32_bf16 v[80:83], a[240:243], v[44:47], v[80:83]
    v_mfma_f32_16x16x32_bf16 v[84:87], a[228:231], v[40:43], v[84:87]
    v_cvt_pk_bf16_f32 v72, v64, v65
    v_mfma_f32_16x16x32_bf16 v[84:87], a[244:247], v[44:47], v[84:87]
    v_cvt_pk_bf16_f32 v73, v66, v67
    v_mfma_f32_16x16x32_bf16 v[88:91], a[232:235], v[40:43], v[88:91]
    v_mfma_f32_16x16x32_bf16 v[88:91], a[248:251], v[44:47], v[88:91]
    v_cvt_pk_bf16_f32 v74, v68, v69
    v_mfma_f32_16x16x32_bf16 v[92:95], a[236:239], v[40:43], v[92:95]
    ds_read_b128 v[40:43], v12 offset:2048
    v_mfma_f32_16x16x32_bf16 v[92:95], a[252:255], v[44:47], v[92:95]
    ds_read_b128 v[44:47], v12 offset:3072
    v_mfma_f32_16x16x32_bf16 v[80:83], v[224:227], v[48:51], v[80:83]
    v_cvt_pk_bf16_f32 v75, v70, v71
    v_mfma_f32_16x16x32_bf16 v[80:83], v[240:243], v[52:55], v[80:83]
    buffer_store_dwordx4 v[72:75], v9, s[40:43], s36 offen sc1
    v_mfma_f32_16x16x32_bf16 v[84:87], v[228:231], v[48:51], v[84:87]
    s_add_u32 s36, s36, s39
    v_mfma_f32_16x16x32_bf16 v[84:87], v[244:247], v[52:55], v[84:87]
    v_mfma_f32_16x16x32_bf16 v[88:91], v[232:235], v[48:51], v[88:91]
    v_mfma_f32_16x16x32_bf16 v[88:91], v[248:251], v[52:55], v[88:91]
    v_mfma_f32_16x16x32_bf16 v[92:95], v[236:239], v[48:51], v[92:95]
    ds_read_b128 v[48:51], v12 offset:4096
    v_mfma_f32_16x16x32_bf16 v[92:95], v[252:255], v[52:55], v[92:95]
    ds_read_b128 v[52:55], v12 offset:5120
    s_sub_u32 s63, s63, 1
    s_cmp_lg_u32 s63, 0
    s_cbranch_scc1 fnet_glu_kernel_loop_20
    v_exp_f32 v96, v96
    v_exp_f32 v97, v97
    v_exp_f32 v98, v98
    v_exp_f32 v99, v99
    v_exp_f32 v100, v100
    v_exp_f32 v101, v101
    v_exp_f32 v102, v102
    v_exp_f32 v103, v103
    v_add_f32 v96, 1.0, v96
    v_add_f32 v97, 1.0, v97
    v_add_f32 v98, 1.0, v98
    v_add_f32 v99, 1.0, v99
    v_add_f32 v100, 1.0, v100
    v_add_f32 v101, 1.0, v101
    v_add_f32 v102, 1.0, v102
    v_add_f32 v103, 1.0, v103
    v_rcp_f32 v96, v96
    v_rcp_f32 v97, v97
    v_rcp_f32 v98, v98
    v_rcp_f32 v99, v99
    v_rcp_f32 v100, v100
    v_rcp_f32 v101, v101
    v_rcp_f32 v102, v102
    v_rcp_f32 v103, v103
    v_mul_f32 v96, v96, v104
    v_mul_f32 v97, v97, v105
    v_mul_f32 v98, v98, v106
    v_mul_f32 v99, v99, v107
    v_mul_f32 v100, v100, v108
    v_mul_f32 v101, v101, v109
    v_mul_f32 v102, v102, v110
    v_mul_f32 v103, v103, v111
    v_cvt_pk_bf16_f32 v104, v96, v97
    v_cvt_pk_bf16_f32 v105, v98, v99
    v_cvt_pk_bf16_f32 v106, v100, v101
    v_cvt_pk_bf16_f32 v107, v102, v103
    buffer_store_dwordx4 v[104:107], v9, s[40:43], s35 offen sc1
    v_exp_f32 v80, v80
    v_exp_f32 v81, v81
    v_exp_f32 v82, v82
    v_exp_f32 v83, v83
    v_exp_f32 v84, v84
    v_exp_f32 v85, v85
    v_exp_f32 v86, v86
    v_exp_f32 v87, v87
    v_add_f32 v80, 1.0, v80
    v_add_f32 v81, 1.0, v81
    v_add_f32 v82, 1.0, v82
    v_add_f32 v83, 1.0, v83
    v_add_f32 v84, 1.0, v84
    v_add_f32 v85, 1.0, v85
    v_add_f32 v86, 1.0, v86
    v_add_f32 v87, 1.0, v87
    v_rcp_f32 v80, v80
    v_rcp_f32 v81, v81
    v_rcp_f32 v82, v82
    v_rcp_f32 v83, v83
    v_rcp_f32 v84, v84
    v_rcp_f32 v85, v85
    v_rcp_f32 v86, v86
    v_rcp_f32 v87, v87
    v_mul_f32 v80, v80, v88
    v_mul_f32 v81, v81, v89
    v_mul_f32 v82, v82, v90
    v_mul_f32 v83, v83, v91
    v_mul_f32 v84, v84, v92
    v_mul_f32 v85, v85, v93
    v_mul_f32 v86, v86, v94
    v_mul_f32 v87, v87, v95
    v_cvt_pk_bf16_f32 v88, v80, v81
    v_cvt_pk_bf16_f32 v89, v82, v83
    v_cvt_pk_bf16_f32 v90, v84, v85
    v_cvt_pk_bf16_f32 v91, v86, v87
    buffer_store_dwordx4 v[88:91], v9, s[40:43], s36 offen sc1
    s_add_u32 s36, s36, s39
    s_branch fnet_glu_kernel_tailJ_22
fnet_glu_kernel_tailA_21:
    v_exp_f32 v96, v96
    v_exp_f32 v97, v97
    v_exp_f32 v98, v98
    v_exp_f32 v99, v99
    v_exp_f32 v100, v100
    v_exp_f32 v101, v101
    v_exp_f32 v102, v102
    v_exp_f32 v103, v103
    v_add_f32 v96, 1.0, v96
    v_add_f32 v97, 1.0, v97
    v_add_f32 v98, 1.0, v98
    v_add_f32 v99, 1.0, v99
    v_add_f32 v100, 1.0, v100
    v_add_f32 v101, 1.0, v101
    v_add_f32 v102, 1.0, v102
    v_add_f32 v103, 1.0, v103
    v_rcp_f32 v96, v96
    v_rcp_f32 v97, v97
    v_rcp_f32 v98, v98
    v_rcp_f32 v99, v99
    v_rcp_f32 v100, v100
    v_rcp_f32 v101, v101
    v_rcp_f32 v102, v102
    v_rcp_f32 v103, v103
    v_mul_f32 v96, v96, v104
    v_mul_f32 v97, v97, v105
    v_mul_f32 v98, v98, v106
    v_mul_f32 v99, v99, v107
    v_mul_f32 v100, v100, v108
    v_mul_f32 v101, v101, v109
    v_mul_f32 v102, v102, v110
    v_mul_f32 v103, v103, v111
    v_cvt_pk_bf16_f32 v104, v96, v97
    v_cvt_pk_bf16_f32 v105, v98, v99
    v_cvt_pk_bf16_f32 v106, v100, v101
    v_cvt_pk_bf16_f32 v107, v102, v103
    buffer_store_dwordx4 v[104:107], v9, s[40:43], s35 offen sc1
    v_exp_f32 v64, v64
    v_exp_f32 v65, v65
    v_exp_f32 v66, v66
    v_exp_f32 v67, v67
    v_exp_f32 v68, v68
    v_exp_f32 v69, v69
    v_exp_f32 v70, v70
    v_exp_f32 v71, v71
    v_add_f32 v64, 1.0, v64
    v_add_f32 v65, 1.0, v65
    v_add_f32 v66, 1.0, v66
    v_add_f32 v67, 1.0, v67
    v_add_f32 v68, 1.0, v68
    v_add_f32 v69, 1.0, v69
    v_add_f32 v70, 1.0, v70
    v_add_f32 v71, 1.0, v71
    v_rcp_f32 v64, v64
    v_rcp_f32 v65, v65
    v_rcp_f32 v66, v66
    v_rcp_f32 v67, v67
    v_rcp_f32 v68, v68
    v_rcp_f32 v69, v69
    v_rcp_f32 v70, v70
    v_rcp_f32 v71, v71
    v_mul_f32 v64, v64, v72
    v_mul_f32 v65, v65, v73
    v_mul_f32 v66, v66, v74
    v_mul_f32 v67, v67, v75
    v_mul_f32 v68, v68, v76
    v_mul_f32 v69, v69, v77
    v_mul_f32 v70, v70, v78
    v_mul_f32 v71, v71, v79
    v_cvt_pk_bf16_f32 v72, v64, v65
    v_cvt_pk_bf16_f32 v73, v66, v67
    v_cvt_pk_bf16_f32 v74, v68, v69
    v_cvt_pk_bf16_f32 v75, v70, v71
    buffer_store_dwordx4 v[72:75], v9, s[40:43], s36 offen sc1
    s_add_u32 s36, s36, s39
fnet_glu_kernel_tailJ_22:
fnet_glu_kernel_skip4_14:
    s_and_b32 s27, s2, 7
    s_lshr_b32 s28, s2, 3
    s_mul_i32 s29, s28, 43
    s_lshr_b32 s29, s29, 7
    s_mul_i32 s30, s29, 3
    s_sub_u32 s26, s28, s30
    s_mul_i32 s27, s27, 10
    s_add_u32 s27, s27, s29
    s_lshr_b32 s24, s27, 4
    s_and_b32 s25, s27, 15
    s_lshl_b32 s31, s25, 3
    s_lshl_b32 s32, s3, 1
    s_add_u32 s31, s31, s32
    s_mul_i32 s31, s31, 147456
    v_add_u32 v8, s31, v10
    v_add_u32 v9, 146432, v8
    s_mul_i32 s37, s24, 1069056
    s_mul_i32 s38, s24, 29696
    s_mul_i32 s35, s3, 3072
    s_lshl_b32 s34, s3, 11
    s_add_u32 s34, s34, 98304
    s_mov_b32 s39, 36864
    s_movk_i32 s36, 1024
    s_mov_b32 s8, s44
    s_and_b32 s9, s45, 0xffff
    s_mov_b32 s10, 0x510000
    s_mov_b32 s11, 0x00020000
    v_lshrrev_b32 v2, 2, v1
    v_mul_u32_u24 v3, 384, v2
    v_and_b32 v7, 3, v1
    v_lshl_add_u32 v3, v7, 3, v3
    v_bfe_u32 v2, v1, 3, 2
    s_and_b32 s31, s3, 1
    s_mul_i32 s31, s31, 6
    s_add_u32 s32, s31, 0
    v_xor_b32 v7, s32, v2
    v_lshl_add_u32 v224, v7, 5, v3
    v_add_u32 v228, 0x10000, v224
    v_add_u32 v232, 0x20000, v224
    s_add_u32 s32, s31, 1
    v_xor_b32 v7, s32, v2
    v_lshl_add_u32 v225, v7, 5, v3
    v_add_u32 v229, 0x10000, v225
    v_add_u32 v233, 0x20000, v225
    s_add_u32 s32, s31, 2
    v_xor_b32 v7, s32, v2
    v_lshl_add_u32 v226, v7, 5, v3
    v_add_u32 v230, 0x10000, v226
    v_add_u32 v234, 0x20000, v226
    s_add_u32 s32, s31, 3
    v_xor_b32 v7, s32, v2
    v_lshl_add_u32 v227, v7, 5, v3
    v_add_u32 v231, 0x10000, v227
    v_add_u32 v235, 0x20000, v227
    s_lshr_b32 s33, s3, 1
    s_lshl_b32 s32, s33, 12
    v_add_u32 v236, s32, v10
    v_add_u32 v237, 0x10000, v236
    v_add_u32 v238, 0x20000, v236
    s_add_u32 s16, s6, 0x2a00000
    s_addc_u32 s17, s7, 0
    s_and_b32 s17, s17, 0xffff
    s_mov_b32 s18, 0xb40000
    s_mov_b32 s19, 0x00020000
    s_lshl_b32 s20, s24, 6
    s_lshl_b32 s21, s25, 2
    s_add_u32 s20, s20, s21
    s_lshl_b32 s21, s33, 1
    s_add_u32 s20, s20, s21
    s_mul_i32 s20, s20, 36
    s_mul_i32 s21, s26, 12
    s_add_u32 s20, s20, s21
    s_add_u32 s20, s20, s31
    s_lshl_b32 s20, s20, 10
    s_add_u32 s21, s20, 4096
    s_add_u32 s22, s20, 36864
    s_add_u32 s23, s22, 4096
    s_mul_i32 s30, s24, 29
    s_lshr_b32 s31, s30, 2
    s_add_u32 s32, s30, 7
    s_lshr_b32 s32, s32, 2
    s_add_u32 s30, s30, 28
    s_lshr_b32 s30, s30, 2
    s_min_u32 s30, s30, 35
    v_lshrrev_b32 v2, 1, v1
    v_add_u32 v2, s31, v2
    v_min_u32 v6, s32, v2
    v_min_u32 v2, s30, v2
    v_and_b32 v3, 1, v1
    v_mul_u32_u24 v3, 7, v3
    s_mul_i32 s30, s25, 56
    s_mul_i32 s31, s3, 14
    s_add_u32 s30, s30, s31
    s_add_u32 s30, s30, 6
    v_add_u32 v3, s30, v3
    v_lshrrev_b32 v3, 7, v3
    v_add_u32 v3, 0x100, v3
    v_mad_u32_u24 v4, v2, 7, v3
    v_lshlrev_b32 v4, 7, v4
    v_mad_u32_u24 v5, v6, 7, v3
    v_lshlrev_b32 v5, 7, v5
    s_lshl_b32 s29, s56, 7
    s_add_u32 s29, s29, 32768
    s_lshl_b32 s60, s25, 4
    s_mul_i32 s30, s24, 3
    s_add_u32 s60, s60, s30
    s_add_u32 s60, s60, s26
    s_lshl_b32 s60, s60, 7
    s_add_u32 s60, s60, 65536
    s_waitcnt vmcnt(0) lgkmcnt(0)
    s_barrier
    v_mov_b32 v2, s92
    buffer_store_dword v2, v223, s[52:55], s29 offen sc1
    s_cmp_ge_u32 s2, 240
    s_cbranch_scc1 fnet_glu_kernel_skip5_23
    s_mov_b32 s61, s37
    s_add_u32 s37, s37, 921600
    s_add_u32 m0, s35, 114688
    s_nop 0
    buffer_load_dwordx4 v220, s[8:11], s37 offen offset:0 lds
    buffer_load_dwordx4 v221, s[8:11], s37 offen offset:1024 lds
    buffer_load_dwordx4 v222, s[8:11], s37 offen offset:2048 lds
    s_add_u32 s37, s37, s39
    s_add_u32 m0, s35, 126976
    s_nop 0
    buffer_load_dwordx4 v220, s[8:11], s37 offen offset:0 lds
    buffer_load_dwordx4 v221, s[8:11], s37 offen offset:1024 lds
    buffer_load_dwordx4 v222, s[8:11], s37 offen offset:2048 lds
    s_add_u32 s37, s37, s39
    s_add_u32 m0, s35, 139264
    s_nop 0
    buffer_load_dwordx4 v220, s[8:11], s37 offen offset:0 lds
    buffer_load_dwordx4 v221, s[8:11], s37 offen offset:1024 lds
    buffer_load_dwordx4 v222, s[8:11], s37 offen offset:2048 lds
    s_add_u32 s37, s37, s39
    s_add_u32 m0, s35, 151552
    s_nop 0
    buffer_load_dwordx4 v220, s[8:11], s37 offen offset:0 lds
    buffer_load_dwordx4 v221, s[8:11], s37 offen offset:1024 lds
    buffer_load_dwordx4 v222, s[8:11], s37 offen offset:2048 lds
    s_add_u32 s37, s37, s39
    s_mov_b32 s37, s61
    s_add_u32 m0, s35, 0
    s_nop 0
    buffer_load_dwordx4 v220, s[8:11], s37 offen offset:0 lds
    buffer_load_dwordx4 v221, s[8:11], s37 offen offset:1024 lds
    buffer_load_dwordx4 v222, s[8:11], s37 offen offset:2048 lds
    s_add_u32 s37, s37, s39
    s_add_u32 m0, s35, 12288
    s_nop 0
    buffer_load_dwordx4 v220, s[8:11], s37 offen offset:0 lds
    buffer_load_dwordx4 v221, s[8:11], s37 offen offset:1024 lds
    buffer_load_dwordx4 v222, s[8:11], s37 offen offset:2048 lds
    s_add_u32 s37, s37, s39
    s_add_u32 m0, s35, 24576
    s_nop 0
    buffer_load_dwordx4 v220, s[8:11], s37 offen offset:0 lds
    buffer_load_dwordx4 v221, s[8:11], s37 offen offset:1024 lds
    buffer_load_dwordx4 v222, s[8:11], s37 offen offset:2048 lds
    s_add_u32 s37, s37, s39
    s_waitcnt vmcnt(9)
    s_barrier
    s_add_u32 m0, s35, 36864
    s_nop 0
    buffer_load_dwordx4 v220, s[8:11], s37 offen offset:0 lds
    buffer_load_dwordx4 v221, s[8:11], s37 offen offset:1024 lds
    buffer_load_dwordx4 v222, s[8:11], s37 offen offset:2048 lds
    s_add_u32 s37, s37, s39
    s_add_u32 m0, s35, 49152
    s_nop 0
    buffer_load_dwordx4 v220, s[8:11], s37 offen offset:0 lds
    buffer_load_dwordx4 v221, s[8:11], s37 offen offset:1024 lds
    buffer_load_dwordx4 v222, s[8:11], s37 offen offset:2048 lds
    s_add_u32 s37, s37, s39
    s_add_u32 m0, s35, 61440
    s_nop 0
    buffer_load_dwordx4 v220, s[8:11], s37 offen offset:0 lds
    buffer_load_dwordx4 v221, s[8:11], s37 offen offset:1024 lds
    buffer_load_dwordx4 v222, s[8:11], s37 offen offset:2048 lds
    s_add_u32 s37, s37, s39
    s_add_u32 m0, s35, 73728
    s_nop 0
    buffer_load_dwordx4 v220, s[8:11], s37 offen offset:0 lds
    buffer_load_dwordx4 v221, s[8:11], s37 offen offset:1024 lds
    buffer_load_dwordx4 v222, s[8:11], s37 offen offset:2048 lds
    s_add_u32 s37, s37, s39
    s_add_u32 m0, s35, 86016
    s_nop 0
    buffer_load_dwordx4 v220, s[8:11], s37 offen offset:0 lds
    buffer_load_dwordx4 v221, s[8:11], s37 offen offset:1024 lds
    buffer_load_dwordx4 v222, s[8:11], s37 offen offset:2048 lds
    s_add_u32 s37, s37, s39
    buffer_load_dword v2, v5, s[52:55], 0 offen sc1
    ds_read_b64_tr_b16 a[96:97], v228 offset:49152
    ds_read_b64_tr_b16 a[98:99], v228 offset:55296
    ds_read_b64_tr_b16 a[120:121], v228 offset:61440
    ds_read_b64_tr_b16 a[122:123], v232 offset:2048
    ds_read_b64_tr_b16 a[144:145], v232 offset:8192
    ds_read_b64_tr_b16 a[146:147], v232 offset:14336
    ds_read_b64_tr_b16 a[168:169], v232 offset:20480
    ds_read_b64_tr_b16 a[170:171], v232 offset:26624
    ds_read_b64_tr_b16 a[100:101], v229 offset:49152
    ds_read_b64_tr_b16 a[102:103], v229 offset:55296
    ds_read_b64_tr_b16 a[124:125], v229 offset:61440
    ds_read_b64_tr_b16 a[126:127], v233 offset:2048
    ds_read_b64_tr_b16 a[148:149], v233 offset:8192
    ds_read_b64_tr_b16 a[150:151], v233 offset:14336
    ds_read_b64_tr_b16 a[172:173], v233 offset:20480
    ds_read_b64_tr_b16 a[174:175], v233 offset:26624
    ds_read_b64_tr_b16 a[104:105], v230 offset:49152
    ds_read_b64_tr_b16 a[106:107], v230 offset:55296
    ds_read_b64_tr_b16 a[128:129], v230 offset:61440
    ds_read_b64_tr_b16 a[130:131], v234 offset:2048
    ds_read_b64_tr_b16 a[152:153], v234 offset:8192
    ds_read_b64_tr_b16 a[154:155], v234 offset:14336
    ds_read_b64_tr_b16 a[176:177], v234 offset:20480
    ds_read_b64_tr_b16 a[178:179], v234 offset:26624
    ds_read_b64_tr_b16 a[108:109], v231 offset:49152
    ds_read_b64_tr_b16 a[110:111], v231 offset:55296
    ds_read_b64_tr_b16 a[132:133], v231 offset:61440
    ds_read_b64_tr_b16 a[134:135], v235 offset:2048
    ds_read_b64_tr_b16 a[156:157], v235 offset:8192
    ds_read_b64_tr_b16 a[158:159], v235 offset:14336
    ds_read_b64_tr_b16 a[180:181], v235 offset:20480
    ds_read_b64_tr_b16 a[182:183], v235 offset:26624
    ds_read_b64_tr_b16 a[112:113], v228 offset:49280
    ds_read_b64_tr_b16 a[114:115], v228 offset:55424
    ds_read_b64_tr_b16 a[136:137], v228 offset:61568
    ds_read_b64_tr_b16 a[138:139], v232 offset:2176
    ds_read_b64_tr_b16 a[160:161], v232 offset:8320
    ds_read_b64_tr_b16 a[162:163], v232 offset:14464
    ds_read_b64_tr_b16 a[184:185], v232 offset:20608
    ds_read_b64_tr_b16 a[186:187], v232 offset:26752
    ds_read_b64_tr_b16 a[116:117], v229 offset:49280
    ds_read_b64_tr_b16 a[118:119], v229 offset:55424
    ds_read_b64_tr_b16 a[140:141], v229 offset:61568
    ds_read_b64_tr_b16 a[142:143], v233 offset:2176
    ds_read_b64_tr_b16 a[164:165], v233 offset:8320
    ds_read_b64_tr_b16 a[166:167], v233 offset:14464
    ds_read_b64_tr_b16 a[188:189], v233 offset:20608
    ds_read_b64_tr_b16 a[190:191], v233 offset:26752
    s_waitcnt lgkmcnt(0)
    s_barrier
    s_waitcnt vmcnt(0)
    s_mov_b32 s30, 0
fnet_glu_kernel_poll_24:
    v_cmp_eq_u32 vcc, s92, v2
    s_cmp_eq_u64 vcc, -1
    s_cbranch_scc1 fnet_glu_kernel_pok_25
    s_add_u32 s30, s30, 1
    s_cmp_gt_u32 s30, 0x40000
    s_cbranch_scc1 fnet_glu_kernel_pok_25
    buffer_load_dword v2, v5, s[52:55], 0 offen sc1
    s_waitcnt vmcnt(0)
    s_branch fnet_glu_kernel_poll_24
fnet_glu_kernel_pok_25:
    s_add_u32 m0, s34, 0
    s_nop 0
    buffer_load_dwordx4 v8, s[40:43], s38 offen offset:0 sc1 lds
    buffer_load_dwordx4 v9, s[40:43], s38 offen offset:1024 sc1 lds
    s_add_u32 s38, s38, s36
    s_add_u32 m0, s34, 8192
    s_nop 0
    buffer_load_dwordx4 v8, s[40:43], s38 offen offset:0 sc1 lds
    buffer_load_dwordx4 v9, s[40:43], s38 offen offset:1024 sc1 lds
    s_add_u32 s38, s38, s36
    s_add_u32 m0, s34, 16384
    s_nop 0
    buffer_load_dwordx4 v8, s[40:43], s38 offen offset:0 sc1 lds
    buffer_load_dwordx4 v9, s[40:43], s38 offen offset:1024 sc1 lds
    s_add_u32 s38, s38, s36
    s_add_u32 m0, s34, 24576
    s_nop 0
    buffer_load_dwordx4 v8, s[40:43], s38 offen offset:0 sc1 lds
    buffer_load_dwordx4 v9, s[40:43], s38 offen offset:1024 sc1 lds
    s_add_u32 s38, s38, s36
    s_waitcnt vmcnt(4)
    s_barrier
    ds_read_b128 a[64:67], v237 offset:32768
    ds_read_b64_tr_b16 v[128:129], v224 offset:0
    ds_read_b64_tr_b16 v[130:131], v224 offset:6144
    ds_read_b128 a[68:71], v237 offset:33792
    ds_read_b128 a[72:75], v237 offset:34816
    ds_read_b128 a[76:79], v237 offset:35840
    ds_read_b64_tr_b16 v[132:133], v225 offset:0
    ds_read_b64_tr_b16 v[134:135], v225 offset:6144
    ds_read_b64_tr_b16 v[136:137], v226 offset:0
    ds_read_b64_tr_b16 v[138:139], v226 offset:6144
    ds_read_b64_tr_b16 v[140:141], v227 offset:0
    ds_read_b64_tr_b16 v[142:143], v227 offset:6144
    ds_read_b64_tr_b16 v[144:145], v224 offset:128
    ds_read_b64_tr_b16 v[146:147], v224 offset:6272
    ds_read_b64_tr_b16 v[148:149], v225 offset:128
    ds_read_b64_tr_b16 v[150:151], v225 offset:6272
    s_waitcnt lgkmcnt(10)
    v_mfma_f32_16x16x32_bf16 v[32:35], v[128:131], a[64:67], 0
    ds_read_b128 a[80:83], v237 offset:40960
    s_add_u32 m0, s34, 32768
    v_mfma_f32_16x16x32_bf16 v[36:39], v[128:131], a[68:71], 0
    ds_read_b64_tr_b16 v[152:153], v224 offset:12288
    buffer_load_dwordx4 v8, s[40:43], s38 offen offset:0 sc1 lds
    v_mfma_f32_16x16x32_bf16 v[40:43], v[128:131], a[72:75], 0
    ds_read_b64_tr_b16 v[154:155], v224 offset:18432
    v_mfma_f32_16x16x32_bf16 v[44:47], v[128:131], a[76:79], 0
    s_waitcnt lgkmcnt(11)
    ds_read_b128 a[84:87], v237 offset:41984
    v_mfma_f32_16x16x32_bf16 v[48:51], v[132:135], a[64:67], 0
    ds_read_b128 a[88:91], v237 offset:43008
    buffer_load_dwordx4 v9, s[40:43], s38 offen offset:1024 sc1 lds
    v_mfma_f32_16x16x32_bf16 v[52:55], v[132:135], a[68:71], 0
    ds_read_b128 a[92:95], v237 offset:44032
    s_add_u32 s38, s38, s36
    v_mfma_f32_16x16x32_bf16 v[56:59], v[132:135], a[72:75], 0
    ds_read_b64_tr_b16 v[156:157], v225 offset:12288
    s_add_u32 m0, s34, 40960
    v_mfma_f32_16x16x32_bf16 v[60:63], v[132:135], a[76:79], 0
    s_waitcnt lgkmcnt(13)
    ds_read_b64_tr_b16 v[158:159], v225 offset:18432
    v_mfma_f32_16x16x32_bf16 v[64:67], v[136:139], a[64:67], 0
    ds_read_b64_tr_b16 v[160:161], v226 offset:12288
    buffer_load_dwordx4 v8, s[40:43], s38 offen offset:0 sc1 lds
    v_mfma_f32_16x16x32_bf16 v[68:71], v[136:139], a[68:71], 0
    ds_read_b64_tr_b16 v[162:163], v226 offset:18432
    buffer_load_dwordx4 v9, s[40:43], s38 offen offset:1024 sc1 lds
    v_mfma_f32_16x16x32_bf16 v[72:75], v[136:139], a[72:75], 0
    ds_read_b64_tr_b16 v[164:165], v227 offset:12288
    s_add_u32 s38, s38, s36
    v_mfma_f32_16x16x32_bf16 v[76:79], v[136:139], a[76:79], 0
    s_waitcnt lgkmcnt(15)
    ds_read_b64_tr_b16 v[166:167], v227 offset:18432
    v_mfma_f32_16x16x32_bf16 v[80:83], v[140:143], a[64:67], 0
    v_mfma_f32_16x16x32_bf16 v[84:87], v[140:143], a[68:71], 0
    v_mfma_f32_16x16x32_bf16 v[88:91], v[140:143], a[72:75], 0
    ds_read_b64_tr_b16 v[168:169], v224 offset:12416
    v_mfma_f32_16x16x32_bf16 v[92:95], v[140:143], a[76:79], 0
    s_waitcnt lgkmcnt(15)
    ds_read_b64_tr_b16 v[170:171], v224 offset:18560
    v_mfma_f32_16x16x32_bf16 v[96:99], v[144:147], a[64:67], 0
    buffer_load_dword v2, v4, s[52:55], 0 offen sc1
    v_mfma_f32_16x16x32_bf16 v[100:103], v[144:147], a[68:71], 0
    v_mfma_f32_16x16x32_bf16 v[104:107], v[144:147], a[72:75], 0
    ds_read_b64_tr_b16 v[172:173], v225 offset:12416
    v_mfma_f32_16x16x32_bf16 v[108:111], v[144:147], a[76:79], 0
    s_waitcnt lgkmcnt(15)
    ds_read_b64_tr_b16 v[174:175], v225 offset:18560
    v_mfma_f32_16x16x32_bf16 v[112:115], v[148:151], a[64:67], 0
    v_mfma_f32_16x16x32_bf16 v[116:119], v[148:151], a[68:71], 0
    v_mfma_f32_16x16x32_bf16 v[120:123], v[148:151], a[72:75], 0
    v_mfma_f32_16x16x32_bf16 v[124:127], v[148:151], a[76:79], 0
    s_waitcnt lgkmcnt(10)
    v_mfma_f32_16x16x32_bf16 v[32:35], v[152:155], a[80:83], v[32:35]
    s_add_u32 m0, s34, 49152
    v_mfma_f32_16x16x32_bf16 v[36:39], v[152:155], a[84:87], v[36:39]
    buffer_load_dwordx4 v8, s[40:43], s38 offen offset:0 sc1 lds
    v_mfma_f32_16x16x32_bf16 v[40:43], v[152:155], a[88:91], v[40:43]
    s_waitcnt vmcnt(6)
    s_barrier
    v_mfma_f32_16x16x32_bf16 v[44:47], v[152:155], a[92:95], v[44:47]
    s_waitcnt lgkmcnt(8)
    ds_read_b128 a[64:67], v237 offset:49152
    v_mfma_f32_16x16x32_bf16 v[48:51], v[156:159], a[80:83], v[48:51]
    ds_read_b64_tr_b16 v[128:129], v224 offset:24576
    buffer_load_dwordx4 v9, s[40:43], s38 offen offset:1024 sc1 lds
    v_mfma_f32_16x16x32_bf16 v[52:55], v[156:159], a[84:87], v[52:55]
    ds_read_b64_tr_b16 v[130:131], v224 offset:30720
    s_add_u32 s38, s38, s36
    v_mfma_f32_16x16x32_bf16 v[56:59], v[156:159], a[88:91], v[56:59]
    ds_read_b128 a[68:71], v237 offset:50176
    s_add_u32 m0, s35, 0
    v_mfma_f32_16x16x32_bf16 v[60:63], v[156:159], a[92:95], v[60:63]
    s_waitcnt lgkmcnt(10)
    ds_read_b128 a[72:75], v237 offset:51200
    v_mfma_f32_16x16x32_bf16 v[64:67], v[160:163], a[80:83], v[64:67]
    ds_read_b128 a[76:79], v237 offset:52224
    buffer_load_dwordx4 v220, s[8:11], s37 offen offset:0 lds
    v_mfma_f32_16x16x32_bf16 v[68:71], v[160:163], a[84:87], v[68:71]
    ds_read_b64_tr_b16 v[132:133], v225 offset:24576
    buffer_load_dwordx4 v221, s[8:11], s37 offen offset:1024 lds
    v_mfma_f32_16x16x32_bf16 v[72:75], v[160:163], a[88:91], v[72:75]
    ds_read_b64_tr_b16 v[134:135], v225 offset:30720
    v_mfma_f32_16x16x32_bf16 v[76:79], v[160:163], a[92:95], v[76:79]
    s_waitcnt lgkmcnt(12)
    ds_read_b64_tr_b16 v[136:137], v226 offset:24576
    v_mfma_f32_16x16x32_bf16 v[80:83], v[164:167], a[80:83], v[80:83]
    ds_read_b64_tr_b16 v[138:139], v226 offset:30720
    buffer_load_dwordx4 v222, s[8:11], s37 offen offset:2048 lds
    v_mfma_f32_16x16x32_bf16 v[84:87], v[164:167], a[84:87], v[84:87]
    ds_read_b64_tr_b16 v[140:141], v227 offset:24576
    s_add_u32 s37, s37, s39
    v_mfma_f32_16x16x32_bf16 v[88:91], v[164:167], a[88:91], v[88:91]
    ds_read_b64_tr_b16 v[142:143], v227 offset:30720
    v_mfma_f32_16x16x32_bf16 v[92:95], v[164:167], a[92:95], v[92:95]
    s_waitcnt lgkmcnt(14)
    ds_read_b64_tr_b16 v[144:145], v224 offset:24704
    v_mfma_f32_16x16x32_bf16 v[96:99], v[168:171], a[80:83], v[96:99]
    ds_read_b64_tr_b16 v[146:147], v224 offset:30848
    v_mfma_f32_16x16x32_bf16 v[100:103], v[168:171], a[84:87], v[100:103]
    v_mfma_f32_16x16x32_bf16 v[104:107], v[168:171], a[88:91], v[104:107]
    ds_read_b64_tr_b16 v[148:149], v225 offset:24704
    v_mfma_f32_16x16x32_bf16 v[108:111], v[168:171], a[92:95], v[108:111]
    s_waitcnt lgkmcnt(15)
    ds_read_b64_tr_b16 v[150:151], v225 offset:30848
    v_mfma_f32_16x16x32_bf16 v[112:115], v[172:175], a[80:83], v[112:115]
    v_mfma_f32_16x16x32_bf16 v[116:119], v[172:175], a[84:87], v[116:119]
    v_mfma_f32_16x16x32_bf16 v[120:123], v[172:175], a[88:91], v[120:123]
    ds_read_b128 a[80:83], v237 offset:57344
    v_mfma_f32_16x16x32_bf16 v[124:127], v[172:175], a[92:95], v[124:127]
    s_waitcnt lgkmcnt(11)
    ds_read_b64_tr_b16 v[152:153], v224 offset:36864
    v_mfma_f32_16x16x32_bf16 v[32:35], v[128:131], a[64:67], v[32:35]
    ds_read_b64_tr_b16 v[154:155], v224 offset:43008
    s_add_u32 m0, s34, 57344
    v_mfma_f32_16x16x32_bf16 v[36:39], v[128:131], a[68:71], v[36:39]
    ds_read_b128 a[84:87], v237 offset:58368
    buffer_load_dwordx4 v8, s[40:43], s38 offen offset:0 sc1 lds
    v_mfma_f32_16x16x32_bf16 v[40:43], v[128:131], a[72:75], v[40:43]
    ds_read_b128 a[88:91], v237 offset:59392
    v_mfma_f32_16x16x32_bf16 v[44:47], v[128:131], a[76:79], v[44:47]
    s_waitcnt lgkmcnt(13)
    ds_read_b128 a[92:95], v237 offset:60416
    v_mfma_f32_16x16x32_bf16 v[48:51], v[132:135], a[64:67], v[48:51]
    ds_read_b64_tr_b16 v[156:157], v225 offset:36864
    buffer_load_dwordx4 v9, s[40:43], s38 offen offset:1024 sc1 lds
    v_mfma_f32_16x16x32_bf16 v[52:55], v[132:135], a[68:71], v[52:55]
    ds_read_b64_tr_b16 v[158:159], v225 offset:43008
    s_add_u32 s38, s38, s36
    v_mfma_f32_16x16x32_bf16 v[56:59], v[132:135], a[72:75], v[56:59]
    ds_read_b64_tr_b16 v[160:161], v226 offset:36864
    v_mfma_f32_16x16x32_bf16 v[60:63], v[132:135], a[76:79], v[60:63]
    s_waitcnt lgkmcnt(15)
    ds_read_b64_tr_b16 v[162:163], v226 offset:43008
    v_mfma_f32_16x16x32_bf16 v[64:67], v[136:139], a[64:67], v[64:67]
    v_mfma_f32_16x16x32_bf16 v[68:71], v[136:139], a[68:71], v[68:71]
    v_mfma_f32_16x16x32_bf16 v[72:75], v[136:139], a[72:75], v[72:75]
    ds_read_b64_tr_b16 v[164:165], v227 offset:36864
    v_mfma_f32_16x16x32_bf16 v[76:79], v[136:139], a[76:79], v[76:79]
    s_waitcnt lgkmcnt(15)
    ds_read_b64_tr_b16 v[166:167], v227 offset:43008
    v_mfma_f32_16x16x32_bf16 v[80:83], v[140:143], a[64:67], v[80:83]
    v_mfma_f32_16x16x32_bf16 v[84:87], v[140:143], a[68:71], v[84:87]
    v_mfma_f32_16x16x32_bf16 v[88:91], v[140:143], a[72:75], v[88:91]
    ds_read_b64_tr_b16 v[168:169], v224 offset:36992
    v_mfma_f32_16x16x32_bf16 v[92:95], v[140:143], a[76:79], v[92:95]
    s_waitcnt lgkmcnt(15)
    ds_read_b64_tr_b16 v[170:171], v224 offset:43136
    v_mfma_f32_16x16x32_bf16 v[96:99], v[144:147], a[64:67], v[96:99]
    v_mfma_f32_16x16x32_bf16 v[100:103], v[144:147], a[68:71], v[100:103]
    v_mfma_f32_16x16x32_bf16 v[104:107], v[144:147], a[72:75], v[104:107]
    ds_read_b64_tr_b16 v[172:173], v225 offset:36992
    v_mfma_f32_16x16x32_bf16 v[108:111], v[144:147], a[76:79], v[108:111]
    s_waitcnt lgkmcnt(15)
    ds_read_b64_tr_b16 v[174:175], v225 offset:43136
    v_mfma_f32_16x16x32_bf16 v[112:115], v[148:151], a[64:67], v[112:115]
    v_mfma_f32_16x16x32_bf16 v[116:119], v[148:151], a[68:71], v[116:119]
    v_mfma_f32_16x16x32_bf16 v[120:123], v[148:151], a[72:75], v[120:123]
    v_mfma_f32_16x16x32_bf16 v[124:127], v[148:151], a[76:79], v[124:127]
    s_waitcnt lgkmcnt(10)
    v_mfma_f32_16x16x32_bf16 v[32:35], v[152:155], a[80:83], v[32:35]
    s_waitcnt vmcnt(7)
    s_mov_b32 s30, 0
fnet_glu_kernel_poll_26:
    v_cmp_eq_u32 vcc, s92, v2
    s_cmp_eq_u64 vcc, -1
    s_cbranch_scc1 fnet_glu_kernel_pok_27
    s_add_u32 s30, s30, 1
    s_cmp_gt_u32 s30, 0x40000
    s_cbranch_scc1 fnet_glu_kernel_pok_27
    buffer_load_dword v2, v4, s[52:55], 0 offen sc1
    s_waitcnt vmcnt(0)
    s_branch fnet_glu_kernel_poll_26
fnet_glu_kernel_pok_27:
    v_mfma_f32_16x16x32_bf16 v[36:39], v[152:155], a[84:87], v[36:39]
    s_add_u32 m0, s34, 0
    v_mfma_f32_16x16x32_bf16 v[40:43], v[152:155], a[88:91], v[40:43]
    s_barrier
    buffer_load_dwordx4 v8, s[40:43], s38 offen offset:0 sc1 lds
    v_mfma_f32_16x16x32_bf16 v[44:47], v[152:155], a[92:95], v[44:47]
    s_waitcnt lgkmcnt(8)
    ds_read_b128 a[64:67], v238 offset:0
    v_mfma_f32_16x16x32_bf16 v[48:51], v[156:159], a[80:83], v[48:51]
    ds_read_b64_tr_b16 v[128:129], v224 offset:49152
    buffer_load_dwordx4 v9, s[40:43], s38 offen offset:1024 sc1 lds
    v_mfma_f32_16x16x32_bf16 v[52:55], v[156:159], a[84:87], v[52:55]
    ds_read_b64_tr_b16 v[130:131], v224 offset:55296
    s_add_u32 s38, s38, s36
    v_mfma_f32_16x16x32_bf16 v[56:59], v[156:159], a[88:91], v[56:59]
    ds_read_b128 a[68:71], v238 offset:1024
    s_add_u32 m0, s35, 12288
    v_mfma_f32_16x16x32_bf16 v[60:63], v[156:159], a[92:95], v[60:63]
    s_waitcnt lgkmcnt(10)
    ds_read_b128 a[72:75], v238 offset:2048
    v_mfma_f32_16x16x32_bf16 v[64:67], v[160:163], a[80:83], v[64:67]
    ds_read_b128 a[76:79], v238 offset:3072
    buffer_load_dwordx4 v220, s[8:11], s37 offen offset:0 lds
    v_mfma_f32_16x16x32_bf16 v[68:71], v[160:163], a[84:87], v[68:71]
    ds_read_b64_tr_b16 v[132:133], v225 offset:49152
    buffer_load_dwordx4 v221, s[8:11], s37 offen offset:1024 lds
    v_mfma_f32_16x16x32_bf16 v[72:75], v[160:163], a[88:91], v[72:75]
    ds_read_b64_tr_b16 v[134:135], v225 offset:55296
    v_mfma_f32_16x16x32_bf16 v[76:79], v[160:163], a[92:95], v[76:79]
    s_waitcnt lgkmcnt(12)
    ds_read_b64_tr_b16 v[136:137], v226 offset:49152
    v_mfma_f32_16x16x32_bf16 v[80:83], v[164:167], a[80:83], v[80:83]
    ds_read_b64_tr_b16 v[138:139], v226 offset:55296
    buffer_load_dwordx4 v222, s[8:11], s37 offen offset:2048 lds
    v_mfma_f32_16x16x32_bf16 v[84:87], v[164:167], a[84:87], v[84:87]
    ds_read_b64_tr_b16 v[140:141], v227 offset:49152
    s_add_u32 s37, s37, s39
    v_mfma_f32_16x16x32_bf16 v[88:91], v[164:167], a[88:91], v[88:91]
    ds_read_b64_tr_b16 v[142:143], v227 offset:55296
    s_add_u32 m0, s35, 24576
    v_mfma_f32_16x16x32_bf16 v[92:95], v[164:167], a[92:95], v[92:95]
    s_waitcnt lgkmcnt(14)
    ds_read_b64_tr_b16 v[144:145], v224 offset:49280
    v_mfma_f32_16x16x32_bf16 v[96:99], v[168:171], a[80:83], v[96:99]
    ds_read_b64_tr_b16 v[146:147], v224 offset:55424
    v_mfma_f32_16x16x32_bf16 v[100:103], v[168:171], a[84:87], v[100:103]
    buffer_load_dwordx4 v220, s[8:11], s37 offen offset:0 lds
    v_mfma_f32_16x16x32_bf16 v[104:107], v[168:171], a[88:91], v[104:107]
    ds_read_b64_tr_b16 v[148:149], v225 offset:49280
    v_mfma_f32_16x16x32_bf16 v[108:111], v[168:171], a[92:95], v[108:111]
    s_waitcnt lgkmcnt(15)
    ds_read_b64_tr_b16 v[150:151], v225 offset:55424
    v_mfma_f32_16x16x32_bf16 v[112:115], v[172:175], a[80:83], v[112:115]
    buffer_load_dwordx4 v221, s[8:11], s37 offen offset:1024 lds
    v_mfma_f32_16x16x32_bf16 v[116:119], v[172:175], a[84:87], v[116:119]
    buffer_load_dwordx4 v222, s[8:11], s37 offen offset:2048 lds
    s_add_u32 s37, s37, s39
    v_mfma_f32_16x16x32_bf16 v[120:123], v[172:175], a[88:91], v[120:123]
    ds_read_b128 a[80:83], v238 offset:8192
    v_mfma_f32_16x16x32_bf16 v[124:127], v[172:175], a[92:95], v[124:127]
    s_waitcnt lgkmcnt(11)
    ds_read_b64_tr_b16 v[152:153], v224 offset:61440
    v_mfma_f32_16x16x32_bf16 v[32:35], v[128:131], a[64:67], v[32:35]
    ds_read_b64_tr_b16 v[154:155], v228 offset:2048
    s_add_u32 m0, s34, 8192
    v_mfma_f32_16x16x32_bf16 v[36:39], v[128:131], a[68:71], v[36:39]
    ds_read_b128 a[84:87], v238 offset:9216
    buffer_load_dwordx4 v8, s[40:43], s38 offen offset:0 sc1 lds
    v_mfma_f32_16x16x32_bf16 v[40:43], v[128:131], a[72:75], v[40:43]
    ds_read_b128 a[88:91], v238 offset:10240
    v_mfma_f32_16x16x32_bf16 v[44:47], v[128:131], a[76:79], v[44:47]
    s_waitcnt lgkmcnt(13)
    ds_read_b128 a[92:95], v238 offset:11264
    v_mfma_f32_16x16x32_bf16 v[48:51], v[132:135], a[64:67], v[48:51]
    ds_read_b64_tr_b16 v[156:157], v225 offset:61440
    buffer_load_dwordx4 v9, s[40:43], s38 offen offset:1024 sc1 lds
    v_mfma_f32_16x16x32_bf16 v[52:55], v[132:135], a[68:71], v[52:55]
    ds_read_b64_tr_b16 v[158:159], v229 offset:2048
    s_add_u32 s38, s38, s36
    v_mfma_f32_16x16x32_bf16 v[56:59], v[132:135], a[72:75], v[56:59]
    ds_read_b64_tr_b16 v[160:161], v226 offset:61440
    v_mfma_f32_16x16x32_bf16 v[60:63], v[132:135], a[76:79], v[60:63]
    s_waitcnt lgkmcnt(15)
    ds_read_b64_tr_b16 v[162:163], v230 offset:2048
    v_mfma_f32_16x16x32_bf16 v[64:67], v[136:139], a[64:67], v[64:67]
    v_mfma_f32_16x16x32_bf16 v[68:71], v[136:139], a[68:71], v[68:71]
    v_mfma_f32_16x16x32_bf16 v[72:75], v[136:139], a[72:75], v[72:75]
    ds_read_b64_tr_b16 v[164:165], v227 offset:61440
    v_mfma_f32_16x16x32_bf16 v[76:79], v[136:139], a[76:79], v[76:79]
    s_waitcnt lgkmcnt(15)
    ds_read_b64_tr_b16 v[166:167], v231 offset:2048
    v_mfma_f32_16x16x32_bf16 v[80:83], v[140:143], a[64:67], v[80:83]
    v_mfma_f32_16x16x32_bf16 v[84:87], v[140:143], a[68:71], v[84:87]
    v_mfma_f32_16x16x32_bf16 v[88:91], v[140:143], a[72:75], v[88:91]
    ds_read_b64_tr_b16 v[168:169], v224 offset:61568
    v_mfma_f32_16x16x32_bf16 v[92:95], v[140:143], a[76:79], v[92:95]
    s_waitcnt lgkmcnt(15)
    ds_read_b64_tr_b16 v[170:171], v228 offset:2176
    v_mfma_f32_16x16x32_bf16 v[96:99], v[144:147], a[64:67], v[96:99]
    v_mfma_f32_16x16x32_bf16 v[100:103], v[144:147], a[68:71], v[100:103]
    v_mfma_f32_16x16x32_bf16 v[104:107], v[144:147], a[72:75], v[104:107]
    ds_read_b64_tr_b16 v[172:173], v225 offset:61568
    v_mfma_f32_16x16x32_bf16 v[108:111], v[144:147], a[76:79], v[108:111]
    s_waitcnt lgkmcnt(15)
    ds_read_b64_tr_b16 v[174:175], v229 offset:2176
    v_mfma_f32_16x16x32_bf16 v[112:115], v[148:151], a[64:67], v[112:115]
    v_mfma_f32_16x16x32_bf16 v[116:119], v[148:151], a[68:71], v[116:119]
    v_mfma_f32_16x16x32_bf16 v[120:123], v[148:151], a[72:75], v[120:123]
    v_mfma_f32_16x16x32_bf16 v[124:127], v[148:151], a[76:79], v[124:127]
    s_waitcnt lgkmcnt(10)
    v_mfma_f32_16x16x32_bf16 v[32:35], v[152:155], a[80:83], v[32:35]
    s_add_u32 m0, s34, 16384
    v_mfma_f32_16x16x32_bf16 v[36:39], v[152:155], a[84:87], v[36:39]
    buffer_load_dwordx4 v8, s[40:43], s38 offen offset:0 sc1 lds
    v_mfma_f32_16x16x32_bf16 v[40:43], v[152:155], a[88:91], v[40:43]
    s_waitcnt vmcnt(11)
    s_barrier
    v_mfma_f32_16x16x32_bf16 v[44:47], v[152:155], a[92:95], v[44:47]
    s_waitcnt lgkmcnt(8)
    ds_read_b128 a[64:67], v238 offset:16384
    v_mfma_f32_16x16x32_bf16 v[48:51], v[156:159], a[80:83], v[48:51]
    ds_read_b64_tr_b16 v[128:129], v228 offset:8192
    buffer_load_dwordx4 v9, s[40:43], s38 offen offset:1024 sc1 lds
    v_mfma_f32_16x16x32_bf16 v[52:55], v[156:159], a[84:87], v[52:55]
    ds_read_b64_tr_b16 v[130:131], v228 offset:14336
    s_add_u32 s38, s38, s36
    v_mfma_f32_16x16x32_bf16 v[56:59], v[156:159], a[88:91], v[56:59]
    ds_read_b128 a[68:71], v238 offset:17408
    s_add_u32 m0, s35, 36864
    v_mfma_f32_16x16x32_bf16 v[60:63], v[156:159], a[92:95], v[60:63]
    s_waitcnt lgkmcnt(10)
    ds_read_b128 a[72:75], v238 offset:18432
    v_mfma_f32_16x16x32_bf16 v[64:67], v[160:163], a[80:83], v[64:67]
    ds_read_b128 a[76:79], v238 offset:19456
    buffer_load_dwordx4 v220, s[8:11], s37 offen offset:0 lds
    v_mfma_f32_16x16x32_bf16 v[68:71], v[160:163], a[84:87], v[68:71]
    ds_read_b64_tr_b16 v[132:133], v229 offset:8192
    buffer_load_dwordx4 v221, s[8:11], s37 offen offset:1024 lds
    v_mfma_f32_16x16x32_bf16 v[72:75], v[160:163], a[88:91], v[72:75]
    ds_read_b64_tr_b16 v[134:135], v229 offset:14336
    v_mfma_f32_16x16x32_bf16 v[76:79], v[160:163], a[92:95], v[76:79]
    s_waitcnt lgkmcnt(12)
    ds_read_b64_tr_b16 v[136:137], v230 offset:8192
    v_mfma_f32_16x16x32_bf16 v[80:83], v[164:167], a[80:83], v[80:83]
    ds_read_b64_tr_b16 v[138:139], v230 offset:14336
    buffer_load_dwordx4 v222, s[8:11], s37 offen offset:2048 lds
    v_mfma_f32_16x16x32_bf16 v[84:87], v[164:167], a[84:87], v[84:87]
    ds_read_b64_tr_b16 v[140:141], v231 offset:8192
    s_add_u32 s37, s37, s39
    v_mfma_f32_16x16x32_bf16 v[88:91], v[164:167], a[88:91], v[88:91]
    ds_read_b64_tr_b16 v[142:143], v231 offset:14336
    s_add_u32 m0, s35, 49152
    v_mfma_f32_16x16x32_bf16 v[92:95], v[164:167], a[92:95], v[92:95]
    s_waitcnt lgkmcnt(14)
    ds_read_b64_tr_b16 v[144:145], v228 offset:8320
    v_mfma_f32_16x16x32_bf16 v[96:99], v[168:171], a[80:83], v[96:99]
    ds_read_b64_tr_b16 v[146:147], v228 offset:14464
    v_mfma_f32_16x16x32_bf16 v[100:103], v[168:171], a[84:87], v[100:103]
    buffer_load_dwordx4 v220, s[8:11], s37 offen offset:0 lds
    v_mfma_f32_16x16x32_bf16 v[104:107], v[168:171], a[88:91], v[104:107]
    ds_read_b64_tr_b16 v[148:149], v229 offset:8320
    v_mfma_f32_16x16x32_bf16 v[108:111], v[168:171], a[92:95], v[108:111]
    s_waitcnt lgkmcnt(15)
    ds_read_b64_tr_b16 v[150:151], v229 offset:14464
    v_mfma_f32_16x16x32_bf16 v[112:115], v[172:175], a[80:83], v[112:115]
    buffer_load_dwordx4 v221, s[8:11], s37 offen offset:1024 lds
    v_mfma_f32_16x16x32_bf16 v[116:119], v[172:175], a[84:87], v[116:119]
    buffer_load_dwordx4 v222, s[8:11], s37 offen offset:2048 lds
    s_add_u32 s37, s37, s39
    v_mfma_f32_16x16x32_bf16 v[120:123], v[172:175], a[88:91], v[120:123]
    ds_read_b128 a[80:83], v238 offset:24576
    v_mfma_f32_16x16x32_bf16 v[124:127], v[172:175], a[92:95], v[124:127]
    s_waitcnt lgkmcnt(11)
    ds_read_b64_tr_b16 v[152:153], v228 offset:20480
    v_mfma_f32_16x16x32_bf16 v[32:35], v[128:131], a[64:67], v[32:35]
    ds_read_b64_tr_b16 v[154:155], v228 offset:26624
    s_add_u32 m0, s34, 24576
    v_mfma_f32_16x16x32_bf16 v[36:39], v[128:131], a[68:71], v[36:39]
    ds_read_b128 a[84:87], v238 offset:25600
    buffer_load_dwordx4 v8, s[40:43], s38 offen offset:0 sc1 lds
    v_mfma_f32_16x16x32_bf16 v[40:43], v[128:131], a[72:75], v[40:43]
    ds_read_b128 a[88:91], v238 offset:26624
    v_mfma_f32_16x16x32_bf16 v[44:47], v[128:131], a[76:79], v[44:47]
    s_waitcnt lgkmcnt(13)
    ds_read_b128 a[92:95], v238 offset:27648
    v_mfma_f32_16x16x32_bf16 v[48:51], v[132:135], a[64:67], v[48:51]
    ds_read_b64_tr_b16 v[156:157], v229 offset:20480
    buffer_load_dwordx4 v9, s[40:43], s38 offen offset:1024 sc1 lds
    v_mfma_f32_16x16x32_bf16 v[52:55], v[132:135], a[68:71], v[52:55]
    ds_read_b64_tr_b16 v[158:159], v229 offset:26624
    s_add_u32 s38, s38, s36
    v_mfma_f32_16x16x32_bf16 v[56:59], v[132:135], a[72:75], v[56:59]
    ds_read_b64_tr_b16 v[160:161], v230 offset:20480
    v_mfma_f32_16x16x32_bf16 v[60:63], v[132:135], a[76:79], v[60:63]
    s_waitcnt lgkmcnt(15)
    ds_read_b64_tr_b16 v[162:163], v230 offset:26624
    v_mfma_f32_16x16x32_bf16 v[64:67], v[136:139], a[64:67], v[64:67]
    v_mfma_f32_16x16x32_bf16 v[68:71], v[136:139], a[68:71], v[68:71]
    v_mfma_f32_16x16x32_bf16 v[72:75], v[136:139], a[72:75], v[72:75]
    ds_read_b64_tr_b16 v[164:165], v231 offset:20480
    v_mfma_f32_16x16x32_bf16 v[76:79], v[136:139], a[76:79], v[76:79]
    s_waitcnt lgkmcnt(15)
    ds_read_b64_tr_b16 v[166:167], v231 offset:26624
    v_mfma_f32_16x16x32_bf16 v[80:83], v[140:143], a[64:67], v[80:83]
    v_mfma_f32_16x16x32_bf16 v[84:87], v[140:143], a[68:71], v[84:87]
    v_mfma_f32_16x16x32_bf16 v[88:91], v[140:143], a[72:75], v[88:91]
    ds_read_b64_tr_b16 v[168:169], v228 offset:20608
    v_mfma_f32_16x16x32_bf16 v[92:95], v[140:143], a[76:79], v[92:95]
    s_waitcnt lgkmcnt(15)
    ds_read_b64_tr_b16 v[170:171], v228 offset:26752
    v_mfma_f32_16x16x32_bf16 v[96:99], v[144:147], a[64:67], v[96:99]
    v_mfma_f32_16x16x32_bf16 v[100:103], v[144:147], a[68:71], v[100:103]
    v_mfma_f32_16x16x32_bf16 v[104:107], v[144:147], a[72:75], v[104:107]
    ds_read_b64_tr_b16 v[172:173], v229 offset:20608
    v_mfma_f32_16x16x32_bf16 v[108:111], v[144:147], a[76:79], v[108:111]
    s_waitcnt lgkmcnt(15)
    ds_read_b64_tr_b16 v[174:175], v229 offset:26752
    v_mfma_f32_16x16x32_bf16 v[112:115], v[148:151], a[64:67], v[112:115]
    v_mfma_f32_16x16x32_bf16 v[116:119], v[148:151], a[68:71], v[116:119]
    v_mfma_f32_16x16x32_bf16 v[120:123], v[148:151], a[72:75], v[120:123]
    v_mfma_f32_16x16x32_bf16 v[124:127], v[148:151], a[76:79], v[124:127]
    s_waitcnt lgkmcnt(10)
    v_mfma_f32_16x16x32_bf16 v[32:35], v[152:155], a[80:83], v[32:35]
    s_add_u32 m0, s34, 32768
    v_mfma_f32_16x16x32_bf16 v[36:39], v[152:155], a[84:87], v[36:39]
    buffer_load_dwordx4 v8, s[40:43], s38 offen offset:0 sc1 lds
    v_mfma_f32_16x16x32_bf16 v[40:43], v[152:155], a[88:91], v[40:43]
    s_waitcnt vmcnt(11)
    s_barrier
    v_mfma_f32_16x16x32_bf16 v[44:47], v[152:155], a[92:95], v[44:47]
    s_waitcnt lgkmcnt(8)
    ds_read_b128 a[64:67], v237 offset:32768
    v_mfma_f32_16x16x32_bf16 v[48:51], v[156:159], a[80:83], v[48:51]
    ds_read_b64_tr_b16 v[128:129], v224 offset:0
    buffer_load_dwordx4 v9, s[40:43], s38 offen offset:1024 sc1 lds
    v_mfma_f32_16x16x32_bf16 v[52:55], v[156:159], a[84:87], v[52:55]
    ds_read_b64_tr_b16 v[130:131], v224 offset:6144
    s_add_u32 s38, s38, s36
    v_mfma_f32_16x16x32_bf16 v[56:59], v[156:159], a[88:91], v[56:59]
    ds_read_b128 a[68:71], v237 offset:33792
    s_add_u32 m0, s35, 61440
    v_mfma_f32_16x16x32_bf16 v[60:63], v[156:159], a[92:95], v[60:63]
    s_waitcnt lgkmcnt(10)
    ds_read_b128 a[72:75], v237 offset:34816
    v_mfma_f32_16x16x32_bf16 v[64:67], v[160:163], a[80:83], v[64:67]
    ds_read_b128 a[76:79], v237 offset:35840
    buffer_load_dwordx4 v220, s[8:11], s37 offen offset:0 lds
    v_mfma_f32_16x16x32_bf16 v[68:71], v[160:163], a[84:87], v[68:71]
    ds_read_b64_tr_b16 v[132:133], v225 offset:0
    buffer_load_dwordx4 v221, s[8:11], s37 offen offset:1024 lds
    v_mfma_f32_16x16x32_bf16 v[72:75], v[160:163], a[88:91], v[72:75]
    ds_read_b64_tr_b16 v[134:135], v225 offset:6144
    v_mfma_f32_16x16x32_bf16 v[76:79], v[160:163], a[92:95], v[76:79]
    s_waitcnt lgkmcnt(12)
    ds_read_b64_tr_b16 v[136:137], v226 offset:0
    v_mfma_f32_16x16x32_bf16 v[80:83], v[164:167], a[80:83], v[80:83]
    ds_read_b64_tr_b16 v[138:139], v226 offset:6144
    buffer_load_dwordx4 v222, s[8:11], s37 offen offset:2048 lds
    v_mfma_f32_16x16x32_bf16 v[84:87], v[164:167], a[84:87], v[84:87]
    ds_read_b64_tr_b16 v[140:141], v227 offset:0
    s_add_u32 s37, s37, s39
    v_mfma_f32_16x16x32_bf16 v[88:91], v[164:167], a[88:91], v[88:91]
    ds_read_b64_tr_b16 v[142:143], v227 offset:6144
    s_add_u32 m0, s35, 73728
    v_mfma_f32_16x16x32_bf16 v[92:95], v[164:167], a[92:95], v[92:95]
    s_waitcnt lgkmcnt(14)
    ds_read_b64_tr_b16 v[144:145], v224 offset:128
    v_mfma_f32_16x16x32_bf16 v[96:99], v[168:171], a[80:83], v[96:99]
    ds_read_b64_tr_b16 v[146:147], v224 offset:6272
    v_mfma_f32_16x16x32_bf16 v[100:103], v[168:171], a[84:87], v[100:103]
    buffer_load_dwordx4 v220, s[8:11], s37 offen offset:0 lds
    v_mfma_f32_16x16x32_bf16 v[104:107], v[168:171], a[88:91], v[104:107]
    ds_read_b64_tr_b16 v[148:149], v225 offset:128
    v_mfma_f32_16x16x32_bf16 v[108:111], v[168:171], a[92:95], v[108:111]
    s_waitcnt lgkmcnt(15)
    ds_read_b64_tr_b16 v[150:151], v225 offset:6272
    v_mfma_f32_16x16x32_bf16 v[112:115], v[172:175], a[80:83], v[112:115]
    buffer_load_dwordx4 v221, s[8:11], s37 offen offset:1024 lds
    v_mfma_f32_16x16x32_bf16 v[116:119], v[172:175], a[84:87], v[116:119]
    buffer_load_dwordx4 v222, s[8:11], s37 offen offset:2048 lds
    s_add_u32 s37, s37, s39
    v_mfma_f32_16x16x32_bf16 v[120:123], v[172:175], a[88:91], v[120:123]
    ds_read_b128 a[80:83], v237 offset:40960
    v_mfma_f32_16x16x32_bf16 v[124:127], v[172:175], a[92:95], v[124:127]
    s_waitcnt lgkmcnt(11)
    ds_read_b64_tr_b16 v[152:153], v224 offset:12288
    v_mfma_f32_16x16x32_bf16 v[32:35], v[128:131], a[64:67], v[32:35]
    ds_read_b64_tr_b16 v[154:155], v224 offset:18432
    s_add_u32 m0, s34, 40960
    v_mfma_f32_16x16x32_bf16 v[36:39], v[128:131], a[68:71], v[36:39]
    ds_read_b128 a[84:87], v237 offset:41984
    buffer_load_dwordx4 v8, s[40:43], s38 offen offset:0 sc1 lds
    v_mfma_f32_16x16x32_bf16 v[40:43], v[128:131], a[72:75], v[40:43]
    ds_read_b128 a[88:91], v237 offset:43008
    v_mfma_f32_16x16x32_bf16 v[44:47], v[128:131], a[76:79], v[44:47]
    s_waitcnt lgkmcnt(13)
    ds_read_b128 a[92:95], v237 offset:44032
    v_mfma_f32_16x16x32_bf16 v[48:51], v[132:135], a[64:67], v[48:51]
    ds_read_b64_tr_b16 v[156:157], v225 offset:12288
    buffer_load_dwordx4 v9, s[40:43], s38 offen offset:1024 sc1 lds
    v_mfma_f32_16x16x32_bf16 v[52:55], v[132:135], a[68:71], v[52:55]
    ds_read_b64_tr_b16 v[158:159], v225 offset:18432
    s_add_u32 s38, s38, s36
    v_mfma_f32_16x16x32_bf16 v[56:59], v[132:135], a[72:75], v[56:59]
    ds_read_b64_tr_b16 v[160:161], v226 offset:12288
    v_mfma_f32_16x16x32_bf16 v[60:63], v[132:135], a[76:79], v[60:63]
    s_waitcnt lgkmcnt(15)
    ds_read_b64_tr_b16 v[162:163], v226 offset:18432
    v_mfma_f32_16x16x32_bf16 v[64:67], v[136:139], a[64:67], v[64:67]
    v_mfma_f32_16x16x32_bf16 v[68:71], v[136:139], a[68:71], v[68:71]
    v_mfma_f32_16x16x32_bf16 v[72:75], v[136:139], a[72:75], v[72:75]
    ds_read_b64_tr_b16 v[164:165], v227 offset:12288
    v_mfma_f32_16x16x32_bf16 v[76:79], v[136:139], a[76:79], v[76:79]
    s_waitcnt lgkmcnt(15)
    ds_read_b64_tr_b16 v[166:167], v227 offset:18432
    v_mfma_f32_16x16x32_bf16 v[80:83], v[140:143], a[64:67], v[80:83]
    v_mfma_f32_16x16x32_bf16 v[84:87], v[140:143], a[68:71], v[84:87]
    v_mfma_f32_16x16x32_bf16 v[88:91], v[140:143], a[72:75], v[88:91]
    ds_read_b64_tr_b16 v[168:169], v224 offset:12416
    v_mfma_f32_16x16x32_bf16 v[92:95], v[140:143], a[76:79], v[92:95]
    s_waitcnt lgkmcnt(15)
    ds_read_b64_tr_b16 v[170:171], v224 offset:18560
    v_mfma_f32_16x16x32_bf16 v[96:99], v[144:147], a[64:67], v[96:99]
    v_mfma_f32_16x16x32_bf16 v[100:103], v[144:147], a[68:71], v[100:103]
    v_mfma_f32_16x16x32_bf16 v[104:107], v[144:147], a[72:75], v[104:107]
    ds_read_b64_tr_b16 v[172:173], v225 offset:12416
    v_mfma_f32_16x16x32_bf16 v[108:111], v[144:147], a[76:79], v[108:111]
    s_waitcnt lgkmcnt(15)
    ds_read_b64_tr_b16 v[174:175], v225 offset:18560
    v_mfma_f32_16x16x32_bf16 v[112:115], v[148:151], a[64:67], v[112:115]
    v_mfma_f32_16x16x32_bf16 v[116:119], v[148:151], a[68:71], v[116:119]
    v_mfma_f32_16x16x32_bf16 v[120:123], v[148:151], a[72:75], v[120:123]
    v_mfma_f32_16x16x32_bf16 v[124:127], v[148:151], a[76:79], v[124:127]
    s_waitcnt lgkmcnt(10)
    v_mfma_f32_16x16x32_bf16 v[32:35], v[152:155], a[80:83], v[32:35]
    s_add_u32 m0, s34, 49152
    v_mfma_f32_16x16x32_bf16 v[36:39], v[152:155], a[84:87], v[36:39]
    buffer_load_dwordx4 v8, s[40:43], s38 offen offset:0 sc1 lds
    v_mfma_f32_16x16x32_bf16 v[40:43], v[152:155], a[88:91], v[40:43]
    s_waitcnt vmcnt(11)
    s_barrier
    v_mfma_f32_16x16x32_bf16 v[44:47], v[152:155], a[92:95], v[44:47]
    s_waitcnt lgkmcnt(8)
    ds_read_b128 a[64:67], v237 offset:49152
    v_mfma_f32_16x16x32_bf16 v[48:51], v[156:159], a[80:83], v[48:51]
    ds_read_b64_tr_b16 v[128:129], v224 offset:24576
    buffer_load_dwordx4 v9, s[40:43], s38 offen offset:1024 sc1 lds
    v_mfma_f32_16x16x32_bf16 v[52:55], v[156:159], a[84:87], v[52:55]
    ds_read_b64_tr_b16 v[130:131], v224 offset:30720
    s_add_u32 s38, s38, s36
    v_mfma_f32_16x16x32_bf16 v[56:59], v[156:159], a[88:91], v[56:59]
    ds_read_b128 a[68:71], v237 offset:50176
    s_add_u32 m0, s35, 86016
    v_mfma_f32_16x16x32_bf16 v[60:63], v[156:159], a[92:95], v[60:63]
    s_waitcnt lgkmcnt(10)
    ds_read_b128 a[72:75], v237 offset:51200
    v_mfma_f32_16x16x32_bf16 v[64:67], v[160:163], a[80:83], v[64:67]
    ds_read_b128 a[76:79], v237 offset:52224
    buffer_load_dwordx4 v220, s[8:11], s37 offen offset:0 lds
    v_mfma_f32_16x16x32_bf16 v[68:71], v[160:163], a[84:87], v[68:71]
    ds_read_b64_tr_b16 v[132:133], v225 offset:24576
    buffer_load_dwordx4 v221, s[8:11], s37 offen offset:1024 lds
    v_mfma_f32_16x16x32_bf16 v[72:75], v[160:163], a[88:91], v[72:75]
    ds_read_b64_tr_b16 v[134:135], v225 offset:30720
    v_mfma_f32_16x16x32_bf16 v[76:79], v[160:163], a[92:95], v[76:79]
    s_waitcnt lgkmcnt(12)
    ds_read_b64_tr_b16 v[136:137], v226 offset:24576
    v_mfma_f32_16x16x32_bf16 v[80:83], v[164:167], a[80:83], v[80:83]
    ds_read_b64_tr_b16 v[138:139], v226 offset:30720
    buffer_load_dwordx4 v222, s[8:11], s37 offen offset:2048 lds
    v_mfma_f32_16x16x32_bf16 v[84:87], v[164:167], a[84:87], v[84:87]
    ds_read_b64_tr_b16 v[140:141], v227 offset:24576
    s_add_u32 s37, s37, s39
    v_mfma_f32_16x16x32_bf16 v[88:91], v[164:167], a[88:91], v[88:91]
    ds_read_b64_tr_b16 v[142:143], v227 offset:30720
    v_mfma_f32_16x16x32_bf16 v[92:95], v[164:167], a[92:95], v[92:95]
    s_waitcnt lgkmcnt(14)
    ds_read_b64_tr_b16 v[144:145], v224 offset:24704
    v_mfma_f32_16x16x32_bf16 v[96:99], v[168:171], a[80:83], v[96:99]
    ds_read_b64_tr_b16 v[146:147], v224 offset:30848
    v_mfma_f32_16x16x32_bf16 v[100:103], v[168:171], a[84:87], v[100:103]
    v_mfma_f32_16x16x32_bf16 v[104:107], v[168:171], a[88:91], v[104:107]
    ds_read_b64_tr_b16 v[148:149], v225 offset:24704
    v_mfma_f32_16x16x32_bf16 v[108:111], v[168:171], a[92:95], v[108:111]
    s_waitcnt lgkmcnt(15)
    ds_read_b64_tr_b16 v[150:151], v225 offset:30848
    v_mfma_f32_16x16x32_bf16 v[112:115], v[172:175], a[80:83], v[112:115]
    v_mfma_f32_16x16x32_bf16 v[116:119], v[172:175], a[84:87], v[116:119]
    v_mfma_f32_16x16x32_bf16 v[120:123], v[172:175], a[88:91], v[120:123]
    ds_read_b128 a[80:83], v237 offset:57344
    v_mfma_f32_16x16x32_bf16 v[124:127], v[172:175], a[92:95], v[124:127]
    s_waitcnt lgkmcnt(11)
    ds_read_b64_tr_b16 v[152:153], v224 offset:36864
    v_mfma_f32_16x16x32_bf16 v[32:35], v[128:131], a[64:67], v[32:35]
    ds_read_b64_tr_b16 v[154:155], v224 offset:43008
    s_add_u32 m0, s35, 0
    v_mfma_f32_16x16x32_bf16 v[36:39], v[128:131], a[68:71], v[36:39]
    ds_read_b128 a[84:87], v237 offset:58368
    v_mfma_f32_16x16x32_bf16 v[40:43], v[128:131], a[72:75], v[40:43]
    ds_read_b128 a[88:91], v237 offset:59392
    v_mfma_f32_16x16x32_bf16 v[44:47], v[128:131], a[76:79], v[44:47]
    s_waitcnt lgkmcnt(13)
    ds_read_b128 a[92:95], v237 offset:60416
    v_mfma_f32_16x16x32_bf16 v[48:51], v[132:135], a[64:67], v[48:51]
    ds_read_b64_tr_b16 v[156:157], v225 offset:36864
    v_mfma_f32_16x16x32_bf16 v[52:55], v[132:135], a[68:71], v[52:55]
    ds_read_b64_tr_b16 v[158:159], v225 offset:43008
    v_mfma_f32_16x16x32_bf16 v[56:59], v[132:135], a[72:75], v[56:59]
    ds_read_b64_tr_b16 v[160:161], v226 offset:36864
    v_mfma_f32_16x16x32_bf16 v[60:63], v[132:135], a[76:79], v[60:63]
    s_waitcnt lgkmcnt(15)
    ds_read_b64_tr_b16 v[162:163], v226 offset:43008
    v_mfma_f32_16x16x32_bf16 v[64:67], v[136:139], a[64:67], v[64:67]
    buffer_load_dwordx4 v220, s[8:11], s37 offen offset:0 lds
    v_mfma_f32_16x16x32_bf16 v[68:71], v[136:139], a[68:71], v[68:71]
    buffer_load_dwordx4 v221, s[8:11], s37 offen offset:1024 lds
    buffer_load_dwordx4 v222, s[8:11], s37 offen offset:2048 lds
    s_add_u32 s37, s37, s39
    v_mfma_f32_16x16x32_bf16 v[72:75], v[136:139], a[72:75], v[72:75]
    ds_read_b64_tr_b16 v[164:165], v227 offset:36864
    s_add_u32 m0, s34, 57344
    v_mfma_f32_16x16x32_bf16 v[76:79], v[136:139], a[76:79], v[76:79]
    s_waitcnt lgkmcnt(15)
    ds_read_b64_tr_b16 v[166:167], v227 offset:43008
    v_mfma_f32_16x16x32_bf16 v[80:83], v[140:143], a[64:67], v[80:83]
    buffer_load_dwordx4 v8, s[40:43], s38 offen offset:0 sc1 lds
    v_mfma_f32_16x16x32_bf16 v[84:87], v[140:143], a[68:71], v[84:87]
    buffer_load_dwordx4 v9, s[40:43], s38 offen offset:1024 sc1 lds
    v_mfma_f32_16x16x32_bf16 v[88:91], v[140:143], a[72:75], v[88:91]
    ds_read_b64_tr_b16 v[168:169], v224 offset:36992
    s_add_u32 s38, s38, s36
    v_mfma_f32_16x16x32_bf16 v[92:95], v[140:143], a[76:79], v[92:95]
    s_waitcnt lgkmcnt(15)
    ds_read_b64_tr_b16 v[170:171], v224 offset:43136
    v_mfma_f32_16x16x32_bf16 v[96:99], v[144:147], a[64:67], v[96:99]
    v_mfma_f32_16x16x32_bf16 v[100:103], v[144:147], a[68:71], v[100:103]
    v_mfma_f32_16x16x32_bf16 v[104:107], v[144:147], a[72:75], v[104:107]
    ds_read_b64_tr_b16 v[172:173], v225 offset:36992
    v_mfma_f32_16x16x32_bf16 v[108:111], v[144:147], a[76:79], v[108:111]
    s_waitcnt lgkmcnt(15)
    ds_read_b64_tr_b16 v[174:175], v225 offset:43136
    v_mfma_f32_16x16x32_bf16 v[112:115], v[148:151], a[64:67], v[112:115]
    v_mfma_f32_16x16x32_bf16 v[116:119], v[148:151], a[68:71], v[116:119]
    v_mfma_f32_16x16x32_bf16 v[120:123], v[148:151], a[72:75], v[120:123]
    v_mfma_f32_16x16x32_bf16 v[124:127], v[148:151], a[76:79], v[124:127]
    s_waitcnt lgkmcnt(10)
    v_mfma_f32_16x16x32_bf16 v[32:35], v[152:155], a[80:83], v[32:35]
    s_add_u32 m0, s34, 0
    v_mfma_f32_16x16x32_bf16 v[36:39], v[152:155], a[84:87], v[36:39]
    buffer_load_dwordx4 v8, s[40:43], s38 offen offset:0 sc1 lds
    v_mfma_f32_16x16x32_bf16 v[40:43], v[152:155], a[88:91], v[40:43]
    s_waitcnt vmcnt(11)
    s_barrier
    v_mfma_f32_16x16x32_bf16 v[44:47], v[152:155], a[92:95], v[44:47]
    s_waitcnt lgkmcnt(8)
    ds_read_b128 a[64:67], v238 offset:0
    v_mfma_f32_16x16x32_bf16 v[48:51], v[156:159], a[80:83], v[48:51]
    ds_read_b64_tr_b16 v[128:129], v224 offset:49152
    buffer_load_dwordx4 v9, s[40:43], s38 offen offset:1024 sc1 lds
    v_mfma_f32_16x16x32_bf16 v[52:55], v[156:159], a[84:87], v[52:55]
    ds_read_b64_tr_b16 v[130:131], v224 offset:55296
    s_add_u32 s38, s38, s36
    v_mfma_f32_16x16x32_bf16 v[56:59], v[156:159], a[88:91], v[56:59]
    ds_read_b128 a[68:71], v238 offset:1024
    s_add_u32 m0, s35, 12288
    v_mfma_f32_16x16x32_bf16 v[60:63], v[156:159], a[92:95], v[60:63]
    s_waitcnt lgkmcnt(10)
    ds_read_b128 a[72:75], v238 offset:2048
    v_mfma_f32_16x16x32_bf16 v[64:67], v[160:163], a[80:83], v[64:67]
    ds_read_b128 a[76:79], v238 offset:3072
    buffer_load_dwordx4 v220, s[8:11], s37 offen offset:0 lds
    v_mfma_f32_16x16x32_bf16 v[68:71], v[160:163], a[84:87], v[68:71]
    ds_read_b64_tr_b16 v[132:133], v225 offset:49152
    v_mfma_f32_16x16x32_bf16 v[72:75], v[160:163], a[88:91], v[72:75]
    ds_read_b64_tr_b16 v[134:135], v225 offset:55296
    buffer_load_dwordx4 v221, s[8:11], s37 offen offset:1024 lds
    v_mfma_f32_16x16x32_bf16 v[76:79], v[160:163], a[92:95], v[76:79]
    s_waitcnt lgkmcnt(12)
    ds_read_b64_tr_b16 v[136:137], v226 offset:49152
    v_mfma_f32_16x16x32_bf16 v[80:83], v[164:167], a[80:83], v[80:83]
    ds_read_b64_tr_b16 v[138:139], v226 offset:55296
    buffer_load_dwordx4 v222, s[8:11], s37 offen offset:2048 lds
    v_mfma_f32_16x16x32_bf16 v[84:87], v[164:167], a[84:87], v[84:87]
    ds_read_b64_tr_b16 v[140:141], v227 offset:49152
    v_mfma_f32_16x16x32_bf16 v[88:91], v[164:167], a[88:91], v[88:91]
    ds_read_b64_tr_b16 v[142:143], v227 offset:55296
    s_add_u32 s37, s37, s39
    v_mfma_f32_16x16x32_bf16 v[92:95], v[164:167], a[92:95], v[92:95]
    s_waitcnt lgkmcnt(14)
    ds_read_b64_tr_b16 v[144:145], v224 offset:49280
    v_mfma_f32_16x16x32_bf16 v[96:99], v[168:171], a[80:83], v[96:99]
    ds_read_b64_tr_b16 v[146:147], v224 offset:55424
    v_mfma_f32_16x16x32_bf16 v[100:103], v[168:171], a[84:87], v[100:103]
    v_mfma_f32_16x16x32_bf16 v[104:107], v[168:171], a[88:91], v[104:107]
    ds_read_b64_tr_b16 v[148:149], v225 offset:49280
    v_mfma_f32_16x16x32_bf16 v[108:111], v[168:171], a[92:95], v[108:111]
    s_waitcnt lgkmcnt(15)
    ds_read_b64_tr_b16 v[150:151], v225 offset:55424
    v_mfma_f32_16x16x32_bf16 v[112:115], v[172:175], a[80:83], v[112:115]
    v_mfma_f32_16x16x32_bf16 v[116:119], v[172:175], a[84:87], v[116:119]
    v_mfma_f32_16x16x32_bf16 v[120:123], v[172:175], a[88:91], v[120:123]
    ds_read_b128 a[80:83], v238 offset:8192
    v_mfma_f32_16x16x32_bf16 v[124:127], v[172:175], a[92:95], v[124:127]
    s_waitcnt lgkmcnt(11)
    ds_read_b64_tr_b16 v[152:153], v224 offset:61440
    v_mfma_f32_16x16x32_bf16 v[32:35], v[128:131], a[64:67], v[32:35]
    ds_read_b64_tr_b16 v[154:155], v228 offset:2048
    s_add_u32 m0, s34, 8192
    v_mfma_f32_16x16x32_bf16 v[36:39], v[128:131], a[68:71], v[36:39]
    ds_read_b128 a[84:87], v238 offset:9216
    buffer_load_dwordx4 v8, s[40:43], s38 offen offset:0 sc1 lds
    v_mfma_f32_16x16x32_bf16 v[40:43], v[128:131], a[72:75], v[40:43]
    ds_read_b128 a[88:91], v238 offset:10240
    v_mfma_f32_16x16x32_bf16 v[44:47], v[128:131], a[76:79], v[44:47]
    s_waitcnt lgkmcnt(13)
    ds_read_b128 a[92:95], v238 offset:11264
    v_mfma_f32_16x16x32_bf16 v[48:51], v[132:135], a[64:67], v[48:51]
    ds_read_b64_tr_b16 v[156:157], v225 offset:61440
    buffer_load_dwordx4 v9, s[40:43], s38 offen offset:1024 sc1 lds
    v_mfma_f32_16x16x32_bf16 v[52:55], v[132:135], a[68:71], v[52:55]
    ds_read_b64_tr_b16 v[158:159], v229 offset:2048
    s_add_u32 s38, s38, s36
    v_mfma_f32_16x16x32_bf16 v[56:59], v[132:135], a[72:75], v[56:59]
    ds_read_b64_tr_b16 v[160:161], v226 offset:61440
    v_mfma_f32_16x16x32_bf16 v[60:63], v[132:135], a[76:79], v[60:63]
    s_waitcnt lgkmcnt(15)
    ds_read_b64_tr_b16 v[162:163], v230 offset:2048
    v_mfma_f32_16x16x32_bf16 v[64:67], v[136:139], a[64:67], v[64:67]
    v_mfma_f32_16x16x32_bf16 v[68:71], v[136:139], a[68:71], v[68:71]
    v_mfma_f32_16x16x32_bf16 v[72:75], v[136:139], a[72:75], v[72:75]
    ds_read_b64_tr_b16 v[164:165], v227 offset:61440
    v_mfma_f32_16x16x32_bf16 v[76:79], v[136:139], a[76:79], v[76:79]
    s_waitcnt lgkmcnt(15)
    ds_read_b64_tr_b16 v[166:167], v231 offset:2048
    v_mfma_f32_16x16x32_bf16 v[80:83], v[140:143], a[64:67], v[80:83]
    s_add_u32 m0, s35, 24576
    v_mfma_f32_16x16x32_bf16 v[84:87], v[140:143], a[68:71], v[84:87]
    v_mfma_f32_16x16x32_bf16 v[88:91], v[140:143], a[72:75], v[88:91]
    ds_read_b64_tr_b16 v[168:169], v224 offset:61568
    v_mfma_f32_16x16x32_bf16 v[92:95], v[140:143], a[76:79], v[92:95]
    s_waitcnt lgkmcnt(15)
    ds_read_b64_tr_b16 v[170:171], v228 offset:2176
    v_mfma_f32_16x16x32_bf16 v[96:99], v[144:147], a[64:67], v[96:99]
    buffer_load_dwordx4 v220, s[8:11], s37 offen offset:0 lds
    v_mfma_f32_16x16x32_bf16 v[100:103], v[144:147], a[68:71], v[100:103]
    buffer_load_dwordx4 v221, s[8:11], s37 offen offset:1024 lds
    v_mfma_f32_16x16x32_bf16 v[104:107], v[144:147], a[72:75], v[104:107]
    ds_read_b64_tr_b16 v[172:173], v225 offset:61568
    v_mfma_f32_16x16x32_bf16 v[108:111], v[144:147], a[76:79], v[108:111]
    s_waitcnt lgkmcnt(15)
    ds_read_b64_tr_b16 v[174:175], v229 offset:2176
    v_mfma_f32_16x16x32_bf16 v[112:115], v[148:151], a[64:67], v[112:115]
    buffer_load_dwordx4 v222, s[8:11], s37 offen offset:2048 lds
    s_add_u32 s37, s37, s39
    v_mfma_f32_16x16x32_bf16 v[116:119], v[148:151], a[68:71], v[116:119]
    v_mfma_f32_16x16x32_bf16 v[120:123], v[148:151], a[72:75], v[120:123]
    v_mfma_f32_16x16x32_bf16 v[124:127], v[148:151], a[76:79], v[124:127]
    s_waitcnt lgkmcnt(10)
    v_mfma_f32_16x16x32_bf16 v[32:35], v[152:155], a[80:83], v[32:35]
    s_add_u32 m0, s34, 16384
    v_mfma_f32_16x16x32_bf16 v[36:39], v[152:155], a[84:87], v[36:39]
    buffer_load_dwordx4 v8, s[40:43], s38 offen offset:0 sc1 lds
    v_mfma_f32_16x16x32_bf16 v[40:43], v[152:155], a[88:91], v[40:43]
    s_waitcnt vmcnt(11)
    s_barrier
    v_mfma_f32_16x16x32_bf16 v[44:47], v[152:155], a[92:95], v[44:47]
    s_waitcnt lgkmcnt(8)
    ds_read_b128 a[64:67], v238 offset:16384
    v_mfma_f32_16x16x32_bf16 v[48:51], v[156:159], a[80:83], v[48:51]
    ds_read_b64_tr_b16 v[128:129], v228 offset:8192
    buffer_load_dwordx4 v9, s[40:43], s38 offen offset:1024 sc1 lds
    v_mfma_f32_16x16x32_bf16 v[52:55], v[156:159], a[84:87], v[52:55]
    ds_read_b64_tr_b16 v[130:131], v228 offset:14336
    s_add_u32 s38, s38, s36
    v_mfma_f32_16x16x32_bf16 v[56:59], v[156:159], a[88:91], v[56:59]
    ds_read_b128 a[68:71], v238 offset:17408
    v_mfma_f32_16x16x32_bf16 v[60:63], v[156:159], a[92:95], v[60:63]
    s_waitcnt lgkmcnt(10)
    ds_read_b128 a[72:75], v238 offset:18432
    v_mfma_f32_16x16x32_bf16 v[64:67], v[160:163], a[80:83], v[64:67]
    ds_read_b128 a[76:79], v238 offset:19456
    v_mfma_f32_16x16x32_bf16 v[68:71], v[160:163], a[84:87], v[68:71]
    ds_read_b64_tr_b16 v[132:133], v229 offset:8192
    v_mfma_f32_16x16x32_bf16 v[72:75], v[160:163], a[88:91], v[72:75]
    ds_read_b64_tr_b16 v[134:135], v229 offset:14336
    v_mfma_f32_16x16x32_bf16 v[76:79], v[160:163], a[92:95], v[76:79]
    s_waitcnt lgkmcnt(12)
    ds_read_b64_tr_b16 v[136:137], v230 offset:8192
    v_mfma_f32_16x16x32_bf16 v[80:83], v[164:167], a[80:83], v[80:83]
    ds_read_b64_tr_b16 v[138:139], v230 offset:14336
    v_mfma_f32_16x16x32_bf16 v[84:87], v[164:167], a[84:87], v[84:87]
    ds_read_b64_tr_b16 v[140:141], v231 offset:8192
    v_mfma_f32_16x16x32_bf16 v[88:91], v[164:167], a[88:91], v[88:91]
    ds_read_b64_tr_b16 v[142:143], v231 offset:14336
    v_mfma_f32_16x16x32_bf16 v[92:95], v[164:167], a[92:95], v[92:95]
    s_waitcnt lgkmcnt(14)
    ds_read_b64_tr_b16 v[144:145], v228 offset:8320
    v_mfma_f32_16x16x32_bf16 v[96:99], v[168:171], a[80:83], v[96:99]
    ds_read_b64_tr_b16 v[146:147], v228 offset:14464
    v_mfma_f32_16x16x32_bf16 v[100:103], v[168:171], a[84:87], v[100:103]
    v_mfma_f32_16x16x32_bf16 v[104:107], v[168:171], a[88:91], v[104:107]
    ds_read_b64_tr_b16 v[148:149], v229 offset:8320
    s_add_u32 m0, s35, 36864
    v_mfma_f32_16x16x32_bf16 v[108:111], v[168:171], a[92:95], v[108:111]
    s_waitcnt lgkmcnt(15)
    ds_read_b64_tr_b16 v[150:151], v229 offset:14464
    v_mfma_f32_16x16x32_bf16 v[112:115], v[172:175], a[80:83], v[112:115]
    buffer_load_dwordx4 v220, s[8:11], s37 offen offset:0 lds
    v_mfma_f32_16x16x32_bf16 v[116:119], v[172:175], a[84:87], v[116:119]
    v_mfma_f32_16x16x32_bf16 v[120:123], v[172:175], a[88:91], v[120:123]
    ds_read_b128 a[80:83], v238 offset:24576
    buffer_load_dwordx4 v221, s[8:11], s37 offen offset:1024 lds
    v_mfma_f32_16x16x32_bf16 v[124:127], v[172:175], a[92:95], v[124:127]
    s_waitcnt lgkmcnt(11)
    ds_read_b64_tr_b16 v[152:153], v228 offset:20480
    v_mfma_f32_16x16x32_bf16 v[32:35], v[128:131], a[64:67], v[32:35]
    ds_read_b64_tr_b16 v[154:155], v228 offset:26624
    buffer_load_dwordx4 v222, s[8:11], s37 offen offset:2048 lds
    v_mfma_f32_16x16x32_bf16 v[36:39], v[128:131], a[68:71], v[36:39]
    ds_read_b128 a[84:87], v238 offset:25600
    v_mfma_f32_16x16x32_bf16 v[40:43], v[128:131], a[72:75], v[40:43]
    ds_read_b128 a[88:91], v238 offset:26624
    s_add_u32 s37, s37, s39
    v_mfma_f32_16x16x32_bf16 v[44:47], v[128:131], a[76:79], v[44:47]
    s_waitcnt lgkmcnt(13)
    ds_read_b128 a[92:95], v238 offset:27648
    v_mfma_f32_16x16x32_bf16 v[48:51], v[132:135], a[64:67], v[48:51]
    ds_read_b64_tr_b16 v[156:157], v229 offset:20480
    s_add_u32 m0, s34, 24576
    v_mfma_f32_16x16x32_bf16 v[52:55], v[132:135], a[68:71], v[52:55]
    ds_read_b64_tr_b16 v[158:159], v229 offset:26624
    v_mfma_f32_16x16x32_bf16 v[56:59], v[132:135], a[72:75], v[56:59]
    ds_read_b64_tr_b16 v[160:161], v230 offset:20480
    v_mfma_f32_16x16x32_bf16 v[60:63], v[132:135], a[76:79], v[60:63]
    s_waitcnt lgkmcnt(15)
    ds_read_b64_tr_b16 v[162:163], v230 offset:26624
    v_mfma_f32_16x16x32_bf16 v[64:67], v[136:139], a[64:67], v[64:67]
    buffer_load_dwordx4 v8, s[40:43], s38 offen offset:0 sc1 lds
    buffer_load_dwordx4 v9, s[40:43], s38 offen offset:1024 sc1 lds
    s_add_u32 s38, s38, s36
    v_mfma_f32_16x16x32_bf16 v[68:71], v[136:139], a[68:71], v[68:71]
    v_mfma_f32_16x16x32_bf16 v[72:75], v[136:139], a[72:75], v[72:75]
    ds_read_b64_tr_b16 v[164:165], v231 offset:20480
    v_mfma_f32_16x16x32_bf16 v[76:79], v[136:139], a[76:79], v[76:79]
    s_waitcnt lgkmcnt(15)
    ds_read_b64_tr_b16 v[166:167], v231 offset:26624
    v_mfma_f32_16x16x32_bf16 v[80:83], v[140:143], a[64:67], v[80:83]
    v_mfma_f32_16x16x32_bf16 v[84:87], v[140:143], a[68:71], v[84:87]
    v_mfma_f32_16x16x32_bf16 v[88:91], v[140:143], a[72:75], v[88:91]
    ds_read_b64_tr_b16 v[168:169], v228 offset:20608
    v_mfma_f32_16x16x32_bf16 v[92:95], v[140:143], a[76:79], v[92:95]
    s_waitcnt lgkmcnt(15)
    ds_read_b64_tr_b16 v[170:171], v228 offset:26752
    v_mfma_f32_16x16x32_bf16 v[96:99], v[144:147], a[64:67], v[96:99]
    v_mfma_f32_16x16x32_bf16 v[100:103], v[144:147], a[68:71], v[100:103]
    v_mfma_f32_16x16x32_bf16 v[104:107], v[144:147], a[72:75], v[104:107]
    ds_read_b64_tr_b16 v[172:173], v229 offset:20608
    v_mfma_f32_16x16x32_bf16 v[108:111], v[144:147], a[76:79], v[108:111]
    s_waitcnt lgkmcnt(15)
    ds_read_b64_tr_b16 v[174:175], v229 offset:26752
    v_mfma_f32_16x16x32_bf16 v[112:115], v[148:151], a[64:67], v[112:115]
    v_mfma_f32_16x16x32_bf16 v[116:119], v[148:151], a[68:71], v[116:119]
    v_mfma_f32_16x16x32_bf16 v[120:123], v[148:151], a[72:75], v[120:123]
    v_mfma_f32_16x16x32_bf16 v[124:127], v[148:151], a[76:79], v[124:127]
    s_waitcnt lgkmcnt(10)
    v_mfma_f32_16x16x32_bf16 v[32:35], v[152:155], a[80:83], v[32:35]
    s_add_u32 m0, s35, 49152
    v_mfma_f32_16x16x32_bf16 v[36:39], v[152:155], a[84:87], v[36:39]
    v_mfma_f32_16x16x32_bf16 v[40:43], v[152:155], a[88:91], v[40:43]
    s_waitcnt vmcnt(10)
    s_barrier
    buffer_load_dwordx4 v220, s[8:11], s37 offen offset:0 lds
    v_mfma_f32_16x16x32_bf16 v[44:47], v[152:155], a[92:95], v[44:47]
    s_waitcnt lgkmcnt(8)
    ds_read_b128 a[64:67], v237 offset:32768
    v_mfma_f32_16x16x32_bf16 v[48:51], v[156:159], a[80:83], v[48:51]
    ds_read_b64_tr_b16 v[128:129], v224 offset:0
    buffer_load_dwordx4 v221, s[8:11], s37 offen offset:1024 lds
    v_mfma_f32_16x16x32_bf16 v[52:55], v[156:159], a[84:87], v[52:55]
    ds_read_b64_tr_b16 v[130:131], v224 offset:6144
    v_mfma_f32_16x16x32_bf16 v[56:59], v[156:159], a[88:91], v[56:59]
    ds_read_b128 a[68:71], v237 offset:33792
    buffer_load_dwordx4 v222, s[8:11], s37 offen offset:2048 lds
    v_mfma_f32_16x16x32_bf16 v[60:63], v[156:159], a[92:95], v[60:63]
    s_waitcnt lgkmcnt(10)
    ds_read_b128 a[72:75], v237 offset:34816
    v_mfma_f32_16x16x32_bf16 v[64:67], v[160:163], a[80:83], v[64:67]
    ds_read_b128 a[76:79], v237 offset:35840
    s_add_u32 s37, s37, s39
    v_mfma_f32_16x16x32_bf16 v[68:71], v[160:163], a[84:87], v[68:71]
    ds_read_b64_tr_b16 v[132:133], v225 offset:0
    s_add_u32 m0, s34, 32768
    v_mfma_f32_16x16x32_bf16 v[72:75], v[160:163], a[88:91], v[72:75]
    ds_read_b64_tr_b16 v[134:135], v225 offset:6144
    buffer_load_dwordx4 v8, s[40:43], s38 offen offset:0 sc1 lds
    v_mfma_f32_16x16x32_bf16 v[76:79], v[160:163], a[92:95], v[76:79]
    s_waitcnt lgkmcnt(12)
    ds_read_b64_tr_b16 v[136:137], v226 offset:0
    v_mfma_f32_16x16x32_bf16 v[80:83], v[164:167], a[80:83], v[80:83]
    ds_read_b64_tr_b16 v[138:139], v226 offset:6144
    buffer_load_dwordx4 v9, s[40:43], s38 offen offset:1024 sc1 lds
    v_mfma_f32_16x16x32_bf16 v[84:87], v[164:167], a[84:87], v[84:87]
    ds_read_b64_tr_b16 v[140:141], v227 offset:0
    s_add_u32 s38, s38, s36
    v_mfma_f32_16x16x32_bf16 v[88:91], v[164:167], a[88:91], v[88:91]
    ds_read_b64_tr_b16 v[142:143], v227 offset:6144
    v_mfma_f32_16x16x32_bf16 v[92:95], v[164:167], a[92:95], v[92:95]
    s_waitcnt lgkmcnt(14)
    ds_read_b64_tr_b16 v[144:145], v224 offset:128
    v_mfma_f32_16x16x32_bf16 v[96:99], v[168:171], a[80:83], v[96:99]
    ds_read_b64_tr_b16 v[146:147], v224 offset:6272
    v_mfma_f32_16x16x32_bf16 v[100:103], v[168:171], a[84:87], v[100:103]
    v_mfma_f32_16x16x32_bf16 v[104:107], v[168:171], a[88:91], v[104:107]
    ds_read_b64_tr_b16 v[148:149], v225 offset:128
    v_mfma_f32_16x16x32_bf16 v[108:111], v[168:171], a[92:95], v[108:111]
    s_waitcnt lgkmcnt(15)
    ds_read_b64_tr_b16 v[150:151], v225 offset:6272
    v_mfma_f32_16x16x32_bf16 v[112:115], v[172:175], a[80:83], v[112:115]
    v_mfma_f32_16x16x32_bf16 v[116:119], v[172:175], a[84:87], v[116:119]
    v_mfma_f32_16x16x32_bf16 v[120:123], v[172:175], a[88:91], v[120:123]
    ds_read_b128 a[80:83], v237 offset:40960
    v_mfma_f32_16x16x32_bf16 v[124:127], v[172:175], a[92:95], v[124:127]
    s_waitcnt lgkmcnt(11)
    ds_read_b64_tr_b16 v[152:153], v224 offset:12288
    v_mfma_f32_16x16x32_bf16 v[32:35], v[128:131], a[64:67], v[32:35]
    ds_read_b64_tr_b16 v[154:155], v224 offset:18432
    s_add_u32 m0, s34, 40960
    v_mfma_f32_16x16x32_bf16 v[36:39], v[128:131], a[68:71], v[36:39]
    ds_read_b128 a[84:87], v237 offset:41984
    buffer_load_dwordx4 v8, s[40:43], s38 offen offset:0 sc1 lds
    v_mfma_f32_16x16x32_bf16 v[40:43], v[128:131], a[72:75], v[40:43]
    ds_read_b128 a[88:91], v237 offset:43008
    v_mfma_f32_16x16x32_bf16 v[44:47], v[128:131], a[76:79], v[44:47]
    s_waitcnt lgkmcnt(13)
    ds_read_b128 a[92:95], v237 offset:44032
    v_mfma_f32_16x16x32_bf16 v[48:51], v[132:135], a[64:67], v[48:51]
    ds_read_b64_tr_b16 v[156:157], v225 offset:12288
    buffer_load_dwordx4 v9, s[40:43], s38 offen offset:1024 sc1 lds
    v_mfma_f32_16x16x32_bf16 v[52:55], v[132:135], a[68:71], v[52:55]
    ds_read_b64_tr_b16 v[158:159], v225 offset:18432
    s_add_u32 s38, s38, s36
    v_mfma_f32_16x16x32_bf16 v[56:59], v[132:135], a[72:75], v[56:59]
    ds_read_b64_tr_b16 v[160:161], v226 offset:12288
    s_add_u32 m0, s35, 61440
    v_mfma_f32_16x16x32_bf16 v[60:63], v[132:135], a[76:79], v[60:63]
    s_waitcnt lgkmcnt(15)
    ds_read_b64_tr_b16 v[162:163], v226 offset:18432
    v_mfma_f32_16x16x32_bf16 v[64:67], v[136:139], a[64:67], v[64:67]
    buffer_load_dwordx4 v220, s[8:11], s37 offen offset:0 lds
    v_mfma_f32_16x16x32_bf16 v[68:71], v[136:139], a[68:71], v[68:71]
    v_mfma_f32_16x16x32_bf16 v[72:75], v[136:139], a[72:75], v[72:75]
    ds_read_b64_tr_b16 v[164:165], v227 offset:12288
    v_mfma_f32_16x16x32_bf16 v[76:79], v[136:139], a[76:79], v[76:79]
    s_waitcnt lgkmcnt(15)
    ds_read_b64_tr_b16 v[166:167], v227 offset:18432
    v_mfma_f32_16x16x32_bf16 v[80:83], v[140:143], a[64:67], v[80:83]
    buffer_load_dwordx4 v221, s[8:11], s37 offen offset:1024 lds
    v_mfma_f32_16x16x32_bf16 v[84:87], v[140:143], a[68:71], v[84:87]
    buffer_load_dwordx4 v222, s[8:11], s37 offen offset:2048 lds
    v_mfma_f32_16x16x32_bf16 v[88:91], v[140:143], a[72:75], v[88:91]
    ds_read_b64_tr_b16 v[168:169], v224 offset:12416
    s_add_u32 s37, s37, s39
    v_mfma_f32_16x16x32_bf16 v[92:95], v[140:143], a[76:79], v[92:95]
    s_waitcnt lgkmcnt(15)
    ds_read_b64_tr_b16 v[170:171], v224 offset:18560
    v_mfma_f32_16x16x32_bf16 v[96:99], v[144:147], a[64:67], v[96:99]
    v_mfma_f32_16x16x32_bf16 v[100:103], v[144:147], a[68:71], v[100:103]
    v_mfma_f32_16x16x32_bf16 v[104:107], v[144:147], a[72:75], v[104:107]
    ds_read_b64_tr_b16 v[172:173], v225 offset:12416
    v_mfma_f32_16x16x32_bf16 v[108:111], v[144:147], a[76:79], v[108:111]
    s_waitcnt lgkmcnt(15)
    ds_read_b64_tr_b16 v[174:175], v225 offset:18560
    v_mfma_f32_16x16x32_bf16 v[112:115], v[148:151], a[64:67], v[112:115]
    v_mfma_f32_16x16x32_bf16 v[116:119], v[148:151], a[68:71], v[116:119]
    v_mfma_f32_16x16x32_bf16 v[120:123], v[148:151], a[72:75], v[120:123]
    v_mfma_f32_16x16x32_bf16 v[124:127], v[148:151], a[76:79], v[124:127]
    s_waitcnt lgkmcnt(10)
    v_mfma_f32_16x16x32_bf16 v[32:35], v[152:155], a[80:83], v[32:35]
    s_add_u32 m0, s34, 49152
    v_mfma_f32_16x16x32_bf16 v[36:39], v[152:155], a[84:87], v[36:39]
    buffer_load_dwordx4 v8, s[40:43], s38 offen offset:0 sc1 lds
    v_mfma_f32_16x16x32_bf16 v[40:43], v[152:155], a[88:91], v[40:43]
    s_waitcnt vmcnt(11)
    s_barrier
    v_mfma_f32_16x16x32_bf16 v[44:47], v[152:155], a[92:95], v[44:47]
    s_waitcnt lgkmcnt(8)
    ds_read_b128 a[64:67], v237 offset:49152
    v_mfma_f32_16x16x32_bf16 v[48:51], v[156:159], a[80:83], v[48:51]
    ds_read_b64_tr_b16 v[128:129], v224 offset:24576
    buffer_load_dwordx4 v9, s[40:43], s38 offen offset:1024 sc1 lds
    v_mfma_f32_16x16x32_bf16 v[52:55], v[156:159], a[84:87], v[52:55]
    ds_read_b64_tr_b16 v[130:131], v224 offset:30720
    s_add_u32 s38, s38, s36
    v_mfma_f32_16x16x32_bf16 v[56:59], v[156:159], a[88:91], v[56:59]
    ds_read_b128 a[68:71], v237 offset:50176
    v_mfma_f32_16x16x32_bf16 v[60:63], v[156:159], a[92:95], v[60:63]
    s_waitcnt lgkmcnt(10)
    ds_read_b128 a[72:75], v237 offset:51200
    v_mfma_f32_16x16x32_bf16 v[64:67], v[160:163], a[80:83], v[64:67]
    ds_read_b128 a[76:79], v237 offset:52224
    v_mfma_f32_16x16x32_bf16 v[68:71], v[160:163], a[84:87], v[68:71]
    ds_read_b64_tr_b16 v[132:133], v225 offset:24576
    v_mfma_f32_16x16x32_bf16 v[72:75], v[160:163], a[88:91], v[72:75]
    ds_read_b64_tr_b16 v[134:135], v225 offset:30720
    v_mfma_f32_16x16x32_bf16 v[76:79], v[160:163], a[92:95], v[76:79]
    s_waitcnt lgkmcnt(12)
    ds_read_b64_tr_b16 v[136:137], v226 offset:24576
    v_mfma_f32_16x16x32_bf16 v[80:83], v[164:167], a[80:83], v[80:83]
    ds_read_b64_tr_b16 v[138:139], v226 offset:30720
    s_add_u32 m0, s35, 73728
    v_mfma_f32_16x16x32_bf16 v[84:87], v[164:167], a[84:87], v[84:87]
    ds_read_b64_tr_b16 v[140:141], v227 offset:24576
    v_mfma_f32_16x16x32_bf16 v[88:91], v[164:167], a[88:91], v[88:91]
    ds_read_b64_tr_b16 v[142:143], v227 offset:30720
    v_mfma_f32_16x16x32_bf16 v[92:95], v[164:167], a[92:95], v[92:95]
    s_waitcnt lgkmcnt(14)
    ds_read_b64_tr_b16 v[144:145], v224 offset:24704
    v_mfma_f32_16x16x32_bf16 v[96:99], v[168:171], a[80:83], v[96:99]
    ds_read_b64_tr_b16 v[146:147], v224 offset:30848
    v_mfma_f32_16x16x32_bf16 v[100:103], v[168:171], a[84:87], v[100:103]
    buffer_load_dwordx4 v220, s[8:11], s37 offen offset:0 lds
    v_mfma_f32_16x16x32_bf16 v[104:107], v[168:171], a[88:91], v[104:107]
    ds_read_b64_tr_b16 v[148:149], v225 offset:24704
    v_mfma_f32_16x16x32_bf16 v[108:111], v[168:171], a[92:95], v[108:111]
    s_waitcnt lgkmcnt(15)
    ds_read_b64_tr_b16 v[150:151], v225 offset:30848
    v_mfma_f32_16x16x32_bf16 v[112:115], v[172:175], a[80:83], v[112:115]
    buffer_load_dwordx4 v221, s[8:11], s37 offen offset:1024 lds
    v_mfma_f32_16x16x32_bf16 v[116:119], v[172:175], a[84:87], v[116:119]
    buffer_load_dwordx4 v222, s[8:11], s37 offen offset:2048 lds
    s_add_u32 s37, s37, s39
    v_mfma_f32_16x16x32_bf16 v[120:123], v[172:175], a[88:91], v[120:123]
    ds_read_b128 a[80:83], v237 offset:57344
    v_mfma_f32_16x16x32_bf16 v[124:127], v[172:175], a[92:95], v[124:127]
    s_waitcnt lgkmcnt(11)
    ds_read_b64_tr_b16 v[152:153], v224 offset:36864
    v_mfma_f32_16x16x32_bf16 v[32:35], v[128:131], a[64:67], v[32:35]
    ds_read_b64_tr_b16 v[154:155], v224 offset:43008
    s_add_u32 m0, s34, 57344
    v_mfma_f32_16x16x32_bf16 v[36:39], v[128:131], a[68:71], v[36:39]
    ds_read_b128 a[84:87], v237 offset:58368
    buffer_load_dwordx4 v8, s[40:43], s38 offen offset:0 sc1 lds
    v_mfma_f32_16x16x32_bf16 v[40:43], v[128:131], a[72:75], v[40:43]
    ds_read_b128 a[88:91], v237 offset:59392
    v_mfma_f32_16x16x32_bf16 v[44:47], v[128:131], a[76:79], v[44:47]
    s_waitcnt lgkmcnt(13)
    ds_read_b128 a[92:95], v237 offset:60416
    v_mfma_f32_16x16x32_bf16 v[48:51], v[132:135], a[64:67], v[48:51]
    ds_read_b64_tr_b16 v[156:157], v225 offset:36864
    buffer_load_dwordx4 v9, s[40:43], s38 offen offset:1024 sc1 lds
    v_mfma_f32_16x16x32_bf16 v[52:55], v[132:135], a[68:71], v[52:55]
    ds_read_b64_tr_b16 v[158:159], v225 offset:43008
    s_add_u32 s38, s38, s36
    v_mfma_f32_16x16x32_bf16 v[56:59], v[132:135], a[72:75], v[56:59]
    ds_read_b64_tr_b16 v[160:161], v226 offset:36864
    v_mfma_f32_16x16x32_bf16 v[60:63], v[132:135], a[76:79], v[60:63]
    s_waitcnt lgkmcnt(15)
    ds_read_b64_tr_b16 v[162:163], v226 offset:43008
    v_mfma_f32_16x16x32_bf16 v[64:67], v[136:139], a[64:67], v[64:67]
    v_mfma_f32_16x16x32_bf16 v[68:71], v[136:139], a[68:71], v[68:71]
    v_mfma_f32_16x16x32_bf16 v[72:75], v[136:139], a[72:75], v[72:75]
    ds_read_b64_tr_b16 v[164:165], v227 offset:36864
    v_mfma_f32_16x16x32_bf16 v[76:79], v[136:139], a[76:79], v[76:79]
    s_waitcnt lgkmcnt(15)
    ds_read_b64_tr_b16 v[166:167], v227 offset:43008
    v_mfma_f32_16x16x32_bf16 v[80:83], v[140:143], a[64:67], v[80:83]
    v_mfma_f32_16x16x32_bf16 v[84:87], v[140:143], a[68:71], v[84:87]
    v_mfma_f32_16x16x32_bf16 v[88:91], v[140:143], a[72:75], v[88:91]
    ds_read_b64_tr_b16 v[168:169], v224 offset:36992
    v_mfma_f32_16x16x32_bf16 v[92:95], v[140:143], a[76:79], v[92:95]
    s_waitcnt lgkmcnt(15)
    ds_read_b64_tr_b16 v[170:171], v224 offset:43136
    v_mfma_f32_16x16x32_bf16 v[96:99], v[144:147], a[64:67], v[96:99]
    v_mfma_f32_16x16x32_bf16 v[100:103], v[144:147], a[68:71], v[100:103]
    v_mfma_f32_16x16x32_bf16 v[104:107], v[144:147], a[72:75], v[104:107]
    ds_read_b64_tr_b16 v[172:173], v225 offset:36992
    s_add_u32 m0, s35, 86016
    v_mfma_f32_16x16x32_bf16 v[108:111], v[144:147], a[76:79], v[108:111]
    s_waitcnt lgkmcnt(15)
    ds_read_b64_tr_b16 v[174:175], v225 offset:43136
    v_mfma_f32_16x16x32_bf16 v[112:115], v[148:151], a[64:67], v[112:115]
    buffer_load_dwordx4 v220, s[8:11], s37 offen offset:0 lds
    v_mfma_f32_16x16x32_bf16 v[116:119], v[148:151], a[68:71], v[116:119]
    v_mfma_f32_16x16x32_bf16 v[120:123], v[148:151], a[72:75], v[120:123]
    buffer_load_dwordx4 v221, s[8:11], s37 offen offset:1024 lds
    v_mfma_f32_16x16x32_bf16 v[124:127], v[148:151], a[76:79], v[124:127]
    s_waitcnt lgkmcnt(10)
    v_mfma_f32_16x16x32_bf16 v[32:35], v[152:155], a[80:83], v[32:35]
    buffer_load_dwordx4 v222, s[8:11], s37 offen offset:2048 lds
    v_mfma_f32_16x16x32_bf16 v[36:39], v[152:155], a[84:87], v[36:39]
    v_mfma_f32_16x16x32_bf16 v[40:43], v[152:155], a[88:91], v[40:43]
    s_waitcnt vmcnt(10)
    s_barrier
    s_add_u32 s37, s37, s39
    v_mfma_f32_16x16x32_bf16 v[44:47], v[152:155], a[92:95], v[44:47]
    s_waitcnt lgkmcnt(8)
    ds_read_b128 a[64:67], v238 offset:0
    v_mfma_f32_16x16x32_bf16 v[48:51], v[156:159], a[80:83], v[48:51]
    ds_read_b64_tr_b16 v[128:129], v224 offset:49152
    s_add_u32 m0, s34, 0
    v_mfma_f32_16x16x32_bf16 v[52:55], v[156:159], a[84:87], v[52:55]
    ds_read_b64_tr_b16 v[130:131], v224 offset:55296
    buffer_load_dwordx4 v8, s[40:43], s38 offen offset:0 sc1 lds
    v_mfma_f32_16x16x32_bf16 v[56:59], v[156:159], a[88:91], v[56:59]
    ds_read_b128 a[68:71], v238 offset:1024
    buffer_load_dwordx4 v9, s[40:43], s38 offen offset:1024 sc1 lds
    v_mfma_f32_16x16x32_bf16 v[60:63], v[156:159], a[92:95], v[60:63]
    s_waitcnt lgkmcnt(10)
    ds_read_b128 a[72:75], v238 offset:2048
    v_mfma_f32_16x16x32_bf16 v[64:67], v[160:163], a[80:83], v[64:67]
    ds_read_b128 a[76:79], v238 offset:3072
    s_add_u32 s38, s38, s36
    v_mfma_f32_16x16x32_bf16 v[68:71], v[160:163], a[84:87], v[68:71]
    ds_read_b64_tr_b16 v[132:133], v225 offset:49152
    v_mfma_f32_16x16x32_bf16 v[72:75], v[160:163], a[88:91], v[72:75]
    ds_read_b64_tr_b16 v[134:135], v225 offset:55296
    v_mfma_f32_16x16x32_bf16 v[76:79], v[160:163], a[92:95], v[76:79]
    s_waitcnt lgkmcnt(12)
    ds_read_b64_tr_b16 v[136:137], v226 offset:49152
    v_mfma_f32_16x16x32_bf16 v[80:83], v[164:167], a[80:83], v[80:83]
    ds_read_b64_tr_b16 v[138:139], v226 offset:55296
    v_mfma_f32_16x16x32_bf16 v[84:87], v[164:167], a[84:87], v[84:87]
    ds_read_b64_tr_b16 v[140:141], v227 offset:49152
    v_mfma_f32_16x16x32_bf16 v[88:91], v[164:167], a[88:91], v[88:91]
    ds_read_b64_tr_b16 v[142:143], v227 offset:55296
    v_mfma_f32_16x16x32_bf16 v[92:95], v[164:167], a[92:95], v[92:95]
    s_waitcnt lgkmcnt(14)
    ds_read_b64_tr_b16 v[144:145], v224 offset:49280
    v_mfma_f32_16x16x32_bf16 v[96:99], v[168:171], a[80:83], v[96:99]
    ds_read_b64_tr_b16 v[146:147], v224 offset:55424
    v_mfma_f32_16x16x32_bf16 v[100:103], v[168:171], a[84:87], v[100:103]
    v_mfma_f32_16x16x32_bf16 v[104:107], v[168:171], a[88:91], v[104:107]
    ds_read_b64_tr_b16 v[148:149], v225 offset:49280
    v_mfma_f32_16x16x32_bf16 v[108:111], v[168:171], a[92:95], v[108:111]
    s_waitcnt lgkmcnt(15)
    ds_read_b64_tr_b16 v[150:151], v225 offset:55424
    v_mfma_f32_16x16x32_bf16 v[112:115], v[172:175], a[80:83], v[112:115]
    v_mfma_f32_16x16x32_bf16 v[116:119], v[172:175], a[84:87], v[116:119]
    v_mfma_f32_16x16x32_bf16 v[120:123], v[172:175], a[88:91], v[120:123]
    ds_read_b128 a[80:83], v238 offset:8192
    v_mfma_f32_16x16x32_bf16 v[124:127], v[172:175], a[92:95], v[124:127]
    s_waitcnt lgkmcnt(11)
    ds_read_b64_tr_b16 v[152:153], v224 offset:61440
    v_mfma_f32_16x16x32_bf16 v[32:35], v[128:131], a[64:67], v[32:35]
    ds_read_b64_tr_b16 v[154:155], v228 offset:2048
    s_add_u32 m0, s35, 0
    v_mfma_f32_16x16x32_bf16 v[36:39], v[128:131], a[68:71], v[36:39]
    ds_read_b128 a[84:87], v238 offset:9216
    v_mfma_f32_16x16x32_bf16 v[40:43], v[128:131], a[72:75], v[40:43]
    ds_read_b128 a[88:91], v238 offset:10240
    v_mfma_f32_16x16x32_bf16 v[44:47], v[128:131], a[76:79], v[44:47]
    s_waitcnt lgkmcnt(13)
    ds_read_b128 a[92:95], v238 offset:11264
    v_mfma_f32_16x16x32_bf16 v[48:51], v[132:135], a[64:67], v[48:51]
    ds_read_b64_tr_b16 v[156:157], v225 offset:61440
    v_mfma_f32_16x16x32_bf16 v[52:55], v[132:135], a[68:71], v[52:55]
    ds_read_b64_tr_b16 v[158:159], v229 offset:2048
    v_mfma_f32_16x16x32_bf16 v[56:59], v[132:135], a[72:75], v[56:59]
    ds_read_b64_tr_b16 v[160:161], v226 offset:61440
    v_mfma_f32_16x16x32_bf16 v[60:63], v[132:135], a[76:79], v[60:63]
    s_waitcnt lgkmcnt(15)
    ds_read_b64_tr_b16 v[162:163], v230 offset:2048
    v_mfma_f32_16x16x32_bf16 v[64:67], v[136:139], a[64:67], v[64:67]
    buffer_load_dwordx4 v220, s[8:11], s37 offen offset:0 lds
    v_mfma_f32_16x16x32_bf16 v[68:71], v[136:139], a[68:71], v[68:71]
    buffer_load_dwordx4 v221, s[8:11], s37 offen offset:1024 lds
    buffer_load_dwordx4 v222, s[8:11], s37 offen offset:2048 lds
    s_add_u32 s37, s37, s39
    v_mfma_f32_16x16x32_bf16 v[72:75], v[136:139], a[72:75], v[72:75]
    ds_read_b64_tr_b16 v[164:165], v227 offset:61440
    s_add_u32 m0, s34, 8192
    v_mfma_f32_16x16x32_bf16 v[76:79], v[136:139], a[76:79], v[76:79]
    s_waitcnt lgkmcnt(15)
    ds_read_b64_tr_b16 v[166:167], v231 offset:2048
    v_mfma_f32_16x16x32_bf16 v[80:83], v[140:143], a[64:67], v[80:83]
    buffer_load_dwordx4 v8, s[40:43], s38 offen offset:0 sc1 lds
    v_mfma_f32_16x16x32_bf16 v[84:87], v[140:143], a[68:71], v[84:87]
    buffer_load_dwordx4 v9, s[40:43], s38 offen offset:1024 sc1 lds
    v_mfma_f32_16x16x32_bf16 v[88:91], v[140:143], a[72:75], v[88:91]
    ds_read_b64_tr_b16 v[168:169], v224 offset:61568
    s_add_u32 s38, s38, s36
    v_mfma_f32_16x16x32_bf16 v[92:95], v[140:143], a[76:79], v[92:95]
    s_waitcnt lgkmcnt(15)
    ds_read_b64_tr_b16 v[170:171], v228 offset:2176
    v_mfma_f32_16x16x32_bf16 v[96:99], v[144:147], a[64:67], v[96:99]
    s_add_u32 m0, s34, 16384
    v_mfma_f32_16x16x32_bf16 v[100:103], v[144:147], a[68:71], v[100:103]
    buffer_load_dwordx4 v8, s[40:43], s38 offen offset:0 sc1 lds
    v_mfma_f32_16x16x32_bf16 v[104:107], v[144:147], a[72:75], v[104:107]
    ds_read_b64_tr_b16 v[172:173], v225 offset:61568
    v_mfma_f32_16x16x32_bf16 v[108:111], v[144:147], a[76:79], v[108:111]
    s_waitcnt lgkmcnt(15)
    ds_read_b64_tr_b16 v[174:175], v229 offset:2176
    v_mfma_f32_16x16x32_bf16 v[112:115], v[148:151], a[64:67], v[112:115]
    buffer_load_dwordx4 v9, s[40:43], s38 offen offset:1024 sc1 lds
    s_add_u32 s38, s38, s36
    v_mfma_f32_16x16x32_bf16 v[116:119], v[148:151], a[68:71], v[116:119]
    v_mfma_f32_16x16x32_bf16 v[120:123], v[148:151], a[72:75], v[120:123]
    v_mfma_f32_16x16x32_bf16 v[124:127], v[148:151], a[76:79], v[124:127]
    s_waitcnt lgkmcnt(10)
    v_mfma_f32_16x16x32_bf16 v[32:35], v[152:155], a[80:83], v[32:35]
    v_mfma_f32_16x16x32_bf16 v[36:39], v[152:155], a[84:87], v[36:39]
    v_mfma_f32_16x16x32_bf16 v[40:43], v[152:155], a[88:91], v[40:43]
    s_waitcnt vmcnt(9)
    s_barrier
    v_mfma_f32_16x16x32_bf16 v[44:47], v[152:155], a[92:95], v[44:47]
    s_waitcnt lgkmcnt(8)
    ds_read_b128 a[64:67], v238 offset:16384
    v_mfma_f32_16x16x32_bf16 v[48:51], v[156:159], a[80:83], v[48:51]
    ds_read_b64_tr_b16 v[128:129], v228 offset:8192
    s_add_u32 m0, s34, 24576
    v_mfma_f32_16x16x32_bf16 v[52:55], v[156:159], a[84:87], v[52:55]
    ds_read_b64_tr_b16 v[130:131], v228 offset:14336
    buffer_load_dwordx4 v8, s[40:43], s38 offen offset:0 sc1 lds
    v_mfma_f32_16x16x32_bf16 v[56:59], v[156:159], a[88:91], v[56:59]
    ds_read_b128 a[68:71], v238 offset:17408
    buffer_load_dwordx4 v9, s[40:43], s38 offen offset:1024 sc1 lds
    v_mfma_f32_16x16x32_bf16 v[60:63], v[156:159], a[92:95], v[60:63]
    s_waitcnt lgkmcnt(10)
    ds_read_b128 a[72:75], v238 offset:18432
    v_mfma_f32_16x16x32_bf16 v[64:67], v[160:163], a[80:83], v[64:67]
    ds_read_b128 a[76:79], v238 offset:19456
    s_add_u32 s38, s38, s36
    v_mfma_f32_16x16x32_bf16 v[68:71], v[160:163], a[84:87], v[68:71]
    ds_read_b64_tr_b16 v[132:133], v229 offset:8192
    s_cmp_eq_u32 s24, 4
    s_cselect_b32 s38, 0x40000000, s38
    v_mfma_f32_16x16x32_bf16 v[72:75], v[160:163], a[88:91], v[72:75]
    ds_read_b64_tr_b16 v[134:135], v229 offset:14336
    s_add_u32 m0, s34, 32768
    v_mfma_f32_16x16x32_bf16 v[76:79], v[160:163], a[92:95], v[76:79]
    s_waitcnt lgkmcnt(12)
    ds_read_b64_tr_b16 v[136:137], v230 offset:8192
    v_mfma_f32_16x16x32_bf16 v[80:83], v[164:167], a[80:83], v[80:83]
    ds_read_b64_tr_b16 v[138:139], v230 offset:14336
    buffer_load_dwordx4 v8, s[40:43], s38 offen offset:0 sc1 lds
    v_mfma_f32_16x16x32_bf16 v[84:87], v[164:167], a[84:87], v[84:87]
    ds_read_b64_tr_b16 v[140:141], v231 offset:8192
    buffer_load_dwordx4 v9, s[40:43], s38 offen offset:1024 sc1 lds
    v_mfma_f32_16x16x32_bf16 v[88:91], v[164:167], a[88:91], v[88:91]
    ds_read_b64_tr_b16 v[142:143], v231 offset:14336
    s_add_u32 s38, s38, s36
    v_mfma_f32_16x16x32_bf16 v[92:95], v[164:167], a[92:95], v[92:95]
    s_waitcnt lgkmcnt(14)
    ds_read_b64_tr_b16 v[144:145], v228 offset:8320
    v_mfma_f32_16x16x32_bf16 v[96:99], v[168:171], a[80:83], v[96:99]
    ds_read_b64_tr_b16 v[146:147], v228 offset:14464
    v_mfma_f32_16x16x32_bf16 v[100:103], v[168:171], a[84:87], v[100:103]
    v_mfma_f32_16x16x32_bf16 v[104:107], v[168:171], a[88:91], v[104:107]
    ds_read_b64_tr_b16 v[148:149], v229 offset:8320
    v_mfma_f32_16x16x32_bf16 v[108:111], v[168:171], a[92:95], v[108:111]
    s_waitcnt lgkmcnt(15)
    ds_read_b64_tr_b16 v[150:151], v229 offset:14464
    v_mfma_f32_16x16x32_bf16 v[112:115], v[172:175], a[80:83], v[112:115]
    v_mfma_f32_16x16x32_bf16 v[116:119], v[172:175], a[84:87], v[116:119]
    v_mfma_f32_16x16x32_bf16 v[120:123], v[172:175], a[88:91], v[120:123]
    ds_read_b128 a[80:83], v238 offset:24576
    v_mfma_f32_16x16x32_bf16 v[124:127], v[172:175], a[92:95], v[124:127]
    s_waitcnt lgkmcnt(11)
    ds_read_b64_tr_b16 v[152:153], v228 offset:20480
    v_mfma_f32_16x16x32_bf16 v[32:35], v[128:131], a[64:67], v[32:35]
    ds_read_b64_tr_b16 v[154:155], v228 offset:26624
    v_mfma_f32_16x16x32_bf16 v[36:39], v[128:131], a[68:71], v[36:39]
    ds_read_b128 a[84:87], v238 offset:25600
    v_mfma_f32_16x16x32_bf16 v[40:43], v[128:131], a[72:75], v[40:43]
    ds_read_b128 a[88:91], v238 offset:26624
    v_mfma_f32_16x16x32_bf16 v[44:47], v[128:131], a[76:79], v[44:47]
    s_waitcnt lgkmcnt(13)
    ds_read_b128 a[92:95], v238 offset:27648
    v_mfma_f32_16x16x32_bf16 v[48:51], v[132:135], a[64:67], v[48:51]
    ds_read_b64_tr_b16 v[156:157], v229 offset:20480
    v_mfma_f32_16x16x32_bf16 v[52:55], v[132:135], a[68:71], v[52:55]
    ds_read_b64_tr_b16 v[158:159], v229 offset:26624
    v_mfma_f32_16x16x32_bf16 v[56:59], v[132:135], a[72:75], v[56:59]
    ds_read_b64_tr_b16 v[160:161], v230 offset:20480
    v_mfma_f32_16x16x32_bf16 v[60:63], v[132:135], a[76:79], v[60:63]
    s_waitcnt lgkmcnt(15)
    ds_read_b64_tr_b16 v[162:163], v230 offset:26624
    v_mfma_f32_16x16x32_bf16 v[64:67], v[136:139], a[64:67], v[64:67]
    v_mfma_f32_16x16x32_bf16 v[68:71], v[136:139], a[68:71], v[68:71]
    v_mfma_f32_16x16x32_bf16 v[72:75], v[136:139], a[72:75], v[72:75]
    ds_read_b64_tr_b16 v[164:165], v231 offset:20480
    v_mfma_f32_16x16x32_bf16 v[76:79], v[136:139], a[76:79], v[76:79]
    s_waitcnt lgkmcnt(15)
    ds_read_b64_tr_b16 v[166:167], v231 offset:26624
    v_mfma_f32_16x16x32_bf16 v[80:83], v[140:143], a[64:67], v[80:83]
    v_mfma_f32_16x16x32_bf16 v[84:87], v[140:143], a[68:71], v[84:87]
    v_mfma_f32_16x16x32_bf16 v[88:91], v[140:143], a[72:75], v[88:91]
    ds_read_b64_tr_b16 v[168:169], v228 offset:20608
    v_mfma_f32_16x16x32_bf16 v[92:95], v[140:143], a[76:79], v[92:95]
    s_waitcnt lgkmcnt(15)
    ds_read_b64_tr_b16 v[170:171], v228 offset:26752
    v_mfma_f32_16x16x32_bf16 v[96:99], v[144:147], a[64:67], v[96:99]
    v_mfma_f32_16x16x32_bf16 v[100:103], v[144:147], a[68:71], v[100:103]
    v_mfma_f32_16x16x32_bf16 v[104:107], v[144:147], a[72:75], v[104:107]
    ds_read_b64_tr_b16 v[172:173], v229 offset:20608
    v_mfma_f32_16x16x32_bf16 v[108:111], v[144:147], a[76:79], v[108:111]
    s_waitcnt lgkmcnt(15)
    ds_read_b64_tr_b16 v[174:175], v229 offset:26752
    v_mfma_f32_16x16x32_bf16 v[112:115], v[148:151], a[64:67], v[112:115]
    v_mfma_f32_16x16x32_bf16 v[116:119], v[148:151], a[68:71], v[116:119]
    v_mfma_f32_16x16x32_bf16 v[120:123], v[148:151], a[72:75], v[120:123]
    v_mfma_f32_16x16x32_bf16 v[124:127], v[148:151], a[76:79], v[124:127]
    s_waitcnt lgkmcnt(10)
    v_mfma_f32_16x16x32_bf16 v[32:35], v[152:155], a[80:83], v[32:35]
    v_mfma_f32_16x16x32_bf16 v[36:39], v[152:155], a[84:87], v[36:39]
    v_mfma_f32_16x16x32_bf16 v[40:43], v[152:155], a[88:91], v[40:43]
    s_waitcnt vmcnt(8)
    s_barrier
    v_mfma_f32_16x16x32_bf16 v[44:47], v[152:155], a[92:95], v[44:47]
    s_waitcnt lgkmcnt(8)
    ds_read_b128 a[64:67], v237 offset:32768
    v_mfma_f32_16x16x32_bf16 v[48:51], v[156:159], a[80:83], v[48:51]
    ds_read_b64_tr_b16 v[128:129], v224 offset:0
    v_mfma_f32_16x16x32_bf16 v[52:55], v[156:159], a[84:87], v[52:55]
    ds_read_b64_tr_b16 v[130:131], v224 offset:6144
    v_mfma_f32_16x16x32_bf16 v[56:59], v[156:159], a[88:91], v[56:59]
    ds_read_b128 a[68:71], v237 offset:33792
    v_mfma_f32_16x16x32_bf16 v[60:63], v[156:159], a[92:95], v[60:63]
    s_waitcnt lgkmcnt(10)
    ds_read_b128 a[72:75], v237 offset:34816
    v_mfma_f32_16x16x32_bf16 v[64:67], v[160:163], a[80:83], v[64:67]
    ds_read_b128 a[76:79], v237 offset:35840
    v_mfma_f32_16x16x32_bf16 v[68:71], v[160:163], a[84:87], v[68:71]
    ds_read_b64_tr_b16 v[132:133], v225 offset:0
    v_mfma_f32_16x16x32_bf16 v[72:75], v[160:163], a[88:91], v[72:75]
    ds_read_b64_tr_b16 v[134:135], v225 offset:6144
    v_mfma_f32_16x16x32_bf16 v[76:79], v[160:163], a[92:95], v[76:79]
    s_waitcnt lgkmcnt(12)
    ds_read_b64_tr_b16 v[136:137], v226 offset:0
    v_mfma_f32_16x16x32_bf16 v[80:83], v[164:167], a[80:83], v[80:83]
    ds_read_b64_tr_b16 v[138:139], v226 offset:6144
    v_mfma_f32_16x16x32_bf16 v[84:87], v[164:167], a[84:87], v[84:87]
    ds_read_b64_tr_b16 v[140:141], v227 offset:0
    v_mfma_f32_16x16x32_bf16 v[88:91], v[164:167], a[88:91], v[88:91]
    ds_read_b64_tr_b16 v[142:143], v227 offset:6144
    v_mfma_f32_16x16x32_bf16 v[92:95], v[164:167], a[92:95], v[92:95]
    s_waitcnt lgkmcnt(14)
    ds_read_b64_tr_b16 v[144:145], v224 offset:128
    v_mfma_f32_16x16x32_bf16 v[96:99], v[168:171], a[80:83], v[96:99]
    ds_read_b64_tr_b16 v[146:147], v224 offset:6272
    v_mfma_f32_16x16x32_bf16 v[100:103], v[168:171], a[84:87], v[100:103]
    v_mfma_f32_16x16x32_bf16 v[104:107], v[168:171], a[88:91], v[104:107]
    ds_read_b64_tr_b16 v[148:149], v225 offset:128
    v_mfma_f32_16x16x32_bf16 v[108:111], v[168:171], a[92:95], v[108:111]
    s_waitcnt lgkmcnt(15)
    ds_read_b64_tr_b16 v[150:151], v225 offset:6272
    v_mfma_f32_16x16x32_bf16 v[112:115], v[172:175], a[80:83], v[112:115]
    v_mfma_f32_16x16x32_bf16 v[116:119], v[172:175], a[84:87], v[116:119]
    v_mfma_f32_16x16x32_bf16 v[120:123], v[172:175], a[88:91], v[120:123]
    v_mfma_f32_16x16x32_bf16 v[124:127], v[172:175], a[92:95], v[124:127]
    s_waitcnt lgkmcnt(10)
    v_mfma_f32_16x16x32_bf16 v[32:35], v[128:131], a[64:67], v[32:35]
    v_mfma_f32_16x16x32_bf16 v[36:39], v[128:131], a[68:71], v[36:39]
    v_mfma_f32_16x16x32_bf16 v[40:43], v[128:131], a[72:75], v[40:43]
    s_waitcnt vmcnt(0)
    s_barrier
    v_mfma_f32_16x16x32_bf16 v[44:47], v[128:131], a[76:79], v[44:47]
    s_waitcnt lgkmcnt(8)
    ds_read_b128 a[0:3], v237 offset:40960
    v_mfma_f32_16x16x32_bf16 v[48:51], v[132:135], a[64:67], v[48:51]
    ds_read_b128 a[4:7], v237 offset:41984
    v_mfma_f32_16x16x32_bf16 v[52:55], v[132:135], a[68:71], v[52:55]
    ds_read_b128 a[8:11], v237 offset:43008
    v_mfma_f32_16x16x32_bf16 v[56:59], v[132:135], a[72:75], v[56:59]
    ds_read_b128 a[12:15], v237 offset:44032
    v_mfma_f32_16x16x32_bf16 v[60:63], v[132:135], a[76:79], v[60:63]
    s_waitcnt lgkmcnt(10)
    ds_read_b128 a[16:19], v237 offset:49152
    v_mfma_f32_16x16x32_bf16 v[64:67], v[136:139], a[64:67], v[64:67]
    ds_read_b128 a[20:23], v237 offset:50176
    v_mfma_f32_16x16x32_bf16 v[68:71], v[136:139], a[68:71], v[68:71]
    ds_read_b128 a[24:27], v237 offset:51200
    v_mfma_f32_16x16x32_bf16 v[72:75], v[136:139], a[72:75], v[72:75]
    ds_read_b128 a[28:31], v237 offset:52224
    v_mfma_f32_16x16x32_bf16 v[76:79], v[136:139], a[76:79], v[76:79]
    s_waitcnt lgkmcnt(12)
    ds_read_b128 a[32:35], v237 offset:57344
    v_mfma_f32_16x16x32_bf16 v[80:83], v[140:143], a[64:67], v[80:83]
    ds_read_b128 a[36:39], v237 offset:58368
    v_mfma_f32_16x16x32_bf16 v[84:87], v[140:143], a[68:71], v[84:87]
    ds_read_b128 a[40:43], v237 offset:59392
    v_mfma_f32_16x16x32_bf16 v[88:91], v[140:143], a[72:75], v[88:91]
    ds_read_b128 a[44:47], v237 offset:60416
    v_mfma_f32_16x16x32_bf16 v[92:95], v[140:143], a[76:79], v[92:95]
    s_waitcnt lgkmcnt(14)
    ds_read_b128 a[48:51], v238 offset:0
    v_mfma_f32_16x16x32_bf16 v[96:99], v[144:147], a[64:67], v[96:99]
    ds_read_b128 a[52:55], v238 offset:1024
    v_mfma_f32_16x16x32_bf16 v[100:103], v[144:147], a[68:71], v[100:103]
    ds_read_b128 a[56:59], v238 offset:2048
    v_mfma_f32_16x16x32_bf16 v[104:107], v[144:147], a[72:75], v[104:107]
    ds_read_b128 a[60:63], v238 offset:3072
    v_mfma_f32_16x16x32_bf16 v[108:111], v[144:147], a[76:79], v[108:111]
    s_waitcnt lgkmcnt(15)
    v_mfma_f32_16x16x32_bf16 v[112:115], v[148:151], a[64:67], v[112:115]
    v_mfma_f32_16x16x32_bf16 v[116:119], v[148:151], a[68:71], v[116:119]
    v_mfma_f32_16x16x32_bf16 v[120:123], v[148:151], a[72:75], v[120:123]
    v_mfma_f32_16x16x32_bf16 v[124:127], v[148:151], a[76:79], v[124:127]
    s_waitcnt lgkmcnt(12)
    v_mfma_f32_16x16x32_bf16 v[32:35], a[96:99], a[0:3], v[32:35]
    v_mfma_f32_16x16x32_bf16 v[36:39], a[96:99], a[4:7], v[36:39]
    v_mfma_f32_16x16x32_bf16 v[40:43], a[96:99], a[8:11], v[40:43]
    v_mfma_f32_16x16x32_bf16 v[44:47], a[96:99], a[12:15], v[44:47]
    s_waitcnt lgkmcnt(8)
    v_mfma_f32_16x16x32_bf16 v[32:35], a[120:123], a[16:19], v[32:35]
    v_mfma_f32_16x16x32_bf16 v[36:39], a[120:123], a[20:23], v[36:39]
    v_mfma_f32_16x16x32_bf16 v[40:43], a[120:123], a[24:27], v[40:43]
    v_mfma_f32_16x16x32_bf16 v[44:47], a[120:123], a[28:31], v[44:47]
    s_waitcnt lgkmcnt(4)
    v_mfma_f32_16x16x32_bf16 v[32:35], a[144:147], a[32:35], v[32:35]
    v_mfma_f32_16x16x32_bf16 v[36:39], a[144:147], a[36:39], v[36:39]
    v_mfma_f32_16x16x32_bf16 v[40:43], a[144:147], a[40:43], v[40:43]
    v_mfma_f32_16x16x32_bf16 v[44:47], a[144:147], a[44:47], v[44:47]
    s_waitcnt lgkmcnt(0)
    v_mfma_f32_16x16x32_bf16 v[32:35], a[168:171], a[48:51], v[32:35]
    v_mfma_f32_16x16x32_bf16 v[36:39], a[168:171], a[52:55], v[36:39]
    v_mfma_f32_16x16x32_bf16 v[40:43], a[168:171], a[56:59], v[40:43]
    v_mfma_f32_16x16x32_bf16 v[44:47], a[168:171], a[60:63], v[44:47]
    v_mfma_f32_16x16x32_bf16 v[48:51], a[100:103], a[0:3], v[48:51]
    v_mfma_f32_16x16x32_bf16 v[52:55], a[100:103], a[4:7], v[52:55]
    v_mfma_f32_16x16x32_bf16 v[56:59], a[100:103], a[8:11], v[56:59]
    v_mfma_f32_16x16x32_bf16 v[60:63], a[100:103], a[12:15], v[60:63]
    v_mfma_f32_16x16x32_bf16 v[48:51], a[124:127], a[16:19], v[48:51]
    v_mfma_f32_16x16x32_bf16 v[52:55], a[124:127], a[20:23], v[52:55]
    v_cvt_pk_bf16_f32 v32, v32, v33
    v_mfma_f32_16x16x32_bf16 v[56:59], a[124:127], a[24:27], v[56:59]
    v_cvt_pk_bf16_f32 v33, v34, v35
    v_mfma_f32_16x16x32_bf16 v[60:63], a[124:127], a[28:31], v[60:63]
    v_cvt_pk_bf16_f32 v34, v36, v37
    v_mfma_f32_16x16x32_bf16 v[48:51], a[148:151], a[32:35], v[48:51]
    v_cvt_pk_bf16_f32 v35, v38, v39
    v_mfma_f32_16x16x32_bf16 v[52:55], a[148:151], a[36:39], v[52:55]
    v_permlane16_swap_b32 v32, v34
    v_mfma_f32_16x16x32_bf16 v[56:59], a[148:151], a[40:43], v[56:59]
    v_permlane16_swap_b32 v33, v35
    v_mfma_f32_16x16x32_bf16 v[60:63], a[148:151], a[44:47], v[60:63]
    buffer_store_dwordx4 v[32:35], v10, s[16:19], s20 offen offset:0 sc1
    v_mfma_f32_16x16x32_bf16 v[48:51], a[172:175], a[48:51], v[48:51]
    v_cvt_pk_bf16_f32 v40, v40, v41
    v_mfma_f32_16x16x32_bf16 v[52:55], a[172:175], a[52:55], v[52:55]
    v_cvt_pk_bf16_f32 v41, v42, v43
    v_mfma_f32_16x16x32_bf16 v[56:59], a[172:175], a[56:59], v[56:59]
    v_cvt_pk_bf16_f32 v42, v44, v45
    v_mfma_f32_16x16x32_bf16 v[60:63], a[172:175], a[60:63], v[60:63]
    v_cvt_pk_bf16_f32 v43, v46, v47
    v_mfma_f32_16x16x32_bf16 v[64:67], a[104:107], a[0:3], v[64:67]
    v_permlane16_swap_b32 v40, v42
    v_mfma_f32_16x16x32_bf16 v[68:71], a[104:107], a[4:7], v[68:71]
    v_permlane16_swap_b32 v41, v43
    v_mfma_f32_16x16x32_bf16 v[72:75], a[104:107], a[8:11], v[72:75]
    buffer_store_dwordx4 v[40:43], v10, s[16:19], s22 offen offset:0 sc1
    v_mfma_f32_16x16x32_bf16 v[76:79], a[104:107], a[12:15], v[76:79]
    v_mfma_f32_16x16x32_bf16 v[64:67], a[128:131], a[16:19], v[64:67]
    v_mfma_f32_16x16x32_bf16 v[68:71], a[128:131], a[20:23], v[68:71]
    v_cvt_pk_bf16_f32 v48, v48, v49
    v_mfma_f32_16x16x32_bf16 v[72:75], a[128:131], a[24:27], v[72:75]
    v_cvt_pk_bf16_f32 v49, v50, v51
    v_mfma_f32_16x16x32_bf16 v[76:79], a[128:131], a[28:31], v[76:79]
    v_cvt_pk_bf16_f32 v50, v52, v53
    v_mfma_f32_16x16x32_bf16 v[64:67], a[152:155], a[32:35], v[64:67]
    v_cvt_pk_bf16_f32 v51, v54, v55
    v_mfma_f32_16x16x32_bf16 v[68:71], a[152:155], a[36:39], v[68:71]
    v_permlane16_swap_b32 v48, v50
    v_mfma_f32_16x16x32_bf16 v[72:75], a[152:155], a[40:43], v[72:75]
    v_permlane16_swap_b32 v49, v51
    v_mfma_f32_16x16x32_bf16 v[76:79], a[152:155], a[44:47], v[76:79]
    buffer_store_dwordx4 v[48:51], v10, s[16:19], s20 offen offset:1024 sc1
    v_mfma_f32_16x16x32_bf16 v[64:67], a[176:179], a[48:51], v[64:67]
    v_cvt_pk_bf16_f32 v56, v56, v57
    v_mfma_f32_16x16x32_bf16 v[68:71], a[176:179], a[52:55], v[68:71]
    v_cvt_pk_bf16_f32 v57, v58, v59
    v_mfma_f32_16x16x32_bf16 v[72:75], a[176:179], a[56:59], v[72:75]
    v_cvt_pk_bf16_f32 v58, v60, v61
    v_mfma_f32_16x16x32_bf16 v[76:79], a[176:179], a[60:63], v[76:79]
    v_cvt_pk_bf16_f32 v59, v62, v63
    v_mfma_f32_16x16x32_bf16 v[80:83], a[108:111], a[0:3], v[80:83]
    v_permlane16_swap_b32 v56, v58
    v_mfma_f32_16x16x32_bf16 v[84:87], a[108:111], a[4:7], v[84:87]
    v_permlane16_swap_b32 v57, v59
    v_mfma_f32_16x16x32_bf16 v[88:91], a[108:111], a[8:11], v[88:91]
    buffer_store_dwordx4 v[56:59], v10, s[16:19], s22 offen offset:1024 sc1
    v_mfma_f32_16x16x32_bf16 v[92:95], a[108:111], a[12:15], v[92:95]
    v_mfma_f32_16x16x32_bf16 v[80:83], a[132:135], a[16:19], v[80:83]
    v_mfma_f32_16x16x32_bf16 v[84:87], a[132:135], a[20:23], v[84:87]
    v_cvt_pk_bf16_f32 v64, v64, v65
    v_mfma_f32_16x16x32_bf16 v[88:91], a[132:135], a[24:27], v[88:91]
    v_cvt_pk_bf16_f32 v65, v66, v67
    v_mfma_f32_16x16x32_bf16 v[92:95], a[132:135], a[28:31], v[92:95]
    v_cvt_pk_bf16_f32 v66, v68, v69
    v_mfma_f32_16x16x32_bf16 v[80:83], a[156:159], a[32:35], v[80:83]
    v_cvt_pk_bf16_f32 v67, v70, v71
    v_mfma_f32_16x16x32_bf16 v[84:87], a[156:159], a[36:39], v[84:87]
    v_permlane16_swap_b32 v64, v66
    v_mfma_f32_16x16x32_bf16 v[88:91], a[156:159], a[40:43], v[88:91]
    v_permlane16_swap_b32 v65, v67
    v_mfma_f32_16x16x32_bf16 v[92:95], a[156:159], a[44:47], v[92:95]
    buffer_store_dwordx4 v[64:67], v10, s[16:19], s20 offen offset:2048 sc1
    v_mfma_f32_16x16x32_bf16 v[80:83], a[180:183], a[48:51], v[80:83]
    v_cvt_pk_bf16_f32 v72, v72, v73
    v_mfma_f32_16x16x32_bf16 v[84:87], a[180:183], a[52:55], v[84:87]
    v_cvt_pk_bf16_f32 v73, v74, v75
    v_mfma_f32_16x16x32_bf16 v[88:91], a[180:183], a[56:59], v[88:91]
    v_cvt_pk_bf16_f32 v74, v76, v77
    v_mfma_f32_16x16x32_bf16 v[92:95], a[180:183], a[60:63], v[92:95]
    v_cvt_pk_bf16_f32 v75, v78, v79
    v_mfma_f32_16x16x32_bf16 v[96:99], a[112:115], a[0:3], v[96:99]
    v_permlane16_swap_b32 v72, v74
    v_mfma_f32_16x16x32_bf16 v[100:103], a[112:115], a[4:7], v[100:103]
    v_permlane16_swap_b32 v73, v75
    v_mfma_f32_16x16x32_bf16 v[104:107], a[112:115], a[8:11], v[104:107]
    buffer_store_dwordx4 v[72:75], v10, s[16:19], s22 offen offset:2048 sc1
    v_mfma_f32_16x16x32_bf16 v[108:111], a[112:115], a[12:15], v[108:111]
    v_mfma_f32_16x16x32_bf16 v[96:99], a[136:139], a[16:19], v[96:99]
    v_mfma_f32_16x16x32_bf16 v[100:103], a[136:139], a[20:23], v[100:103]
    v_cvt_pk_bf16_f32 v80, v80, v81
    v_mfma_f32_16x16x32_bf16 v[104:107], a[136:139], a[24:27], v[104:107]
    v_cvt_pk_bf16_f32 v81, v82, v83
    v_mfma_f32_16x16x32_bf16 v[108:111], a[136:139], a[28:31], v[108:111]
    v_cvt_pk_bf16_f32 v82, v84, v85
    v_mfma_f32_16x16x32_bf16 v[96:99], a[160:163], a[32:35], v[96:99]
    v_cvt_pk_bf16_f32 v83, v86, v87
    v_mfma_f32_16x16x32_bf16 v[100:103], a[160:163], a[36:39], v[100:103]
    v_permlane16_swap_b32 v80, v82
    v_mfma_f32_16x16x32_bf16 v[104:107], a[160:163], a[40:43], v[104:107]
    v_permlane16_swap_b32 v81, v83
    v_mfma_f32_16x16x32_bf16 v[108:111], a[160:163], a[44:47], v[108:111]
    buffer_store_dwordx4 v[80:83], v10, s[16:19], s20 offen offset:3072 sc1
    v_mfma_f32_16x16x32_bf16 v[96:99], a[184:187], a[48:51], v[96:99]
    v_cvt_pk_bf16_f32 v88, v88, v89
    v_mfma_f32_16x16x32_bf16 v[100:103], a[184:187], a[52:55], v[100:103]
    v_cvt_pk_bf16_f32 v89, v90, v91
    v_mfma_f32_16x16x32_bf16 v[104:107], a[184:187], a[56:59], v[104:107]
    v_cvt_pk_bf16_f32 v90, v92, v93
    v_mfma_f32_16x16x32_bf16 v[108:111], a[184:187], a[60:63], v[108:111]
    v_cvt_pk_bf16_f32 v91, v94, v95
    v_mfma_f32_16x16x32_bf16 v[112:115], a[116:119], a[0:3], v[112:115]
    v_permlane16_swap_b32 v88, v90
    v_mfma_f32_16x16x32_bf16 v[116:119], a[116:119], a[4:7], v[116:119]
    v_permlane16_swap_b32 v89, v91
    v_mfma_f32_16x16x32_bf16 v[120:123], a[116:119], a[8:11], v[120:123]
    buffer_store_dwordx4 v[88:91], v10, s[16:19], s22 offen offset:3072 sc1
    v_mfma_f32_16x16x32_bf16 v[124:127], a[116:119], a[12:15], v[124:127]
    v_mfma_f32_16x16x32_bf16 v[112:115], a[140:143], a[16:19], v[112:115]
    v_mfma_f32_16x16x32_bf16 v[116:119], a[140:143], a[20:23], v[116:119]
    v_cvt_pk_bf16_f32 v96, v96, v97
    v_mfma_f32_16x16x32_bf16 v[120:123], a[140:143], a[24:27], v[120:123]
    v_cvt_pk_bf16_f32 v97, v98, v99
    v_mfma_f32_16x16x32_bf16 v[124:127], a[140:143], a[28:31], v[124:127]
    v_cvt_pk_bf16_f32 v98, v100, v101
    v_mfma_f32_16x16x32_bf16 v[112:115], a[164:167], a[32:35], v[112:115]
    v_cvt_pk_bf16_f32 v99, v102, v103
    v_mfma_f32_16x16x32_bf16 v[116:119], a[164:167], a[36:39], v[116:119]
    v_permlane16_swap_b32 v96, v98
    v_mfma_f32_16x16x32_bf16 v[120:123], a[164:167], a[40:43], v[120:123]
    v_permlane16_swap_b32 v97, v99
    v_mfma_f32_16x16x32_bf16 v[124:127], a[164:167], a[44:47], v[124:127]
    buffer_store_dwordx4 v[96:99], v10, s[16:19], s21 offen offset:0 sc1
    v_mfma_f32_16x16x32_bf16 v[112:115], a[188:191], a[48:51], v[112:115]
    v_cvt_pk_bf16_f32 v104, v104, v105
    v_mfma_f32_16x16x32_bf16 v[116:119], a[188:191], a[52:55], v[116:119]
    v_cvt_pk_bf16_f32 v105, v106, v107
    v_cvt_pk_bf16_f32 v106, v108, v109
    v_cvt_pk_bf16_f32 v107, v110, v111
    v_mfma_f32_16x16x32_bf16 v[120:123], a[188:191], a[56:59], v[120:123]
    v_permlane16_swap_b32 v104, v106
    v_permlane16_swap_b32 v105, v107
    v_mfma_f32_16x16x32_bf16 v[124:127], a[188:191], a[60:63], v[124:127]
    buffer_store_dwordx4 v[104:107], v10, s[16:19], s23 offen offset:0 sc1
    s_nop 7
    v_cvt_pk_bf16_f32 v112, v112, v113
    v_cvt_pk_bf16_f32 v113, v114, v115
    v_cvt_pk_bf16_f32 v114, v116, v117
    v_cvt_pk_bf16_f32 v115, v118, v119
    s_nop 0
    v_permlane16_swap_b32 v112, v114
    v_permlane16_swap_b32 v113, v115
    buffer_store_dwordx4 v[112:115], v10, s[16:19], s21 offen offset:1024 sc1
    v_cvt_pk_bf16_f32 v120, v120, v121
    v_cvt_pk_bf16_f32 v121, v122, v123
    v_cvt_pk_bf16_f32 v122, v124, v125
    v_cvt_pk_bf16_f32 v123, v126, v127
    s_nop 0
    v_permlane16_swap_b32 v120, v122
    v_permlane16_swap_b32 v121, v123
    buffer_store_dwordx4 v[120:123], v10, s[16:19], s23 offen offset:1024 sc1
    s_waitcnt vmcnt(0)
    s_barrier
    v_mov_b32 v2, s92
    buffer_store_dword v2, v223, s[52:55], s60 offen sc1
fnet_glu_kernel_skip5_23:
    s_load_dwordx2 s[4:5], s[0:1], 72
    s_and_b32 s24, s2, 7
    s_lshr_b32 s25, s2, 3
    s_and_b32 s26, s25, 3
    s_lshr_b32 s25, s25, 2
    s_lshl_b32 s24, s24, 3
    s_add_u32 s24, s24, s25
    v_and_b32 v40, 7, v1
    v_bfe_u32 v45, v1, 3, 1
    v_lshrrev_b32 v42, 4, v1
    s_lshl_b32 s27, s26, 3
    v_add_u32 v40, s27, v40
    s_mul_i32 s27, s3, 9
    v_add_u32 v43, s27, v42
    v_lshl_add_u32 v32, v45, 5, v40
    v_lshlrev_b32 v32, 4, v32
    v_lshl_add_u32 v32, v43, 10, v32
    v_mul_u32_u24 v33, 1152, v40
    v_lshl_add_u32 v33, v43, 5, v33
    v_lshl_add_u32 v33, v45, 4, v33
    v_cmp_gt_u32 vcc, 3, v42
    v_mov_b32 v39, 0x40000000
    s_mul_i32 s28, s24, 36864
    v_cndmask_b32 v32, v39, v32, vcc
    v_cndmask_b32 v33, v39, v33, vcc
    v_and_b32 v4, 1, v1
    v_lshlrev_b32 v4, 3, v4
    s_mul_i32 s30, s3, 9
    v_add_u32 v4, s30, v4
    v_mul_u32_u24 v4, 43, v4
    v_lshrrev_b32 v4, 9, v4
    v_lshrrev_b32 v5, 1, v1
    v_min_u32 v5, 4, v5
    v_mad_u32_u24 v4, v5, 3, v4
    s_lshr_b32 s30, s24, 2
    s_lshl_b32 s30, s30, 4
    v_add_u32 v4, s30, v4
    v_lshlrev_b32 v4, 7, v4
    v_add_u32 v4, 0x10000, v4
    buffer_load_dword v2, v4, s[52:55], 0 offen sc1
    s_waitcnt vmcnt(0) lgkmcnt(0)
    s_mov_b32 s8, s4
    s_and_b32 s9, s5, 0xffff
    s_mov_b32 s10, 0x240000
    s_mov_b32 s11, 0x00020000
    s_mov_b32 s30, 0
fnet_glu_kernel_poll_28:
    v_cmp_eq_u32 vcc, s92, v2
    s_cmp_eq_u64 vcc, -1
    s_cbranch_scc1 fnet_glu_kernel_pok_29
    s_add_u32 s30, s30, 1
    s_cmp_gt_u32 s30, 0x40000
    s_cbranch_scc1 fnet_glu_kernel_pok_29
    buffer_load_dword v2, v4, s[52:55], 0 offen sc1
    s_waitcnt vmcnt(0)
    s_branch fnet_glu_kernel_poll_28
fnet_glu_kernel_pok_29:
    s_add_u32 s30, s28, 0
    buffer_load_dwordx4 v[64:67], v32, s[16:19], s30 offen sc1
    s_add_u32 s30, s28, 2359296
    buffer_load_dwordx4 v[68:71], v32, s[16:19], s30 offen sc1
    s_add_u32 s30, s28, 4718592
    buffer_load_dwordx4 v[72:75], v32, s[16:19], s30 offen sc1
    s_add_u32 s30, s28, 7077888
    buffer_load_dwordx4 v[76:79], v32, s[16:19], s30 offen sc1
    s_add_u32 s30, s28, 9437184
    buffer_load_dwordx4 v[80:83], v32, s[16:19], s30 offen sc1
    s_add_u32 s30, s28, 3072
    buffer_load_dwordx4 v[84:87], v32, s[16:19], s30 offen sc1
    s_add_u32 s30, s28, 2362368
    buffer_load_dwordx4 v[88:91], v32, s[16:19], s30 offen sc1
    s_add_u32 s30, s28, 4721664
    buffer_load_dwordx4 v[92:95], v32, s[16:19], s30 offen sc1
    s_add_u32 s30, s28, 7080960
    buffer_load_dwordx4 v[96:99], v32, s[16:19], s30 offen sc1
    s_add_u32 s30, s28, 9440256
    buffer_load_dwordx4 v[100:103], v32, s[16:19], s30 offen sc1
    s_add_u32 s30, s28, 6144
    buffer_load_dwordx4 v[104:107], v32, s[16:19], s30 offen sc1
    s_add_u32 s30, s28, 2365440
    buffer_load_dwordx4 v[108:111], v32, s[16:19], s30 offen sc1
    s_add_u32 s30, s28, 4724736
    buffer_load_dwordx4 v[112:115], v32, s[16:19], s30 offen sc1
    s_add_u32 s30, s28, 7084032
    buffer_load_dwordx4 v[116:119], v32, s[16:19], s30 offen sc1
    s_add_u32 s30, s28, 9443328
    buffer_load_dwordx4 v[120:123], v32, s[16:19], s30 offen sc1
    s_mov_b32 s30, 0x00003f80
    s_mov_b32 s31, 0x3f800000
    s_waitcnt vmcnt(10)
    v_lshlrev_b32 v136, 16, v64
    v_and_b32 v137, 0xffff0000, v64
    v_lshlrev_b32 v138, 16, v65
    v_and_b32 v139, 0xffff0000, v65
    v_lshlrev_b32 v140, 16, v66
    v_and_b32 v141, 0xffff0000, v66
    v_lshlrev_b32 v142, 16, v67
    v_and_b32 v143, 0xffff0000, v67
    v_dot2_f32_bf16 v136, v68, s30, v136
    v_dot2_f32_bf16 v137, v68, s31, v137
    v_dot2_f32_bf16 v138, v69, s30, v138
    v_dot2_f32_bf16 v139, v69, s31, v139
    v_dot2_f32_bf16 v140, v70, s30, v140
    v_dot2_f32_bf16 v141, v70, s31, v141
    v_dot2_f32_bf16 v142, v71, s30, v142
    v_dot2_f32_bf16 v143, v71, s31, v143
    v_dot2_f32_bf16 v136, v72, s30, v136
    v_dot2_f32_bf16 v137, v72, s31, v137
    v_dot2_f32_bf16 v138, v73, s30, v138
    v_dot2_f32_bf16 v139, v73, s31, v139
    v_dot2_f32_bf16 v140, v74, s30, v140
    v_dot2_f32_bf16 v141, v74, s31, v141
    v_dot2_f32_bf16 v142, v75, s30, v142
    v_dot2_f32_bf16 v143, v75, s31, v143
    v_dot2_f32_bf16 v136, v76, s30, v136
    v_dot2_f32_bf16 v137, v76, s31, v137
    v_dot2_f32_bf16 v138, v77, s30, v138
    v_dot2_f32_bf16 v139, v77, s31, v139
    v_dot2_f32_bf16 v140, v78, s30, v140
    v_dot2_f32_bf16 v141, v78, s31, v141
    v_dot2_f32_bf16 v142, v79, s30, v142
    v_dot2_f32_bf16 v143, v79, s31, v143
    v_dot2_f32_bf16 v136, v80, s30, v136
    v_dot2_f32_bf16 v137, v80, s31, v137
    v_dot2_f32_bf16 v138, v81, s30, v138
    v_dot2_f32_bf16 v139, v81, s31, v139
    v_dot2_f32_bf16 v140, v82, s30, v140
    v_dot2_f32_bf16 v141, v82, s31, v141
    v_dot2_f32_bf16 v142, v83, s30, v142
    v_dot2_f32_bf16 v143, v83, s31, v143
    s_waitcnt vmcnt(5)
    v_lshlrev_b32 v144, 16, v84
    v_and_b32 v145, 0xffff0000, v84
    v_lshlrev_b32 v146, 16, v85
    v_and_b32 v147, 0xffff0000, v85
    v_lshlrev_b32 v148, 16, v86
    v_and_b32 v149, 0xffff0000, v86
    v_lshlrev_b32 v150, 16, v87
    v_and_b32 v151, 0xffff0000, v87
    v_dot2_f32_bf16 v144, v88, s30, v144
    v_dot2_f32_bf16 v145, v88, s31, v145
    v_dot2_f32_bf16 v146, v89, s30, v146
    v_dot2_f32_bf16 v147, v89, s31, v147
    v_dot2_f32_bf16 v148, v90, s30, v148
    v_dot2_f32_bf16 v149, v90, s31, v149
    v_dot2_f32_bf16 v150, v91, s30, v150
    v_dot2_f32_bf16 v151, v91, s31, v151
    v_dot2_f32_bf16 v144, v92, s30, v144
    v_dot2_f32_bf16 v145, v92, s31, v145
    v_dot2_f32_bf16 v146, v93, s30, v146
    v_dot2_f32_bf16 v147, v93, s31, v147
    v_dot2_f32_bf16 v148, v94, s30, v148
    v_dot2_f32_bf16 v149, v94, s31, v149
    v_dot2_f32_bf16 v150, v95, s30, v150
    v_dot2_f32_bf16 v151, v95, s31, v151
    v_dot2_f32_bf16 v144, v96, s30, v144
    v_dot2_f32_bf16 v145, v96, s31, v145
    v_dot2_f32_bf16 v146, v97, s30, v146
    v_dot2_f32_bf16 v147, v97, s31, v147
    v_dot2_f32_bf16 v148, v98, s30, v148
    v_dot2_f32_bf16 v149, v98, s31, v149
    v_dot2_f32_bf16 v150, v99, s30, v150
    v_dot2_f32_bf16 v151, v99, s31, v151
    v_dot2_f32_bf16 v144, v100, s30, v144
    v_dot2_f32_bf16 v145, v100, s31, v145
    v_dot2_f32_bf16 v146, v101, s30, v146
    v_dot2_f32_bf16 v147, v101, s31, v147
    v_dot2_f32_bf16 v148, v102, s30, v148
    v_dot2_f32_bf16 v149, v102, s31, v149
    v_dot2_f32_bf16 v150, v103, s30, v150
    v_dot2_f32_bf16 v151, v103, s31, v151
    s_waitcnt vmcnt(0)
    v_lshlrev_b32 v152, 16, v104
    v_and_b32 v153, 0xffff0000, v104
    v_lshlrev_b32 v154, 16, v105
    v_and_b32 v155, 0xffff0000, v105
    v_lshlrev_b32 v156, 16, v106
    v_and_b32 v157, 0xffff0000, v106
    v_lshlrev_b32 v158, 16, v107
    v_and_b32 v159, 0xffff0000, v107
    v_dot2_f32_bf16 v152, v108, s30, v152
    v_dot2_f32_bf16 v153, v108, s31, v153
    v_dot2_f32_bf16 v154, v109, s30, v154
    v_dot2_f32_bf16 v155, v109, s31, v155
    v_dot2_f32_bf16 v156, v110, s30, v156
    v_dot2_f32_bf16 v157, v110, s31, v157
    v_dot2_f32_bf16 v158, v111, s30, v158
    v_dot2_f32_bf16 v159, v111, s31, v159
    v_dot2_f32_bf16 v152, v112, s30, v152
    v_dot2_f32_bf16 v153, v112, s31, v153
    v_dot2_f32_bf16 v154, v113, s30, v154
    v_dot2_f32_bf16 v155, v113, s31, v155
    v_dot2_f32_bf16 v156, v114, s30, v156
    v_dot2_f32_bf16 v157, v114, s31, v157
    v_dot2_f32_bf16 v158, v115, s30, v158
    v_dot2_f32_bf16 v159, v115, s31, v159
    v_dot2_f32_bf16 v152, v116, s30, v152
    v_dot2_f32_bf16 v153, v116, s31, v153
    v_dot2_f32_bf16 v154, v117, s30, v154
    v_dot2_f32_bf16 v155, v117, s31, v155
    v_dot2_f32_bf16 v156, v118, s30, v156
    v_dot2_f32_bf16 v157, v118, s31, v157
    v_dot2_f32_bf16 v158, v119, s30, v158
    v_dot2_f32_bf16 v159, v119, s31, v159
    v_dot2_f32_bf16 v152, v120, s30, v152
    v_dot2_f32_bf16 v153, v120, s31, v153
    v_dot2_f32_bf16 v154, v121, s30, v154
    v_dot2_f32_bf16 v155, v121, s31, v155
    v_dot2_f32_bf16 v156, v122, s30, v156
    v_dot2_f32_bf16 v157, v122, s31, v157
    v_dot2_f32_bf16 v158, v123, s30, v158
    v_dot2_f32_bf16 v159, v123, s31, v159
    v_mov_b32 v160, 0xbf317218
    v_mov_b32 v161, v160
    s_nop 0
    v_pk_mul_f32 v[136:137], v[136:137], v[160:161]
    v_pk_mul_f32 v[138:139], v[138:139], v[160:161]
    v_pk_mul_f32 v[140:141], v[140:141], v[160:161]
    v_pk_mul_f32 v[142:143], v[142:143], v[160:161]
    v_pk_mul_f32 v[144:145], v[144:145], v[160:161]
    v_pk_mul_f32 v[146:147], v[146:147], v[160:161]
    v_pk_mul_f32 v[148:149], v[148:149], v[160:161]
    v_pk_mul_f32 v[150:151], v[150:151], v[160:161]
    v_pk_mul_f32 v[152:153], v[152:153], v[160:161]
    v_pk_mul_f32 v[154:155], v[154:155], v[160:161]
    v_pk_mul_f32 v[156:157], v[156:157], v[160:161]
    v_pk_mul_f32 v[158:159], v[158:159], v[160:161]
    v_dot2_f32_bf16 v136, v208, s30, v136
    v_dot2_f32_bf16 v137, v208, s31, v137
    v_dot2_f32_bf16 v138, v209, s30, v138
    v_dot2_f32_bf16 v139, v209, s31, v139
    v_dot2_f32_bf16 v140, v210, s30, v140
    v_dot2_f32_bf16 v141, v210, s31, v141
    v_dot2_f32_bf16 v142, v211, s30, v142
    v_dot2_f32_bf16 v143, v211, s31, v143
    v_dot2_f32_bf16 v144, v212, s30, v144
    v_dot2_f32_bf16 v145, v212, s31, v145
    v_dot2_f32_bf16 v146, v213, s30, v146
    v_dot2_f32_bf16 v147, v213, s31, v147
    v_dot2_f32_bf16 v148, v214, s30, v148
    v_dot2_f32_bf16 v149, v214, s31, v149
    v_dot2_f32_bf16 v150, v215, s30, v150
    v_dot2_f32_bf16 v151, v215, s31, v151
    v_dot2_f32_bf16 v152, v216, s30, v152
    v_dot2_f32_bf16 v153, v216, s31, v153
    v_dot2_f32_bf16 v154, v217, s30, v154
    v_dot2_f32_bf16 v155, v217, s31, v155
    v_dot2_f32_bf16 v156, v218, s30, v156
    v_dot2_f32_bf16 v157, v218, s31, v157
    v_dot2_f32_bf16 v158, v219, s30, v158
    v_dot2_f32_bf16 v159, v219, s31, v159
    v_cvt_pk_bf16_f32 v64, v136, v137
    v_cvt_pk_bf16_f32 v65, v138, v139
    v_cvt_pk_bf16_f32 v66, v140, v141
    v_cvt_pk_bf16_f32 v67, v142, v143
    v_cvt_pk_bf16_f32 v68, v144, v145
    v_cvt_pk_bf16_f32 v69, v146, v147
    v_cvt_pk_bf16_f32 v70, v148, v149
    v_cvt_pk_bf16_f32 v71, v150, v151
    v_cvt_pk_bf16_f32 v72, v152, v153
    v_cvt_pk_bf16_f32 v73, v154, v155
    v_cvt_pk_bf16_f32 v74, v156, v157
    v_cvt_pk_bf16_f32 v75, v158, v159
    buffer_store_dwordx4 v[64:67], v33, s[8:11], s28 offen offset:0
    buffer_store_dwordx4 v[68:71], v33, s[8:11], s28 offen offset:96
    buffer_store_dwordx4 v[72:75], v33, s[8:11], s28 offen offset:192
fnet_glu_kernel_end:
    s_endpgm
.section .rodata,"a"
.p2align 6
.amdhsa_kernel sequential_preLN__spectral_fnet__glu_gated_glu__prompt_kernel
  .amdhsa_next_free_vgpr 512
  .amdhsa_next_free_sgpr 102
  .amdhsa_accum_offset 256
  .amdhsa_group_segment_fixed_size 0
  .amdhsa_kernarg_size 96
  .amdhsa_user_sgpr_count 2
  .amdhsa_user_sgpr_kernarg_segment_ptr 1
  .amdhsa_system_sgpr_workgroup_id_x 1
  .amdhsa_float_denorm_mode_32 3
  .amdhsa_float_denorm_mode_16_64 3
.end_amdhsa_kernel
```
